```python
import torch

def _softmax(x, axis=-1):
    return torch.softmax(x, dim=axis)
def _gelu(x):
    return torch.nn.functional.gelu(x, approximate="tanh")
def _silu(x):
    return torch.nn.functional.silu(x)
def _sigmoid(x):
    return torch.sigmoid(x)
def _layernorm(x, axis=-1, eps=1e-5):
    m = x.mean(dim=axis, keepdim=True)
    v = x.var(dim=axis, keepdim=True, unbiased=False)
    return (x - m) / torch.sqrt(v + eps)
def _scatter_add(tgt, idx, src, axis=0):
    return tgt.clone().index_add_(axis, idx, src)
def _segment_sum(src, seg, n):
    out = torch.zeros((n,) + src.shape[1:], dtype=src.dtype)
    return out.index_add_(0, seg, src)
def _pad(x, pw):
    flat = tuple(v for pair in reversed(pw) for v in pair)
    return torch.nn.functional.pad(x, flat)

kernel_name = 'interleave_layers__ssm_conv_h3__dense_activation_gelu__prompt'

def setup_inputs():

    _w = (lambda a: (lambda t: t.to(torch.bfloat16) if t.is_floating_point() else t)(torch.as_tensor(a)))
    def _A_setup():
        B, S, D = 1, 2048, 512
        ks = 4
        return {
            "q": _w((lambda *s: torch.randn(*s, dtype=torch.bfloat16) * 0.05)(B, S, D)),
            "k": _w((lambda *s: torch.randn(*s, dtype=torch.bfloat16) * 0.2)(B, S, D)),
            "v": _w((lambda *s: torch.randn(*s, dtype=torch.bfloat16) * 0.2)(B, S, D)),
            "shift_k": _w((lambda *s: torch.randn(*s, dtype=torch.bfloat16) * 0.2)(D, ks) * 0.5),
            "ssm_k": _w((lambda *s: torch.randn(*s, dtype=torch.bfloat16) * 0.4)(D, S) * (1.0 / S ** 0.5)),
            "ssm_D": _w((lambda *s: torch.randn(*s, dtype=torch.bfloat16) * 0.2)(D)),
        }
    _A_in = _A_setup()

    def _B_setup():
        B, S, D, F = 1, 2048, 512, 1376
        return {
            "x": _w((lambda *s: torch.randn(*s, dtype=torch.bfloat16) * 0.05)(B, S, D)),
            "w1": _w((lambda *s: torch.randn(*s, dtype=torch.bfloat16) * 0.4)(D, F) * (D ** -0.5)),
            "b1": _w((lambda *s: torch.randn(*s, dtype=torch.bfloat16) * 12.8)(F) * 0.01),
            "w2": _w((lambda *s: torch.randn(*s, dtype=torch.bfloat16) * 0.1)(F, D) * (F ** -0.5)),
            "b2": _w((lambda *s: torch.randn(*s, dtype=torch.bfloat16) * 0.8)(D) * 0.01),
        }
    _B_in = _B_setup()

    return {
        "A_q": _A_in["q"],
        "A_k": _A_in["k"],
        "A_v": _A_in["v"],
        "A_shift_k": _A_in["shift_k"],
        "A_ssm_k": _A_in["ssm_k"],
        "A_ssm_D": _A_in["ssm_D"],
        "B_x": _B_in["x"],
        "B_w1": _B_in["w1"],
        "B_b1": _B_in["b1"],
        "B_w2": _B_in["w2"],
        "B_b2": _B_in["b2"],
    }

def reference(A_q, A_k, A_v, A_shift_k, A_ssm_k, A_ssm_D, B_x, B_w1, B_b1, B_w2, B_b2):
    def _A_ref(q, k, v, shift_k, ssm_k, ssm_D):
        B, S, D = q.shape
        ks = shift_k.shape[-1]
        k_pad = _pad(k, ((0, 0), (ks - 1, 0), (0, 0)))
        k_shift = torch.zeros_like(k)
        for t in range(ks):
            k_shift = k_shift + k_pad[:, t:t + S, :] * shift_k[:, ks - 1 - t][None, None, :]
        kv = k_shift * v
        L = 2 * S
        kv_pad = _pad(kv, ((0, 0), (0, S), (0, 0)))
        kf_pad = _pad(ssm_k, ((0, 0), (0, S)))
        kv_f = (lambda x, axes=(-2,-1): torch.fft.rfft2(x.float(), dim=axes))(kv_pad[:, None, :, :], axes=(1, 2))
        kf_f = (lambda x, axes=(-2,-1): torch.fft.rfft2(x.float(), dim=axes))(kf_pad[:, None, :], axes=(1, 2))
        kf_f = (lambda x, *d: x.permute(*d))(kf_f, 1, 2, 0)
        y_f = kv_f * kf_f[None, :, :, :]
        y = (lambda x, s, axes=(-2,-1): torch.fft.irfft2(x, s=s, dim=axes).to(torch.bfloat16))(y_f, (1, L), axes=(1, 2))[:, 0, :S, :]
        y = y + kv * ssm_D[None, None, :]
        return q * y

    def _B_ref(x, w1, b1, w2, b2):
        h = torch.einsum("bsd,df->bsf", x, w1) + b1
        h = _gelu(h)
        return torch.einsum("bsf,fd->bsd", h, w2) + b2

    x = A_q
    x = x + _A_ref(_layernorm(x, axis=-1), A_k, A_v, A_shift_k, A_ssm_k, A_ssm_D)
    x = x + _B_ref(_layernorm(x, axis=-1), B_w1, B_b1, B_w2, B_b2)
    x = x + _A_ref(_layernorm(x, axis=-1), A_k, A_v, A_shift_k, A_ssm_k, A_ssm_D)
    x = x + _B_ref(_layernorm(x, axis=-1), B_w1, B_b1, B_w2, B_b2)
    return x
```

```asm
; @launch grid=(256,1,1) block=(256,1,1) lds=149392
.amdgcn_target "amdgcn-amd-amdhsa--gfx950"
.text
.globl interleave_layers__ssm_conv_h3__dense_activation_gelu__prompt_kernel
.p2align 8
.type interleave_layers__ssm_conv_h3__dense_activation_gelu__prompt_kernel,@function
interleave_layers__ssm_conv_h3__dense_activation_gelu__prompt_kernel:
    s_cmp_ge_u32 s2, 256
    s_cbranch_scc1 K1_END
    s_load_dwordx2 s[8:9], s[0:1], 8
    s_load_dwordx2 s[12:13], s[0:1], 16
    s_load_dwordx8 s[64:71], s[0:1], 0
    s_load_dwordx4 s[40:43], s[0:1], 32
    s_load_dwordx8 s[72:79], s[0:1], 56
    s_load_dwordx2 s[50:51], s[0:1], 88
    s_load_dwordx2 s[52:53], s[0:1], 104
    s_getpc_b64 s[30:31]
    v_lshrrev_b32 v2, 6, v0
    s_bfe_u32 s38, s2, 0x40003
    v_lshl_add_u32 v21, s38, 8, v0
    v_min_u32 v21, (K1_SLOW-interleave_layers__ssm_conv_h3__dense_activation_gelu__prompt_kernel-64)/16, v21
    v_lshlrev_b32 v21, 4, v21
    global_load_dwordx4 v[168:171], v21, s[30:31]
    v_readfirstlane_b32 s16, v2
    v_and_b32 v14, 7, v0
    v_lshrrev_b32 v21, 3, v0
    v_lshlrev_b32 v21, 6, v21
    v_add_u32 v21, v14, v21
    v_lshlrev_b32 v21, 4, v21
    s_lshr_b32 s28, s2, 6
    s_and_b32 s17, s2, 7
    s_lshl3_add_u32 s17, s28, s17
    s_and_b32 s18, s38, 7
    s_lshl_b32 s38, s17, 9
    s_add_u32 s38, s38, s18
    s_lshl_b32 s38, s38, 7
    s_lshl_b32 s10, 1, 21
    s_lshl_b32 s11, 1, 17
    s_mov_b64 s[14:15], s[10:11]
    s_mul_i32 s33, s16, 1040
    s_add_u32 m0, s33, 59920
    s_waitcnt lgkmcnt(0)
    buffer_load_dwordx4 v21, s[8:11], s38 offen lds
    s_addk_i32 m0, 8320
    v_and_b32 v1, 63, v0
    buffer_load_dwordx4 v21, s[12:15], s38 offen lds
    s_addk_i32 m0, -4160
    s_bitset1_b32 s38, 15
    buffer_load_dwordx4 v21, s[8:11], s38 offen lds
    s_addk_i32 m0, 8320
    s_cmp_lg_u32 s16, 0
    buffer_load_dwordx4 v21, s[12:15], s38 offen lds
    s_bitset0_b32 s38, 15
    s_cbranch_scc1 K1_NOHALO
    s_mov_b32 m0, 58880
    v_add_u32 v23, s38, v21
    v_add_u32 v23, 0xffffe000, v23
    buffer_load_dwordx4 v23, s[8:11], 0 offen lds
K1_NOHALO:
    v_lshrrev_b32 v15, 3, v1
    v_lshlrev_b32 v7, 10, v15
    v_lshl_add_u32 v7, v14, 4, v7
    s_and_b32 s19, s16, 1
    s_mov_b32 s29, s28
    s_mov_b32 s56, 0xffff0000
    s_mov_b32 s57, 0x3f803f80
    s_mov_b32 s58, 0xbdd2d3e8
    s_mov_b32 s59, 0xbdd2d3e8
    s_mov_b32 s62, 0x3b000000
    s_getreg_b32 s89, hwreg(HW_REG_XCC_ID, 0, 4)
    s_mov_b32 s24, s70
    s_and_b32 s25, s71, 0xffff
    s_mov_b32 s26, 0x1000
    s_mov_b32 s27, 0x20000
    s_mov_b32 s4, s52
    s_and_b32 s5, s53, 0xffff
    s_mov_b32 s6, 0x2400000
    s_mov_b32 s7, 0x20000
    v_mov_b32 v236, v0
    v_lshrrev_b32 v23, 3, v0
    s_lshl_b32 s33, s18, 9
    v_lshlrev_b32_e64 v21, 4, v23
    buffer_load_dwordx4 v[52:55], v21, s[24:27], s33 offen
    v_mov_b32_e64 v8, 0
    s_mov_b32 s33, 0x1308000
    buffer_load_dword v56, v8, s[4:7], s33 offen sc1
    v_lshlrev_b32_e64 v11, 4, v1
    v_mul_u32_u24 v242, 24576, v23
    v_lshl_add_u32 v242, v14, 4, v242
    v_mul_u32_u24 v243, 1040, v14
    v_lshl_add_u32 v243, v23, 2, v243
    v_add_u32 v243, 58880, v243
    s_mov_b32 s96, s76
    s_and_b32 s97, s77, 0xffff
    s_mov_b32 s98, 0x158000
    s_mov_b32 s99, 0x20000
    s_mul_i32 s35, s18, 352
    s_mul_i32 s36, s16, 96
    s_add_u32 s35, s35, s36
    s_cmp_eq_u32 s16, 3
    s_cselect_b32 s37, 4, 6
    s_cmp_eq_u32 s35, 2752
    s_cselect_b32 s37, 0, s37
    s_mov_b32 s39, 10923
    v_mov_b32 v23, 0x7ffffff0
    v_add_u32 v40, 0, v1
    v_mul_u32_u24 v21, s39, v40
    v_lshrrev_b32 v21, 16, v21
    v_mul_u32_u24 v22, 6, v21
    v_sub_u32_e64 v22, v40, v22
    v_cmp_gt_u32 vcc, s37, v22
    v_mul_u32_u24 v21, 2752, v21
    v_lshl_add_u32 v21, v22, 4, v21
    v_add_u32 v21, s35, v21
    v_cndmask_b32 v249, v23, v21, vcc
    v_add_u32 v40, 64, v1
    v_mul_u32_u24 v21, s39, v40
    v_lshrrev_b32 v21, 16, v21
    v_mul_u32_u24 v22, 6, v21
    v_sub_u32 v22, v40, v22
    v_cmp_gt_u32 vcc, s37, v22
    v_mul_u32_u24 v21, 2752, v21
    v_lshl_add_u32 v21, v22, 4, v21
    v_add_u32_e64 v21, s35, v21
    v_subrev_u32 v21, 1024, v21
    v_cndmask_b32 v250, v23, v21, vcc
    v_add_u32 v40, 128, v1
    v_mul_u32_u24 v21, s39, v40
    v_lshrrev_b32 v21, 16, v21
    v_mul_u32_u24 v22, 6, v21
    v_sub_u32 v22, v40, v22
    v_cmp_gt_u32 vcc, s37, v22
    v_mul_u32_u24 v21, 2752, v21
    v_lshl_add_u32 v21, v22, 4, v21
    v_add_u32_e64 v21, s35, v21
    v_subrev_u32 v21, 2048, v21
    v_cndmask_b32 v251, v23, v21, vcc
    s_mul_i32 s91, s16, 15360
    s_add_u32 s91, s91, 76928
    s_mov_b32 s24, s42
    s_and_b32 s25, s43, 0xffff
    s_mov_b32 s26, 0x400
    s_mov_b32 s27, 0x20000
    s_lshl_b32 s35, s2, 2
    s_and_b32 s36, s16, 2
    s_add_u32 s35, s35, s36
    buffer_load_ushort v46, v8, s[24:27], s35 offen
    s_mov_b32 s24, s74
    s_and_b32 s25, s75, 0xffff
    s_mov_b32 s26, 0xac0
    s_mov_b32 s27, 0x20000
    v_lshrrev_b32 v12, 4, v1
    s_mul_i32 s35, s18, 11
    s_mul_i32 s36, s16, 3
    s_add_u32 s35, s35, s36
    s_lshl_b32 s36, s35, 5
    v_lshlrev_b32 v21, 3, v12
    v_add_u32_e64 v21, s36, v21
    buffer_load_dwordx2 v[32:33], v21, s[24:27], 0 offen offset:0
    buffer_load_dwordx2 v[34:35], v21, s[24:27], 0 offen offset:32
    buffer_load_dwordx2 v[36:37], v21, s[24:27], 0 offen offset:64
    s_mov_b32 s24, s78
    s_and_b32 s25, s79, 0xffff
    s_mov_b32 s26, 0x400
    s_mov_b32 s27, 0x20000
    s_lshl_b32 s36, s18, 7
    v_lshlrev_b32_e64 v21, 1, v1
    buffer_load_ushort v38, v21, s[24:27], s36 offen
    s_mov_b32 s24, s72
    s_and_b32 s25, s73, 0xffff
    s_mov_b32 s26, 0x158000
    s_mov_b32 s27, 0x20000
    s_mul_i32 s35, s2, 5504
    v_lshlrev_b32 v21, 4, v236
    v_add_u32 v22, 4096, v21
    v_cmp_gt_u32 vcc, 5504, v22
    v_mov_b32 v164, 0x7ffffff0
    s_nop 0
    v_cndmask_b32 v22, v164, v22, vcc
    buffer_load_dwordx4 v[164:167], v21, s[24:27], s35 offen
    buffer_load_dwordx4 v[172:175], v22, s[24:27], s35 offen
    buffer_load_dwordx4 v[164:167], v21, s[96:99], s35 offen
    buffer_load_dwordx4 v[172:175], v22, s[96:99], s35 offen
K1_B1:
    s_mov_b32 s8, s40
    s_and_b32 s9, s41, 0xffff
    s_mov_b32 s10, 0x200000
    s_mov_b32 s11, 0x20000
    s_mov_b32 s12, s50
    s_and_b32 s13, s51, 0xffff
    s_mov_b32 s14, 0x200000
    s_mov_b32 s15, 0x20000
    s_mov_b32 s20, s64
    s_and_b32 s21, s65, 0xffff
    s_mov_b32 s22, 0x200000
    s_mov_b32 s23, 0x20000
    s_mov_b32 s43, s38
    s_lshl_b32 s36, s17, 9
    s_lshr_b32 s37, s18, 1
    s_lshl_b32 s37, s37, 7
    s_add_u32 s41, s36, s37
    s_and_b32 s37, s18, 1
    s_lshl_b32 s37, s37, 4
    s_add_u32 s41, s41, s37
    s_lshl_b32 s37, s16, 2
    s_add_u32 s41, s41, s37
    s_add_u32 s41, s41, 0x1310000
    s_lshl_b32 s37, s16, 7
    s_add_u32 s36, s36, s37
    s_add_u32 s42, s36, 0x1310000
    s_add_u32 s46, s36, 0x1320000
    s_lshl_b32 s37, s18, 2
    s_add_u32 s45, s46, s37
    s_lshr_b32 s35, s2, 2
    s_lshl_b32 s35, s35, 7
    s_and_b32 s36, s2, 3
    s_lshl_b32 s36, s36, 2
    s_add_u32 s93, s35, s36
    s_lshl_b32 s35, s18, 10
    s_lshr_b32 s36, s17, 2
    s_lshl_b32 s36, s36, 7
    s_add_u32 s35, s35, s36
    s_and_b32 s36, s17, 3
    s_lshl_b32 s36, s36, 2
    s_add_u32 s35, s35, s36
    s_add_u32 s86, s35, 0x130a000
    s_lshl_b32 s35, s17, 7
    s_add_u32 s87, s35, 0x1309000
    s_lshr_b32 s35, s2, 5
    s_lshl_b32 s35, s35, 10
    s_add_u32 s52, s35, 0x130a000
    s_lshl_b32 s35, s18, 10
    s_add_u32 s53, s35, 0x130e000
    s_sub_u32 s36, s45, 65536
    v_mov_b32 v21, s41
    v_mov_b32 v22, s36
    v_cmp_lt_u32 vcc, 3, v1
    s_nop 1
    v_cndmask_b32 v21, v21, v22, vcc
    v_lshl_add_u32 v21, v1, 14, v21
    v_mov_b32 v18, -1
    v_mov_b32 v19, -1
    s_mov_b64 exec, 0xff
    buffer_store_dword v18, v21, s[4:7], 0 offen sc1
    s_mov_b64 exec, -1
    v_bfe_u32 v21, v1, 3, 1
    v_lshlrev_b32 v21, 11, v21
    v_lshl_add_u32 v21, v14, 3, v21
    v_lshl_add_u32 v21, v12, 17, v21
    s_lshl_b32 s44, s17, 12
    s_add_u32 s44, s44, 0x1330000
    s_lshl_b32 s36, s18, 8
    s_add_u32 s35, s44, s36
    s_lshl_b32 s36, s16, 6
    s_add_u32 s35, s35, s36
    s_mov_b64 exec, 0xffffffff
    buffer_store_dwordx2 v[18:19], v21, s[4:7], s35 offen sc1
    s_mov_b64 exec, -1
    s_mul_i32 s94, s18, 786432
    s_lshl_b32 s35, s17, 7
    s_add_u32 s94, s94, s35
    s_add_u32 s94, s94, 0x1800
    s_add_u32 s34, s94, 4096
    s_mul_i32 s40, s2, 24576
    s_mul_i32 s36, s16, 3072
    s_add_u32 s40, s40, s36
    s_and_b32 s36, s2, 0xc7
    s_lshl_b32 s37, s16, 4
    s_add_u32 s36, s36, s37
    s_mul_i32 s49, s36, 24576
    s_and_b32 s36, s2, 0xc7
    s_mul_i32 s51, s36, 24576
    s_lshl_b32 s36, s16, 10
    s_add_u32 s47, s51, s36
    s_lshl_b32 s37, s16, 13
    v_add_u32_e64 v7, s37, v7
    s_mul_i32 s48, s16, 8448
    v_lshlrev_b32_e64 v12, 5, v12
    s_mul_i32 s36, s16, 384
    s_add_u32 s36, s36, 139264
    v_add_u32 v12, s36, v12
    v_lshlrev_b32 v248, 7, v14
    v_and_b32 v14, 7, v1
    v_lshrrev_b32_e64 v15, 3, v1
    s_mul_i32 s36, s18, 3
    s_mul_i32 s37, s28, 5
    s_add_u32 s36, s36, s37
    s_cmp_ge_u32 s36, 22
    s_cselect_b32 s37, 22, 0
    s_sub_u32 s36, s36, s37
    s_mul_i32 s95, s16, 22
    s_add_u32 s3, s95, s36
    s_lshl_b32 s3, s3, 14
    s_add_u32 s95, s95, 22
    s_lshl_b32 s95, s95, 14
    s_lshl_b32 s64, s36, 10
    s_cmp_ge_u32 s36, 11
    s_cselect_b32 s37, 185344, 0
    s_add_u32 s64, s64, s37
    s_mov_b32 s36, 196608
    s_add_u32 s65, s64, 1024
    s_cmp_eq_u32 s65, 11264
    s_cselect_b32 s65, s36, s65
    s_cmp_eq_u32 s65, 207872
    s_cselect_b32 s65, 0, s65
    s_add_u32 s66, s65, 1024
    s_cmp_eq_u32 s66, 11264
    s_cselect_b32 s66, s36, s66
    s_cmp_eq_u32 s66, 207872
    s_cselect_b32 s66, 0, s66
    s_add_u32 s67, s66, 1024
    s_cmp_eq_u32 s67, 11264
    s_cselect_b32 s67, s36, s67
    s_cmp_eq_u32 s67, 207872
    s_cselect_b32 s67, 0, s67
    s_add_u32 s68, s67, 1024
    s_cmp_eq_u32 s68, 11264
    s_cselect_b32 s68, s36, s68
    s_cmp_eq_u32 s68, 207872
    s_cselect_b32 s68, 0, s68
    s_add_u32 s69, s68, 1024
    s_cmp_eq_u32 s69, 11264
    s_cselect_b32 s69, s36, s69
    s_cmp_eq_u32 s69, 207872
    s_cselect_b32 s69, 0, s69
    s_add_u32 s70, s69, 1024
    s_cmp_eq_u32 s70, 11264
    s_cselect_b32 s70, s36, s70
    s_cmp_eq_u32 s70, 207872
    s_cselect_b32 s70, 0, s70
    s_add_u32 s71, s70, 1024
    s_cmp_eq_u32 s71, 11264
    s_cselect_b32 s71, s36, s71
    s_cmp_eq_u32 s71, 207872
    s_cselect_b32 s71, 0, s71
    s_add_u32 s72, s71, 1024
    s_cmp_eq_u32 s72, 11264
    s_cselect_b32 s72, s36, s72
    s_cmp_eq_u32 s72, 207872
    s_cselect_b32 s72, 0, s72
    s_add_u32 s73, s72, 1024
    s_cmp_eq_u32 s73, 11264
    s_cselect_b32 s73, s36, s73
    s_cmp_eq_u32 s73, 207872
    s_cselect_b32 s73, 0, s73
    s_add_u32 s74, s73, 1024
    s_cmp_eq_u32 s74, 11264
    s_cselect_b32 s74, s36, s74
    s_cmp_eq_u32 s74, 207872
    s_cselect_b32 s74, 0, s74
    s_add_u32 s75, s74, 1024
    s_cmp_eq_u32 s75, 11264
    s_cselect_b32 s75, s36, s75
    s_cmp_eq_u32 s75, 207872
    s_cselect_b32 s75, 0, s75
    s_add_u32 s76, s75, 1024
    s_cmp_eq_u32 s76, 11264
    s_cselect_b32 s76, s36, s76
    s_cmp_eq_u32 s76, 207872
    s_cselect_b32 s76, 0, s76
    s_add_u32 s77, s76, 1024
    s_cmp_eq_u32 s77, 11264
    s_cselect_b32 s77, s36, s77
    s_cmp_eq_u32 s77, 207872
    s_cselect_b32 s77, 0, s77
    s_add_u32 s78, s77, 1024
    s_cmp_eq_u32 s78, 11264
    s_cselect_b32 s78, s36, s78
    s_cmp_eq_u32 s78, 207872
    s_cselect_b32 s78, 0, s78
    s_add_u32 s79, s78, 1024
    s_cmp_eq_u32 s79, 11264
    s_cselect_b32 s79, s36, s79
    s_cmp_eq_u32 s79, 207872
    s_cselect_b32 s79, 0, s79
    s_add_u32 s80, s79, 1024
    s_cmp_eq_u32 s80, 11264
    s_cselect_b32 s80, s36, s80
    s_cmp_eq_u32 s80, 207872
    s_cselect_b32 s80, 0, s80
    s_add_u32 s81, s80, 1024
    s_cmp_eq_u32 s81, 11264
    s_cselect_b32 s81, s36, s81
    s_cmp_eq_u32 s81, 207872
    s_cselect_b32 s81, 0, s81
    s_add_u32 s82, s81, 1024
    s_cmp_eq_u32 s82, 11264
    s_cselect_b32 s82, s36, s82
    s_cmp_eq_u32 s82, 207872
    s_cselect_b32 s82, 0, s82
    s_add_u32 s83, s82, 1024
    s_cmp_eq_u32 s83, 11264
    s_cselect_b32 s83, s36, s83
    s_cmp_eq_u32 s83, 207872
    s_cselect_b32 s83, 0, s83
    s_add_u32 s84, s83, 1024
    s_cmp_eq_u32 s84, 11264
    s_cselect_b32 s84, s36, s84
    s_cmp_eq_u32 s84, 207872
    s_cselect_b32 s84, 0, s84
    s_add_u32 s85, s84, 1024
    s_cmp_eq_u32 s85, 11264
    s_cselect_b32 s85, s36, s85
    s_cmp_eq_u32 s85, 207872
    s_cselect_b32 s85, 0, s85
    s_mul_i32 s50, s2, 24576
    s_lshl_b32 s36, s16, 3
    v_add_u32 v15, s36, v15
    v_lshlrev_b32 v5, 3, v15
    v_lshl_add_u32 v6, v14, 8, v5
    s_lshl_b32 s37, s18, 8
    v_add_u32 v5, s37, v5
    v_and_b32_e64 v2, 15, v1
    v_bfe_u32 v13, v1, 4, 1
    v_lshl_add_u32 v2, v13, 5, v2
    v_lshrrev_b32_e64 v13, 5, v1
    v_lshl_add_u32 v2, v13, 4, v2
    v_lshlrev_b32 v2, 4, v2
    v_and_b32 v3, 31, v1
    v_mul_u32_u24 v3, 272, v3
    v_lshl_add_u32 v3, v13, 6, v3
    s_mul_i32 s36, s16, 8704
    s_add_u32 s36, s36, 67584
    v_add_u32_e64 v3, s36, v3
    v_mul_u32_u24 v4, 272, v15
    v_lshl_add_u32 v4, v14, 5, v4
    v_add_u32 v4, 67584, v4
    v_lshrrev_b32_e64 v9, 4, v1
    s_mov_b32 s36, 393216
    v_mul_lo_u32 v9, s36, v9
    v_and_b32_e64 v10, 15, v1
    v_lshl_add_u32 v9, v10, 3, v9
    v_lshlrev_b32_e64 v10, 7, v15
    v_lshl_add_u32 v10, v14, 4, v10
    v_lshlrev_b32_e64 v13, 5, v14
    v_add_u32 v13, 140800, v13
    v_lshlrev_b32 v20, 2, v14
    v_lshlrev_b32 v23, 1, v15
    s_mov_b32 s39, 1040
    v_mad_u32_u24 v23, v14, s39, v23
    v_add_u32 v23, 141056, v23
    v_mov_b32 v0, 0xc0135761
    v_lshrrev_b32_e64 v22, 4, v1
    v_bfe_u32 v18, v1, 2, 2
    v_lshl_add_u32 v22, v22, 3, v18
    v_mul_u32_u24 v22, 96, v22
    v_and_b32_e64 v19, 3, v1
    v_lshl_add_u32 v22, v19, 3, v22
    v_add_u32 v252, s91, v22
    v_lshrrev_b32 v22, 5, v1
    v_lshl_add_u32 v22, v22, 2, v18
    v_lshlrev_b32 v22, 7, v22
    v_and_b32 v19, 1, v1
    v_lshl_add_u32 v22, v19, 5, v22
    v_bfe_u32 v19, v1, 4, 1
    v_lshl_add_u32 v22, v19, 4, v22
    v_bfe_u32 v19, v1, 1, 1
    v_lshl_add_u32 v22, v19, 3, v22
    v_add_u32 v17, s91, v22
    v_lshrrev_b32 v22, 3, v1
    v_lshlrev_b32_e64 v22, 10, v22
    v_lshl_add_u32 v22, v14, 4, v22
    s_lshl_b32 s36, s18, 7
    v_add_u32_e64 v253, s36, v22
    s_lshr_b32 s36, s16, 1
    s_mul_i32 s37, s36, 4608
    s_add_u32 s37, s37, 33280
    v_and_b32 v237, 15, v1
    v_lshrrev_b32 v238, 4, v1
    v_mov_b32 v184, 0
    v_mov_b32 v185, 0
    v_mov_b32 v186, 0
    v_mov_b32 v187, 0
    v_lshrrev_b32_e64 v21, 1, v236
    v_mul_u32_u24 v21, 4160, v21
    v_and_b32_e64 v22, 1, v236
    v_lshl_add_u32 v21, v22, 4, v21
    v_cmp_gt_u32 vcc, 16, v236
    s_nop 0
    s_and_saveexec_b64 s[38:39], vcc
    ds_write_b128 v21, v[184:187] offset:0
    s_mov_b64 exec, s[38:39]
    v_lshlrev_b32 v21, 4, v237
    s_lshl_b32 s38, s19, 8
    s_add_u32 s35, s38, s37
    v_add_u32 v21, s35, v21
    ds_write_b128 v21, v[184:187]
    v_lshlrev_b32_e64 v239, 5, v237
    v_lshl_add_u32 v239, v238, 4, v239
    s_sub_u32 s35, s37, s38
    s_add_u32 s35, s35, 288
    v_add_u32 v239, s35, v239
    v_sub_u32 v21, 3, v237
    v_and_b32 v21, 3, v21
    v_mul_u32_u24 v240, 4162, v21
    v_lshl_add_u32 v240, v237, 1, v240
    v_lshlrev_b32 v21, 4, v238
    v_sub_u32 v240, v240, v21
    s_mul_i32 s35, s36, 16640
    s_add_u32 s35, s35, s38
    s_add_u32 s35, s35, 50
    v_add_u32_e64 v240, s35, v240
    v_and_b32 v21, 127, v236
    v_lshrrev_b32_e64 v241, 7, v236
    v_mul_u32_u24 v241, 16640, v241
    v_lshl_add_u32 v241, v21, 5, v241
    v_cmp_eq_u32 s[100:101], 0, v21
    s_lshl_b32 s38, s16, 12
    s_add_u32 s38, s38, 42496
    v_add_u32 v244, s38, v11
    s_xor_b32 s39, s16, 1
    s_lshl_b32 s39, s39, 12
    s_add_u32 s39, s39, 42496
    v_add_u32 v245, s39, v11
    v_lshlrev_b32 v246, 5, v237
    v_lshrrev_b32_e64 v14, 1, v238
    v_lshl_add_u32 v246, v14, 4, v246
    v_and_b32 v21, 1, v238
    v_lshlrev_b32 v22, 3, v21
    v_sub_u32_e64 v246, v246, v22
    s_lshl_b32 s38, s19, 11
    s_add_u32 s38, s38, s37
    s_add_u32 s38, s38, 520
    v_add_u32 v246, s38, v246
    v_lshrrev_b32 v22, 2, v237
    v_lshl_add_u32 v22, v21, 2, v22
    v_mul_u32_u24 v247, 24576, v22
    v_and_b32 v21, 3, v237
    v_lshlrev_b32 v21, 5, v21
    v_lshl_add_u32 v21, v14, 4, v21
    v_add_u32 v247, v247, v21
    s_lshl_b32 s38, s36, 7
    s_lshr_b32 s35, s2, 5
    s_lshl_b32 s35, s35, 3
    s_lshl_b32 s39, s19, 7
    s_add_u32 s35, s35, s39
    s_mul_i32 s35, s35, 24576
    s_add_u32 s35, s35, s38
    s_and_b32 s39, s2, 31
    s_lshl_b32 s39, s39, 8
    s_add_u32 s35, s35, s39
    s_add_u32 s90, s35, 0x3800
    s_waitcnt vmcnt(13)
    s_barrier
    ds_read_b32 v58, v243 offset:640
    ds_read_b32 v59, v243 offset:768
    ds_read_b32 v60, v243 offset:896
    ds_read_b32 v61, v243 offset:1040
    ds_read_b32 v62, v243 offset:1168
    ds_read_b32 v63, v243 offset:1296
    ds_read_b32 v64, v243 offset:1424
    ds_read_b32 v65, v243 offset:1552
    ds_read_b32 v66, v243 offset:1680
    ds_read_b32 v67, v243 offset:1808
    ds_read_b32 v68, v243 offset:1936
    ds_read_b32 v76, v243 offset:9360
    ds_read_b32 v77, v243 offset:9488
    ds_read_b32 v78, v243 offset:9616
    ds_read_b32 v79, v243 offset:9744
    ds_read_b32 v80, v243 offset:9872
    ds_read_b32 v81, v243 offset:10000
    ds_read_b32 v82, v243 offset:10128
    ds_read_b32 v83, v243 offset:10256
    s_waitcnt vmcnt(12)
    v_lshlrev_b32 v84, 16, v52
    v_and_b32 v85, s56, v52
    v_lshlrev_b32 v86, 16, v53
    v_and_b32 v87, s56, v53
    v_lshlrev_b32 v88, 16, v54
    v_and_b32 v89, s56, v54
    v_lshlrev_b32 v90, 16, v55
    v_and_b32 v91, s56, v55
    s_waitcnt vmcnt(11)
    v_readfirstlane_b32 s92, v56
    s_waitcnt lgkmcnt(15)
    v_lshlrev_b32 v92, 16, v58
    v_and_b32 v104, s56, v58
    s_waitcnt lgkmcnt(15)
    v_lshlrev_b32 v93, 16, v59
    v_and_b32 v105, s56, v59
    s_waitcnt lgkmcnt(15)
    v_lshlrev_b32 v94, 16, v60
    v_and_b32 v106, s56, v60
    s_waitcnt lgkmcnt(15)
    v_lshlrev_b32 v95, 16, v61
    v_and_b32 v107, s56, v61
    s_waitcnt lgkmcnt(14)
    v_lshlrev_b32 v96, 16, v62
    v_and_b32 v108, s56, v62
    s_waitcnt lgkmcnt(13)
    v_lshlrev_b32 v97, 16, v63
    v_and_b32 v109, s56, v63
    s_waitcnt lgkmcnt(12)
    v_lshlrev_b32 v98, 16, v64
    v_and_b32 v110, s56, v64
    s_waitcnt lgkmcnt(11)
    v_lshlrev_b32 v99, 16, v65
    v_and_b32 v111, s56, v65
    s_waitcnt lgkmcnt(10)
    v_lshlrev_b32 v100, 16, v66
    v_and_b32 v112, s56, v66
    s_waitcnt lgkmcnt(9)
    v_lshlrev_b32 v101, 16, v67
    v_and_b32 v113, s56, v67
    s_waitcnt lgkmcnt(8)
    v_lshlrev_b32 v102, 16, v68
    v_and_b32 v114, s56, v68
    v_pk_mul_f32 v[116:117], v[92:93], v[86:87] op_sel:[0,1] op_sel_hi:[1,1]
    v_pk_mul_f32 v[118:119], v[94:95], v[86:87] op_sel:[0,1] op_sel_hi:[1,1]
    v_pk_mul_f32 v[120:121], v[96:97], v[86:87] op_sel:[0,1] op_sel_hi:[1,1]
    v_pk_mul_f32 v[122:123], v[98:99], v[86:87] op_sel:[0,1] op_sel_hi:[1,1]
    v_pk_fma_f32 v[116:117], v[94:95], v[84:85], v[116:117] op_sel:[0,1,0] op_sel_hi:[1,1,1]
    v_pk_fma_f32 v[118:119], v[96:97], v[84:85], v[118:119] op_sel:[0,1,0] op_sel_hi:[1,1,1]
    v_pk_fma_f32 v[120:121], v[98:99], v[84:85], v[120:121] op_sel:[0,1,0] op_sel_hi:[1,1,1]
    v_pk_fma_f32 v[122:123], v[100:101], v[84:85], v[122:123] op_sel:[0,1,0] op_sel_hi:[1,1,1]
    v_fmac_f32 v116, v93, v86
    v_fmac_f32 v117, v94, v86
    v_fmac_f32 v118, v95, v86
    v_fmac_f32 v119, v96, v86
    v_fmac_f32 v120, v97, v86
    v_fmac_f32 v121, v98, v86
    v_fmac_f32 v122, v99, v86
    v_fmac_f32 v123, v100, v86
    v_fmac_f32 v116, v95, v84
    v_fmac_f32 v117, v96, v84
    v_fmac_f32 v118, v97, v84
    v_fmac_f32 v119, v98, v84
    v_fmac_f32 v120, v99, v84
    v_fmac_f32 v121, v100, v84
    v_fmac_f32 v122, v101, v84
    v_fmac_f32 v123, v102, v84
    v_pk_mul_f32 v[124:125], v[104:105], v[90:91] op_sel:[0,1] op_sel_hi:[1,1]
    v_pk_mul_f32 v[126:127], v[106:107], v[90:91] op_sel:[0,1] op_sel_hi:[1,1]
    v_pk_mul_f32 v[128:129], v[108:109], v[90:91] op_sel:[0,1] op_sel_hi:[1,1]
    v_pk_mul_f32 v[130:131], v[110:111], v[90:91] op_sel:[0,1] op_sel_hi:[1,1]
    v_pk_fma_f32 v[124:125], v[106:107], v[88:89], v[124:125] op_sel:[0,1,0] op_sel_hi:[1,1,1]
    v_pk_fma_f32 v[126:127], v[108:109], v[88:89], v[126:127] op_sel:[0,1,0] op_sel_hi:[1,1,1]
    v_pk_fma_f32 v[128:129], v[110:111], v[88:89], v[128:129] op_sel:[0,1,0] op_sel_hi:[1,1,1]
    v_pk_fma_f32 v[130:131], v[112:113], v[88:89], v[130:131] op_sel:[0,1,0] op_sel_hi:[1,1,1]
    v_fmac_f32 v124, v105, v90
    v_fmac_f32 v125, v106, v90
    v_fmac_f32 v126, v107, v90
    v_fmac_f32 v127, v108, v90
    v_fmac_f32 v128, v109, v90
    v_fmac_f32 v129, v110, v90
    v_fmac_f32 v130, v111, v90
    v_fmac_f32 v131, v112, v90
    v_fmac_f32 v124, v107, v88
    v_fmac_f32 v125, v108, v88
    v_fmac_f32 v126, v109, v88
    v_fmac_f32 v127, v110, v88
    v_fmac_f32 v128, v111, v88
    v_fmac_f32 v129, v112, v88
    v_fmac_f32 v130, v113, v88
    v_fmac_f32 v131, v114, v88
    s_waitcnt lgkmcnt(7)
    v_lshlrev_b32 v92, 16, v76
    v_and_b32 v104, s56, v76
    s_waitcnt lgkmcnt(6)
    v_lshlrev_b32 v93, 16, v77
    v_and_b32 v105, s56, v77
    s_waitcnt lgkmcnt(5)
    v_lshlrev_b32 v94, 16, v78
    v_and_b32 v106, s56, v78
    s_waitcnt lgkmcnt(4)
    v_lshlrev_b32 v95, 16, v79
    v_and_b32 v107, s56, v79
    s_waitcnt lgkmcnt(3)
    v_lshlrev_b32 v96, 16, v80
    v_and_b32 v108, s56, v80
    s_waitcnt lgkmcnt(2)
    v_lshlrev_b32 v97, 16, v81
    v_and_b32 v109, s56, v81
    s_waitcnt lgkmcnt(1)
    v_lshlrev_b32 v98, 16, v82
    v_and_b32 v110, s56, v82
    s_waitcnt lgkmcnt(0)
    v_lshlrev_b32 v99, 16, v83
    v_and_b32 v111, s56, v83
    v_pk_mul_f32 v[116:117], v[116:117], v[92:93]
    v_pk_mul_f32 v[118:119], v[118:119], v[94:95]
    v_pk_mul_f32 v[120:121], v[120:121], v[96:97]
    v_pk_mul_f32 v[122:123], v[122:123], v[98:99]
    v_cvt_pk_bf16_f32 v132, v123, v122
    v_cvt_pk_bf16_f32 v133, v121, v120
    v_cvt_pk_bf16_f32 v134, v119, v118
    v_cvt_pk_bf16_f32 v135, v117, v116
    buffer_store_dwordx4 v[132:135], v242, s[4:7], s94 offen sc1
    v_pk_mul_f32 v[124:125], v[124:125], v[104:105]
    v_pk_mul_f32 v[126:127], v[126:127], v[106:107]
    v_pk_mul_f32 v[128:129], v[128:129], v[108:109]
    v_pk_mul_f32 v[130:131], v[130:131], v[110:111]
    v_cvt_pk_bf16_f32 v136, v131, v130
    v_cvt_pk_bf16_f32 v137, v129, v128
    v_cvt_pk_bf16_f32 v138, v127, v126
    v_cvt_pk_bf16_f32 v139, v125, v124
    buffer_store_dwordx4 v[136:139], v242, s[4:7], s34 offen sc1
    s_add_u32 s92, s92, 1
    v_lshlrev_b32 v21, 5, v236
    v_subrev_u32 v22, 8, v21
    v_max_i32_e64 v22, 0, v22
    s_lshl_b32 s32, s2, 13
    buffer_load_dwordx4 v[190:193], v21, s[8:11], s32 offen
    buffer_load_dwordx4 v[194:197], v21, s[8:11], s32 offen offset:16
    buffer_load_dwordx2 v[188:189], v22, s[8:11], s32 offen
    s_add_u32 s33, s29, 0
    s_and_b32 s33, s33, 3
    s_mul_i32 s33, s33, 352256
    s_add_u32 m0, s91, 0
    s_nop 0
    buffer_load_dwordx4 v249, s[24:27], s33 offen offset:0 lds
    buffer_load_dwordx4 v250, s[24:27], s33 offen offset:1024 lds
    buffer_load_dwordx4 v251, s[24:27], s33 offen offset:2048 lds
    s_add_u32 s33, s33, 88064
    s_add_u32 m0, s91, 3072
    s_nop 0
    buffer_load_dwordx4 v249, s[24:27], s33 offen offset:0 lds
    buffer_load_dwordx4 v250, s[24:27], s33 offen offset:1024 lds
    buffer_load_dwordx4 v251, s[24:27], s33 offen offset:2048 lds
    s_add_u32 s33, s33, 88064
    s_add_u32 m0, s91, 6144
    s_nop 0
    buffer_load_dwordx4 v249, s[24:27], s33 offen offset:0 lds
    buffer_load_dwordx4 v250, s[24:27], s33 offen offset:1024 lds
    buffer_load_dwordx4 v251, s[24:27], s33 offen offset:2048 lds
    s_add_u32 s33, s33, 88064
    s_add_u32 m0, s91, 9216
    s_nop 0
    buffer_load_dwordx4 v249, s[24:27], s33 offen offset:0 lds
    buffer_load_dwordx4 v250, s[24:27], s33 offen offset:1024 lds
    buffer_load_dwordx4 v251, s[24:27], s33 offen offset:2048 lds
    s_add_u32 s33, s29, 1
    s_and_b32 s33, s33, 3
    s_mul_i32 s33, s33, 352256
    s_add_u32 m0, s91, 12288
    s_nop 0
    buffer_load_dwordx4 v249, s[24:27], s33 offen offset:0 lds
    buffer_load_dwordx4 v250, s[24:27], s33 offen offset:1024 lds
    buffer_load_dwordx4 v251, s[24:27], s33 offen offset:2048 lds
    s_waitcnt vmcnt(29)
    v_lshlrev_b32 v60, 16, v32
    v_and_b32 v61, s56, v32
    v_lshlrev_b32 v62, 16, v33
    v_and_b32_e64 v63, s56, v33
    ds_write_b128 v12, v[60:63] offset:0
    s_waitcnt vmcnt(28)
    v_lshlrev_b32 v60, 16, v34
    v_and_b32 v61, s56, v34
    v_lshlrev_b32 v62, 16, v35
    v_and_b32_e64 v63, s56, v35
    ds_write_b128 v12, v[60:63] offset:128
    s_waitcnt vmcnt(27)
    v_lshlrev_b32 v60, 16, v36
    v_and_b32 v61, s56, v36
    v_lshlrev_b32 v62, 16, v37
    v_and_b32_e64 v63, s56, v37
    ds_write_b128 v12, v[60:63] offset:256
    s_waitcnt vmcnt(26)
    v_lshlrev_b32 v38, 16, v38
    v_lshlrev_b32_e64 v14, 2, v1
    v_add_u32 v14, 140800, v14
    ds_write_b32 v14, v38
    s_waitcnt vmcnt(18)
    s_barrier
    s_cmp_eq_u32 s16, 0
    s_cbranch_scc0 K1_F2
    v_mov_b32 v14, s92
    v_mov_b32_e64 v15, s89
    s_lshl_b32 s35, s18, 3
    s_add_u32 s35, s35, s87
    s_mov_b64 exec, 1
    buffer_store_dword v14, v8, s[4:7], s86 offen sc1
    buffer_store_dwordx2 v[14:15], v8, s[4:7], s35 offen sc1
    s_mov_b64 exec, -1
K1_F2:
    v_lshlrev_b32_e64 v41, 1, v20
    s_cmp_eq_u32 s16, 3
    s_cbranch_scc0 K1_X3
    s_waitcnt vmcnt(12)
    ds_read_b64_tr_b16 a[0:1], v252 offset:0
    ds_read_b64_tr_b16 a[2:3], v252 offset:384
    ds_read_b64_tr_b16 a[64:65], v252 offset:32
    ds_read_b64_tr_b16 a[66:67], v252 offset:416
    ds_read_b64_tr_b16 a[128:129], v252 offset:64
    ds_read_b64_tr_b16 a[130:131], v252 offset:448
    ds_write_b128 v241, v[190:193] offset:32
    ds_write_b128 v241, v[194:197] offset:48
    v_cndmask_b32 v188, v188, v184, s[100:101]
    v_cndmask_b32 v189, v189, v184, s[100:101]
    v_alignbit_b32 v198, v190, v189, 16
    v_alignbit_b32 v199, v191, v190, 16
    v_alignbit_b32 v200, v192, v191, 16
    v_alignbit_b32 v201, v193, v192, 16
    v_alignbit_b32 v202, v194, v193, 16
    v_alignbit_b32 v203, v195, v194, 16
    v_alignbit_b32 v204, v196, v195, 16
    v_alignbit_b32 v205, v197, v196, 16
    ds_write_b128 v241, v[198:201] offset:4192
    ds_write_b128 v241, v[202:205] offset:4208
    v_mov_b32 v206, v189
    v_mov_b32 v207, v190
    v_mov_b32 v208, v191
    v_mov_b32 v209, v192
    v_mov_b32 v210, v193
    v_mov_b32 v211, v194
    v_mov_b32 v212, v195
    v_mov_b32 v213, v196
    ds_write_b128 v241, v[206:209] offset:8352
    ds_write_b128 v241, v[210:213] offset:8368
    v_alignbit_b32 v214, v189, v188, 16
    v_alignbit_b32 v215, v190, v189, 16
    v_alignbit_b32 v216, v191, v190, 16
    v_alignbit_b32 v217, v192, v191, 16
    v_alignbit_b32 v218, v193, v192, 16
    v_alignbit_b32 v219, v194, v193, 16
    v_alignbit_b32 v220, v195, v194, 16
    v_alignbit_b32 v221, v196, v195, 16
    ds_write_b128 v241, v[214:217] offset:12512
    ds_write_b128 v241, v[218:221] offset:12528
    s_waitcnt vmcnt(9)
    ds_read_b64_tr_b16 a[4:5], v252 offset:3072
    ds_read_b64_tr_b16 a[6:7], v252 offset:3456
    ds_read_b64_tr_b16 a[68:69], v252 offset:3104
    ds_read_b64_tr_b16 a[70:71], v252 offset:3488
    ds_read_b64_tr_b16 a[132:133], v252 offset:3136
    ds_read_b64_tr_b16 a[134:135], v252 offset:3520
    s_waitcnt lgkmcnt(14)
    s_add_u32 s33, s33, 88064
    s_add_u32 m0, s91, 0
    s_nop 0
    buffer_load_dwordx4 v249, s[24:27], s33 offen offset:0 lds
    buffer_load_dwordx4 v250, s[24:27], s33 offen offset:1024 lds
    buffer_load_dwordx4 v251, s[24:27], s33 offen offset:2048 lds
    s_waitcnt vmcnt(9)
    ds_read_b64_tr_b16 a[8:9], v252 offset:6144
    ds_read_b64_tr_b16 a[10:11], v252 offset:6528
    ds_read_b64_tr_b16 a[72:73], v252 offset:6176
    ds_read_b64_tr_b16 a[74:75], v252 offset:6560
    ds_read_b64_tr_b16 a[136:137], v252 offset:6208
    ds_read_b64_tr_b16 a[138:139], v252 offset:6592
    s_waitcnt lgkmcnt(6)
    s_add_u32 s33, s33, 88064
    s_add_u32 m0, s91, 3072
    s_nop 0
    buffer_load_dwordx4 v249, s[24:27], s33 offen offset:0 lds
    buffer_load_dwordx4 v250, s[24:27], s33 offen offset:1024 lds
    buffer_load_dwordx4 v251, s[24:27], s33 offen offset:2048 lds
    s_waitcnt vmcnt(9)
    ds_read_b64_tr_b16 a[12:13], v252 offset:9216
    ds_read_b64_tr_b16 a[14:15], v252 offset:9600
    ds_read_b64_tr_b16 a[76:77], v252 offset:9248
    ds_read_b64_tr_b16 a[78:79], v252 offset:9632
    ds_read_b64_tr_b16 a[140:141], v252 offset:9280
    ds_read_b64_tr_b16 a[142:143], v252 offset:9664
    s_waitcnt lgkmcnt(6)
    s_add_u32 s33, s33, 88064
    s_add_u32 m0, s91, 6144
    s_nop 0
    buffer_load_dwordx4 v249, s[24:27], s33 offen offset:0 lds
    buffer_load_dwordx4 v250, s[24:27], s33 offen offset:1024 lds
    buffer_load_dwordx4 v251, s[24:27], s33 offen offset:2048 lds
    buffer_load_dwordx4 v[32:35], v248, s[4:7], s52 offen offset:0 sc1
    s_waitcnt vmcnt(10)
    ds_read_b64_tr_b16 a[16:17], v252 offset:12288
    ds_read_b64_tr_b16 a[18:19], v252 offset:12672
    ds_read_b64_tr_b16 a[80:81], v252 offset:12320
    ds_read_b64_tr_b16 a[82:83], v252 offset:12704
    ds_read_b64_tr_b16 a[144:145], v252 offset:12352
    ds_read_b64_tr_b16 a[146:147], v252 offset:12736
    s_waitcnt lgkmcnt(6)
    s_add_u32 s33, s29, 2
    s_and_b32 s33, s33, 3
    s_mul_i32 s33, s33, 352256
    s_add_u32 m0, s91, 9216
    s_nop 0
    buffer_load_dwordx4 v249, s[24:27], s33 offen offset:0 lds
    buffer_load_dwordx4 v250, s[24:27], s33 offen offset:1024 lds
    buffer_load_dwordx4 v251, s[24:27], s33 offen offset:2048 lds
    s_waitcnt vmcnt(10)
    ds_read_b64_tr_b16 a[20:21], v252 offset:0
    ds_read_b64_tr_b16 a[22:23], v252 offset:384
    ds_read_b64_tr_b16 a[84:85], v252 offset:32
    ds_read_b64_tr_b16 a[86:87], v252 offset:416
    ds_read_b64_tr_b16 a[148:149], v252 offset:64
    ds_read_b64_tr_b16 a[150:151], v252 offset:448
    s_waitcnt lgkmcnt(6)
    s_add_u32 s33, s33, 88064
    s_add_u32 m0, s91, 12288
    s_nop 0
    buffer_load_dwordx4 v249, s[24:27], s33 offen offset:0 lds
    buffer_load_dwordx4 v250, s[24:27], s33 offen offset:1024 lds
    buffer_load_dwordx4 v251, s[24:27], s33 offen offset:2048 lds
    s_waitcnt vmcnt(10)
    ds_read_b64_tr_b16 a[24:25], v252 offset:3072
    ds_read_b64_tr_b16 a[26:27], v252 offset:3456
    ds_read_b64_tr_b16 a[88:89], v252 offset:3104
    ds_read_b64_tr_b16 a[90:91], v252 offset:3488
    ds_read_b64_tr_b16 a[152:153], v252 offset:3136
    ds_read_b64_tr_b16 a[154:155], v252 offset:3520
    s_waitcnt lgkmcnt(6)
    s_add_u32 s33, s33, 88064
    s_add_u32 m0, s91, 0
    s_nop 0
    buffer_load_dwordx4 v249, s[24:27], s33 offen offset:0 lds
    buffer_load_dwordx4 v250, s[24:27], s33 offen offset:1024 lds
    buffer_load_dwordx4 v251, s[24:27], s33 offen offset:2048 lds
    s_waitcnt vmcnt(9)
    v_xor_b32 v32, s92, v32
    v_xor_b32 v33, s92, v33
    v_xor_b32 v34, s92, v34
    v_xor_b32_e64 v35, s92, v35
    v_or3_b32 v36, v32, v33, v34
    v_or_b32_e64 v36, v36, v35
    v_cmp_ne_u32 vcc, 0, v36
    s_nop 0
    s_and_b64 vcc, exec, vcc
    s_cbranch_vccz K1_PDONE7
    s_mov_b32 s63, 524288
K1_POLL6:
    buffer_load_dwordx4 v[32:35], v248, s[4:7], s52 offen offset:0 sc1
    s_waitcnt vmcnt(0)
    v_xor_b32 v32, s92, v32
    v_xor_b32 v33, s92, v33
    v_xor_b32 v34, s92, v34
    v_xor_b32_e64 v35, s92, v35
    v_or3_b32 v36, v32, v33, v34
    v_or_b32 v36, v36, v35
    v_cmp_ne_u32 vcc, 0, v36
    s_nop 0
    s_and_b64 vcc, exec, vcc
    s_cbranch_vccz K1_PDONE7
    s_sub_u32 s63, s63, 1
    s_cmp_lg_u32 s63, 0
    s_cbranch_scc1 K1_POLL6
K1_PDONE7:
    s_mul_i32 s35, s2, 24576
    s_add_u32 s35, s35, 0x1800
    s_mov_b32 m0, 33792
    s_nop 0
    buffer_load_dwordx4 v11, s[4:7], s35 offen offset:0 sc1 lds
    buffer_load_dwordx4 v11, s[4:7], s35 offen offset:1024 sc1 lds
    buffer_load_dwordx4 v11, s[4:7], s35 offen offset:2048 sc1 lds
    buffer_load_dwordx4 v11, s[4:7], s35 offen offset:3072 sc1 lds
    s_add_u32 s35, s35, 4096
    s_mov_b32 m0, 38400
    s_nop 0
    buffer_load_dwordx4 v11, s[4:7], s35 offen offset:0 sc1 lds
    buffer_load_dwordx4 v11, s[4:7], s35 offen offset:1024 sc1 lds
    buffer_load_dwordx4 v11, s[4:7], s35 offen offset:2048 sc1 lds
    buffer_load_dwordx4 v11, s[4:7], s35 offen offset:3072 sc1 lds
    buffer_load_dwordx2 v[42:43], v41, s[4:7], s87 offen sc1
    ds_read_b64_tr_b16 a[28:29], v252 offset:6144
    ds_read_b64_tr_b16 a[30:31], v252 offset:6528
    ds_read_b64_tr_b16 a[92:93], v252 offset:6176
    ds_read_b64_tr_b16 a[94:95], v252 offset:6560
    ds_read_b64_tr_b16 a[156:157], v252 offset:6208
    ds_read_b64_tr_b16 a[158:159], v252 offset:6592
    s_waitcnt lgkmcnt(6)
    s_add_u32 s33, s33, 88064
    s_add_u32 m0, s91, 3072
    s_nop 0
    buffer_load_dwordx4 v249, s[24:27], s33 offen offset:0 lds
    buffer_load_dwordx4 v250, s[24:27], s33 offen offset:1024 lds
    buffer_load_dwordx4 v251, s[24:27], s33 offen offset:2048 lds
    s_waitcnt vmcnt(18)
    ds_read_b64_tr_b16 a[32:33], v252 offset:9216
    ds_read_b64_tr_b16 a[34:35], v252 offset:9600
    ds_read_b64_tr_b16 a[96:97], v252 offset:9248
    ds_read_b64_tr_b16 a[98:99], v252 offset:9632
    ds_read_b64_tr_b16 a[160:161], v252 offset:9280
    ds_read_b64_tr_b16 a[162:163], v252 offset:9664
    s_waitcnt lgkmcnt(6)
    s_add_u32 s33, s29, 3
    s_and_b32 s33, s33, 3
    s_mul_i32 s33, s33, 352256
    s_add_u32 m0, s91, 6144
    s_nop 0
    buffer_load_dwordx4 v249, s[24:27], s33 offen offset:0 lds
    buffer_load_dwordx4 v250, s[24:27], s33 offen offset:1024 lds
    buffer_load_dwordx4 v251, s[24:27], s33 offen offset:2048 lds
    s_waitcnt vmcnt(18)
    ds_read_b64_tr_b16 a[36:37], v252 offset:12288
    ds_read_b64_tr_b16 a[38:39], v252 offset:12672
    ds_read_b64_tr_b16 a[100:101], v252 offset:12320
    ds_read_b64_tr_b16 a[102:103], v252 offset:12704
    ds_read_b64_tr_b16 a[164:165], v252 offset:12352
    ds_read_b64_tr_b16 a[166:167], v252 offset:12736
    s_waitcnt lgkmcnt(6)
    s_add_u32 s33, s33, 88064
    s_add_u32 m0, s91, 9216
    s_nop 0
    buffer_load_dwordx4 v249, s[24:27], s33 offen offset:0 lds
    buffer_load_dwordx4 v250, s[24:27], s33 offen offset:1024 lds
    buffer_load_dwordx4 v251, s[24:27], s33 offen offset:2048 lds
    s_waitcnt vmcnt(9)
    s_mov_b32 s63, 524288
K1_X8:
    v_cmp_ne_u32 vcc, s92, v42
    s_nop 0
    s_and_b64 vcc, exec, vcc
    s_cbranch_vccz K1_X9
    buffer_load_dwordx2 v[42:43], v41, s[4:7], s87 offen sc1
    s_waitcnt vmcnt(0)
    s_sub_u32 s63, s63, 1
    s_cmp_lg_u32 s63, 0
    s_cbranch_scc1 K1_X8
K1_X9:
    v_cmp_ne_u32 vcc, s89, v43
    s_nop 0
    s_and_b64 vcc, exec, vcc
    s_cselect_b32 s36, 0, 1
    v_mov_b32 v32, s36
    v_mov_b32 v33, 149376
    ds_write_b32 v33, v32
    s_branch K1_X5
K1_X3:
    s_waitcnt vmcnt(12)
    ds_read_b64_tr_b16 a[0:1], v252 offset:0
    ds_read_b64_tr_b16 a[2:3], v252 offset:384
    ds_read_b64_tr_b16 a[64:65], v252 offset:32
    ds_read_b64_tr_b16 a[66:67], v252 offset:416
    ds_read_b64_tr_b16 a[128:129], v252 offset:64
    ds_read_b64_tr_b16 a[130:131], v252 offset:448
    ds_write_b128 v241, v[190:193] offset:32
    ds_write_b128 v241, v[194:197] offset:48
    v_cndmask_b32 v188, v188, v184, s[100:101]
    v_cndmask_b32 v189, v189, v184, s[100:101]
    v_alignbit_b32 v198, v190, v189, 16
    v_alignbit_b32 v199, v191, v190, 16
    v_alignbit_b32 v200, v192, v191, 16
    v_alignbit_b32 v201, v193, v192, 16
    v_alignbit_b32 v202, v194, v193, 16
    v_alignbit_b32 v203, v195, v194, 16
    v_alignbit_b32 v204, v196, v195, 16
    v_alignbit_b32 v205, v197, v196, 16
    ds_write_b128 v241, v[198:201] offset:4192
    ds_write_b128 v241, v[202:205] offset:4208
    v_mov_b32 v206, v189
    v_mov_b32 v207, v190
    v_mov_b32 v208, v191
    v_mov_b32 v209, v192
    v_mov_b32 v210, v193
    v_mov_b32 v211, v194
    v_mov_b32 v212, v195
    v_mov_b32 v213, v196
    ds_write_b128 v241, v[206:209] offset:8352
    ds_write_b128 v241, v[210:213] offset:8368
    v_alignbit_b32 v214, v189, v188, 16
    v_alignbit_b32 v215, v190, v189, 16
    v_alignbit_b32 v216, v191, v190, 16
    v_alignbit_b32 v217, v192, v191, 16
    v_alignbit_b32 v218, v193, v192, 16
    v_alignbit_b32 v219, v194, v193, 16
    v_alignbit_b32 v220, v195, v194, 16
    v_alignbit_b32 v221, v196, v195, 16
    ds_write_b128 v241, v[214:217] offset:12512
    ds_write_b128 v241, v[218:221] offset:12528
    s_waitcnt vmcnt(9)
    ds_read_b64_tr_b16 a[4:5], v252 offset:3072
    ds_read_b64_tr_b16 a[6:7], v252 offset:3456
    ds_read_b64_tr_b16 a[68:69], v252 offset:3104
    ds_read_b64_tr_b16 a[70:71], v252 offset:3488
    ds_read_b64_tr_b16 a[132:133], v252 offset:3136
    ds_read_b64_tr_b16 a[134:135], v252 offset:3520
    s_waitcnt lgkmcnt(14)
    s_add_u32 s33, s33, 88064
    s_add_u32 m0, s91, 0
    s_nop 0
    buffer_load_dwordx4 v249, s[24:27], s33 offen offset:0 lds
    buffer_load_dwordx4 v250, s[24:27], s33 offen offset:1024 lds
    buffer_load_dwordx4 v251, s[24:27], s33 offen offset:2048 lds
    s_waitcnt vmcnt(9)
    ds_read_b64_tr_b16 a[8:9], v252 offset:6144
    ds_read_b64_tr_b16 a[10:11], v252 offset:6528
    ds_read_b64_tr_b16 a[72:73], v252 offset:6176
    ds_read_b64_tr_b16 a[74:75], v252 offset:6560
    ds_read_b64_tr_b16 a[136:137], v252 offset:6208
    ds_read_b64_tr_b16 a[138:139], v252 offset:6592
    s_waitcnt lgkmcnt(6)
    s_add_u32 s33, s33, 88064
    s_add_u32 m0, s91, 3072
    s_nop 0
    buffer_load_dwordx4 v249, s[24:27], s33 offen offset:0 lds
    buffer_load_dwordx4 v250, s[24:27], s33 offen offset:1024 lds
    buffer_load_dwordx4 v251, s[24:27], s33 offen offset:2048 lds
    s_waitcnt vmcnt(9)
    ds_read_b64_tr_b16 a[12:13], v252 offset:9216
    ds_read_b64_tr_b16 a[14:15], v252 offset:9600
    ds_read_b64_tr_b16 a[76:77], v252 offset:9248
    ds_read_b64_tr_b16 a[78:79], v252 offset:9632
    ds_read_b64_tr_b16 a[140:141], v252 offset:9280
    ds_read_b64_tr_b16 a[142:143], v252 offset:9664
    s_waitcnt lgkmcnt(6)
    s_add_u32 s33, s33, 88064
    s_add_u32 m0, s91, 6144
    s_nop 0
    buffer_load_dwordx4 v249, s[24:27], s33 offen offset:0 lds
    buffer_load_dwordx4 v250, s[24:27], s33 offen offset:1024 lds
    buffer_load_dwordx4 v251, s[24:27], s33 offen offset:2048 lds
    s_waitcnt vmcnt(9)
    ds_read_b64_tr_b16 a[16:17], v252 offset:12288
    ds_read_b64_tr_b16 a[18:19], v252 offset:12672
    ds_read_b64_tr_b16 a[80:81], v252 offset:12320
    ds_read_b64_tr_b16 a[82:83], v252 offset:12704
    ds_read_b64_tr_b16 a[144:145], v252 offset:12352
    ds_read_b64_tr_b16 a[146:147], v252 offset:12736
    s_waitcnt lgkmcnt(6)
    s_add_u32 s33, s29, 2
    s_and_b32 s33, s33, 3
    s_mul_i32 s33, s33, 352256
    s_add_u32 m0, s91, 9216
    s_nop 0
    buffer_load_dwordx4 v249, s[24:27], s33 offen offset:0 lds
    buffer_load_dwordx4 v250, s[24:27], s33 offen offset:1024 lds
    buffer_load_dwordx4 v251, s[24:27], s33 offen offset:2048 lds
    s_waitcnt vmcnt(9)
    ds_read_b64_tr_b16 a[20:21], v252 offset:0
    ds_read_b64_tr_b16 a[22:23], v252 offset:384
    ds_read_b64_tr_b16 a[84:85], v252 offset:32
    ds_read_b64_tr_b16 a[86:87], v252 offset:416
    ds_read_b64_tr_b16 a[148:149], v252 offset:64
    ds_read_b64_tr_b16 a[150:151], v252 offset:448
    s_waitcnt lgkmcnt(6)
    s_add_u32 s33, s33, 88064
    s_add_u32 m0, s91, 12288
    s_nop 0
    buffer_load_dwordx4 v249, s[24:27], s33 offen offset:0 lds
    buffer_load_dwordx4 v250, s[24:27], s33 offen offset:1024 lds
    buffer_load_dwordx4 v251, s[24:27], s33 offen offset:2048 lds
    s_waitcnt vmcnt(9)
    ds_read_b64_tr_b16 a[24:25], v252 offset:3072
    ds_read_b64_tr_b16 a[26:27], v252 offset:3456
    ds_read_b64_tr_b16 a[88:89], v252 offset:3104
    ds_read_b64_tr_b16 a[90:91], v252 offset:3488
    ds_read_b64_tr_b16 a[152:153], v252 offset:3136
    ds_read_b64_tr_b16 a[154:155], v252 offset:3520
    s_waitcnt lgkmcnt(6)
    s_add_u32 s33, s33, 88064
    s_add_u32 m0, s91, 0
    s_nop 0
    buffer_load_dwordx4 v249, s[24:27], s33 offen offset:0 lds
    buffer_load_dwordx4 v250, s[24:27], s33 offen offset:1024 lds
    buffer_load_dwordx4 v251, s[24:27], s33 offen offset:2048 lds
    s_waitcnt vmcnt(9)
    ds_read_b64_tr_b16 a[28:29], v252 offset:6144
    ds_read_b64_tr_b16 a[30:31], v252 offset:6528
    ds_read_b64_tr_b16 a[92:93], v252 offset:6176
    ds_read_b64_tr_b16 a[94:95], v252 offset:6560
    ds_read_b64_tr_b16 a[156:157], v252 offset:6208
    ds_read_b64_tr_b16 a[158:159], v252 offset:6592
    s_waitcnt lgkmcnt(6)
    s_add_u32 s33, s33, 88064
    s_add_u32 m0, s91, 3072
    s_nop 0
    buffer_load_dwordx4 v249, s[24:27], s33 offen offset:0 lds
    buffer_load_dwordx4 v250, s[24:27], s33 offen offset:1024 lds
    buffer_load_dwordx4 v251, s[24:27], s33 offen offset:2048 lds
    s_waitcnt vmcnt(9)
    ds_read_b64_tr_b16 a[32:33], v252 offset:9216
    ds_read_b64_tr_b16 a[34:35], v252 offset:9600
    ds_read_b64_tr_b16 a[96:97], v252 offset:9248
    ds_read_b64_tr_b16 a[98:99], v252 offset:9632
    ds_read_b64_tr_b16 a[160:161], v252 offset:9280
    ds_read_b64_tr_b16 a[162:163], v252 offset:9664
    s_waitcnt lgkmcnt(6)
    s_add_u32 s33, s29, 3
    s_and_b32 s33, s33, 3
    s_mul_i32 s33, s33, 352256
    s_add_u32 m0, s91, 6144
    s_nop 0
    buffer_load_dwordx4 v249, s[24:27], s33 offen offset:0 lds
    buffer_load_dwordx4 v250, s[24:27], s33 offen offset:1024 lds
    buffer_load_dwordx4 v251, s[24:27], s33 offen offset:2048 lds
    s_waitcnt vmcnt(9)
    ds_read_b64_tr_b16 a[36:37], v252 offset:12288
    ds_read_b64_tr_b16 a[38:39], v252 offset:12672
    ds_read_b64_tr_b16 a[100:101], v252 offset:12320
    ds_read_b64_tr_b16 a[102:103], v252 offset:12704
    ds_read_b64_tr_b16 a[164:165], v252 offset:12352
    ds_read_b64_tr_b16 a[166:167], v252 offset:12736
    s_waitcnt lgkmcnt(6)
    s_add_u32 s33, s33, 88064
    s_add_u32 m0, s91, 9216
    s_nop 0
    buffer_load_dwordx4 v249, s[24:27], s33 offen offset:0 lds
    buffer_load_dwordx4 v250, s[24:27], s33 offen offset:1024 lds
    buffer_load_dwordx4 v251, s[24:27], s33 offen offset:2048 lds
K1_X5:
    s_waitcnt lgkmcnt(0)
    s_barrier
    ds_read_b64 v[204:205], v240 offset:0
    ds_read_b64 v[206:207], v240 offset:8
    ds_read_b128 v[80:83], v239 offset:192
    ds_read_b128 v[84:87], v239 offset:704
    ds_read_b128 v[88:91], v239 offset:1216
    ds_read_b128 v[92:95], v239 offset:1728
    ds_read_b128 v[96:99], v239 offset:2240
    ds_read_b128 v[100:103], v239 offset:2752
    ds_read_b128 v[104:107], v239 offset:3264
    ds_read_b128 v[108:111], v239 offset:3776
    ds_read_b64 v[208:209], v240 offset:512
    ds_read_b64 v[210:211], v240 offset:520
    ds_read_b64 v[212:213], v240 offset:1024
    ds_read_b64 v[214:215], v240 offset:1032
    ds_read_b64 v[216:217], v240 offset:1536
    ds_read_b64 v[218:219], v240 offset:1544
    s_waitcnt lgkmcnt(13)
    v_mfma_f32_16x16x32_bf16 v[48:51], v[204:207], v[80:83], 0
    ds_read_b64 v[220:221], v240 offset:2048
    s_waitcnt lgkmcnt(13)
    v_mfma_f32_16x16x32_bf16 v[52:55], v[204:207], v[84:87], 0
    ds_read_b64 v[222:223], v240 offset:2056
    s_waitcnt lgkmcnt(13)
    v_mfma_f32_16x16x32_bf16 v[56:59], v[204:207], v[88:91], 0
    ds_read_b128 v[112:115], v239 offset:128
    s_mul_i32 s36, s16, 360448
    s_mul_i32 s37, s28, 90112
    s_add_u32 s36, s36, s37
    v_add_u32 v19, s36, v253
    buffer_load_dwordx4 v[160:163], v19, s[96:99], 0 offen
    v_add_u32 v19, 8192, v19
    s_waitcnt lgkmcnt(13)
    v_mfma_f32_16x16x32_bf16 v[60:63], v[204:207], v[92:95], 0
    s_waitcnt lgkmcnt(12)
    v_mfma_f32_16x16x32_bf16 v[64:67], v[204:207], v[96:99], 0
    s_waitcnt lgkmcnt(11)
    v_mfma_f32_16x16x32_bf16 v[68:71], v[204:207], v[100:103], 0
    ds_read_b128 v[116:119], v239 offset:640
    s_waitcnt lgkmcnt(11)
    v_mfma_f32_16x16x32_bf16 v[72:75], v[204:207], v[104:107], 0
    s_waitcnt lgkmcnt(10)
    v_mfma_f32_16x16x32_bf16 v[76:79], v[204:207], v[108:111], 0
    s_waitcnt lgkmcnt(8)
    v_mfma_f32_16x16x32_bf16 v[52:55], v[208:211], v[80:83], v[52:55]
    ds_read_b64 v[224:225], v240 offset:2560
    ds_read_b128 v[120:123], v239 offset:1152
    v_mfma_f32_16x16x32_bf16 v[56:59], v[208:211], v[84:87], v[56:59]
    ds_read_b64 v[226:227], v240 offset:2568
    v_mfma_f32_16x16x32_bf16 v[60:63], v[208:211], v[88:91], v[60:63]
    v_mfma_f32_16x16x32_bf16 v[64:67], v[208:211], v[92:95], v[64:67]
    ds_read_b128 v[124:127], v239 offset:1664
    v_mfma_f32_16x16x32_bf16 v[68:71], v[208:211], v[96:99], v[68:71]
    v_mfma_f32_16x16x32_bf16 v[72:75], v[208:211], v[100:103], v[72:75]
    v_mfma_f32_16x16x32_bf16 v[76:79], v[208:211], v[104:107], v[76:79]
    ds_read_b128 v[128:131], v239 offset:2176
    buffer_load_dwordx4 v[160:163], v19, s[96:99], 0 offen
    v_add_u32 v19, 8192, v19
    s_waitcnt lgkmcnt(11)
    v_mfma_f32_16x16x32_bf16 v[56:59], v[212:215], v[80:83], v[56:59]
    ds_read_b64 v[228:229], v240 offset:3072
    v_mfma_f32_16x16x32_bf16 v[60:63], v[212:215], v[84:87], v[60:63]
    ds_read_b64 v[230:231], v240 offset:3080
    v_mfma_f32_16x16x32_bf16 v[64:67], v[212:215], v[88:91], v[64:67]
    ds_read_b128 v[132:135], v239 offset:2688
    v_mfma_f32_16x16x32_bf16 v[68:71], v[212:215], v[92:95], v[68:71]
    v_mfma_f32_16x16x32_bf16 v[72:75], v[212:215], v[96:99], v[72:75]
    v_mfma_f32_16x16x32_bf16 v[76:79], v[212:215], v[100:103], v[76:79]
    ds_read_b128 v[136:139], v239 offset:3200
    s_waitcnt lgkmcnt(13)
    v_mfma_f32_16x16x32_bf16 v[60:63], v[216:219], v[80:83], v[60:63]
    ds_read_b64 v[232:233], v240 offset:3584
    v_mfma_f32_16x16x32_bf16 v[64:67], v[216:219], v[84:87], v[64:67]
    ds_read_b64 v[234:235], v240 offset:3592
    v_mfma_f32_16x16x32_bf16 v[68:71], v[216:219], v[88:91], v[68:71]
    ds_read_b128 v[140:143], v239 offset:3712
    v_mfma_f32_16x16x32_bf16 v[72:75], v[216:219], v[92:95], v[72:75]
    v_mfma_f32_16x16x32_bf16 v[76:79], v[216:219], v[96:99], v[76:79]
    s_waitcnt lgkmcnt(14)
    v_mfma_f32_16x16x32_bf16 v[64:67], v[220:223], v[80:83], v[64:67]
    ds_read_b64 v[204:205], v240 offset:64
    v_mfma_f32_16x16x32_bf16 v[68:71], v[220:223], v[84:87], v[68:71]
    ds_read_b64 v[206:207], v240 offset:72
    buffer_load_dwordx4 v[160:163], v19, s[96:99], 0 offen
    v_add_u32 v19, 8192, v19
    v_mfma_f32_16x16x32_bf16 v[72:75], v[220:223], v[88:91], v[72:75]
    v_mfma_f32_16x16x32_bf16 v[76:79], v[220:223], v[92:95], v[76:79]
    s_waitcnt lgkmcnt(11)
    v_mfma_f32_16x16x32_bf16 v[68:71], v[224:227], v[80:83], v[68:71]
    ds_read_b64 v[208:209], v240 offset:576
    s_waitcnt vmcnt(12)
    v_mfma_f32_16x16x32_bf16 v[72:75], v[224:227], v[84:87], v[72:75]
    ds_read_b64 v[210:211], v240 offset:584
    ds_read_b64_tr_b16 a[40:41], v252 offset:0
    v_mfma_f32_16x16x32_bf16 v[76:79], v[224:227], v[88:91], v[76:79]
    s_waitcnt lgkmcnt(10)
    v_mfma_f32_16x16x32_bf16 v[72:75], v[228:231], v[80:83], v[72:75]
    ds_read_b64 v[212:213], v240 offset:1088
    ds_read_b64_tr_b16 a[42:43], v252 offset:384
    v_mfma_f32_16x16x32_bf16 v[76:79], v[228:231], v[84:87], v[76:79]
    ds_read_b64 v[214:215], v240 offset:1096
    s_waitcnt lgkmcnt(9)
    v_mfma_f32_16x16x32_bf16 v[76:79], v[232:235], v[80:83], v[76:79]
    ds_read_b64 v[216:217], v240 offset:1600
    ds_read_b64 v[218:219], v240 offset:1608
    ds_read_b64_tr_b16 a[104:105], v252 offset:32
    s_waitcnt lgkmcnt(9)
    v_mfma_f32_16x16x32_bf16 v[48:51], v[204:207], v[112:115], v[48:51]
    ds_read_b64 v[220:221], v240 offset:2112
    v_mfma_f32_16x16x32_bf16 v[52:55], v[204:207], v[116:119], v[52:55]
    ds_read_b64 v[222:223], v240 offset:2120
    ds_read_b64_tr_b16 a[106:107], v252 offset:416
    v_mfma_f32_16x16x32_bf16 v[56:59], v[204:207], v[120:123], v[56:59]
    ds_read_b128 v[80:83], v239 offset:64
    ds_read_b64_tr_b16 a[168:169], v252 offset:64
    v_mfma_f32_16x16x32_bf16 v[60:63], v[204:207], v[124:127], v[60:63]
    buffer_load_dwordx4 v[160:163], v19, s[96:99], 0 offen
    v_add_u32 v19, 8192, v19
    v_mfma_f32_16x16x32_bf16 v[64:67], v[204:207], v[128:131], v[64:67]
    ds_read_b64_tr_b16 a[170:171], v252 offset:448
    v_mfma_f32_16x16x32_bf16 v[68:71], v[204:207], v[132:135], v[68:71]
    ds_read_b128 v[84:87], v239 offset:576
    v_mfma_f32_16x16x32_bf16 v[72:75], v[204:207], v[136:139], v[72:75]
    v_mfma_f32_16x16x32_bf16 v[76:79], v[204:207], v[140:143], v[76:79]
    s_waitcnt lgkmcnt(14)
    v_mfma_f32_16x16x32_bf16 v[52:55], v[208:211], v[112:115], v[52:55]
    ds_read_b64 v[224:225], v240 offset:2624
    ds_read_b128 v[88:91], v239 offset:1088
    s_add_u32 s33, s33, 88064
    v_mfma_f32_16x16x32_bf16 v[56:59], v[208:211], v[116:119], v[56:59]
    ds_read_b64 v[226:227], v240 offset:2632
    s_add_u32 m0, s91, 12288
    v_mfma_f32_16x16x32_bf16 v[60:63], v[208:211], v[120:123], v[60:63]
    v_mfma_f32_16x16x32_bf16 v[64:67], v[208:211], v[124:127], v[64:67]
    ds_read_b128 v[92:95], v239 offset:1600
    buffer_load_dwordx4 v249, s[24:27], s33 offen offset:0 lds
    v_mfma_f32_16x16x32_bf16 v[68:71], v[208:211], v[128:131], v[68:71]
    v_mfma_f32_16x16x32_bf16 v[72:75], v[208:211], v[132:135], v[72:75]
    buffer_load_dwordx4 v250, s[24:27], s33 offen offset:1024 lds
    v_mfma_f32_16x16x32_bf16 v[76:79], v[208:211], v[136:139], v[76:79]
    ds_read_b128 v[96:99], v239 offset:2112
    s_waitcnt lgkmcnt(15)
    v_mfma_f32_16x16x32_bf16 v[56:59], v[212:215], v[112:115], v[56:59]
    ds_read_b64 v[228:229], v240 offset:3136
    buffer_load_dwordx4 v251, s[24:27], s33 offen offset:2048 lds
    v_mfma_f32_16x16x32_bf16 v[60:63], v[212:215], v[116:119], v[60:63]
    ds_read_b64 v[230:231], v240 offset:3144
    s_waitcnt vmcnt(13)
    buffer_load_dwordx4 v[160:163], v19, s[96:99], 0 offen
    v_add_u32 v19, 8192, v19
    v_mfma_f32_16x16x32_bf16 v[64:67], v[212:215], v[120:123], v[64:67]
    ds_read_b128 v[100:103], v239 offset:2624
    v_mfma_f32_16x16x32_bf16 v[68:71], v[212:215], v[124:127], v[68:71]
    ds_read_b64_tr_b16 a[44:45], v252 offset:3072
    v_mfma_f32_16x16x32_bf16 v[72:75], v[212:215], v[128:131], v[72:75]
    v_mfma_f32_16x16x32_bf16 v[76:79], v[212:215], v[132:135], v[76:79]
    ds_read_b128 v[104:107], v239 offset:3136
    ds_read_b64_tr_b16 a[46:47], v252 offset:3456
    s_waitcnt lgkmcnt(15)
    v_mfma_f32_16x16x32_bf16 v[60:63], v[216:219], v[112:115], v[60:63]
    ds_read_b64 v[232:233], v240 offset:3648
    v_mfma_f32_16x16x32_bf16 v[64:67], v[216:219], v[116:119], v[64:67]
    ds_read_b64 v[234:235], v240 offset:3656
    ds_read_b64_tr_b16 a[108:109], v252 offset:3104
    v_mfma_f32_16x16x32_bf16 v[68:71], v[216:219], v[120:123], v[68:71]
    ds_read_b128 v[108:111], v239 offset:3648
    ds_read_b64_tr_b16 a[110:111], v252 offset:3488
    v_mfma_f32_16x16x32_bf16 v[72:75], v[216:219], v[124:127], v[72:75]
    s_add_u32 s35, s43, 32768
    buffer_load_dwordx4 v[24:27], v7, s[20:23], s43 offen
    buffer_load_dwordx4 v[28:31], v7, s[20:23], s35 offen
    v_mfma_f32_16x16x32_bf16 v[76:79], v[216:219], v[128:131], v[76:79]
    ds_read_b64_tr_b16 a[172:173], v252 offset:3136
    s_waitcnt lgkmcnt(15)
    v_mfma_f32_16x16x32_bf16 v[64:67], v[220:223], v[112:115], v[64:67]
    ds_read_b64 v[204:205], v240 offset:128
    v_mfma_f32_16x16x32_bf16 v[68:71], v[220:223], v[116:119], v[68:71]
    ds_read_b64 v[206:207], v240 offset:136
    ds_read_b64_tr_b16 a[174:175], v252 offset:3520
    v_mfma_f32_16x16x32_bf16 v[72:75], v[220:223], v[120:123], v[72:75]
    buffer_load_dwordx4 v[160:163], v19, s[96:99], 0 offen
    v_add_u32 v19, 8192, v19
    v_mfma_f32_16x16x32_bf16 v[76:79], v[220:223], v[124:127], v[76:79]
    s_waitcnt lgkmcnt(15)
    s_waitcnt lgkmcnt(15)
    v_mfma_f32_16x16x32_bf16 v[68:71], v[224:227], v[112:115], v[68:71]
    ds_read_b64 v[208:209], v240 offset:640
    s_add_u32 s33, s33, 88064
    v_mfma_f32_16x16x32_bf16 v[72:75], v[224:227], v[116:119], v[72:75]
    ds_read_b64 v[210:211], v240 offset:648
    v_mfma_f32_16x16x32_bf16 v[76:79], v[224:227], v[120:123], v[76:79]
    s_add_u32 m0, s91, 0
    s_waitcnt lgkmcnt(15)
    v_mfma_f32_16x16x32_bf16 v[72:75], v[228:231], v[112:115], v[72:75]
    ds_read_b64 v[212:213], v240 offset:1152
    v_mfma_f32_16x16x32_bf16 v[76:79], v[228:231], v[116:119], v[76:79]
    ds_read_b64 v[214:215], v240 offset:1160
    buffer_load_dwordx4 v249, s[24:27], s33 offen offset:0 lds
    s_waitcnt lgkmcnt(11)
    v_mfma_f32_16x16x32_bf16 v[76:79], v[232:235], v[112:115], v[76:79]
    ds_read_b64 v[216:217], v240 offset:1664
    ds_read_b64 v[218:219], v240 offset:1672
    s_waitcnt lgkmcnt(7)
    v_mfma_f32_16x16x32_bf16 v[48:51], v[204:207], v[80:83], v[48:51]
    ds_read_b64 v[220:221], v240 offset:2176
    buffer_load_dwordx4 v250, s[24:27], s33 offen offset:1024 lds
    v_mfma_f32_16x16x32_bf16 v[52:55], v[204:207], v[84:87], v[52:55]
    ds_read_b64 v[222:223], v240 offset:2184
    buffer_load_dwordx4 v251, s[24:27], s33 offen offset:2048 lds
    v_mfma_f32_16x16x32_bf16 v[56:59], v[204:207], v[88:91], v[56:59]
    ds_read_b128 v[112:115], v239 offset:0
    v_mfma_f32_16x16x32_bf16 v[60:63], v[204:207], v[92:95], v[60:63]
    s_waitcnt vmcnt(17)
    v_mfma_f32_16x16x32_bf16 v[64:67], v[204:207], v[96:99], v[64:67]
    v_mfma_f32_16x16x32_bf16 v[68:71], v[204:207], v[100:103], v[68:71]
    ds_read_b128 v[116:119], v239 offset:512
    ds_read_b64_tr_b16 a[48:49], v252 offset:6144
    buffer_load_dwordx4 v[160:163], v19, s[96:99], 0 offen
    v_add_u32 v19, 8192, v19
    v_mfma_f32_16x16x32_bf16 v[72:75], v[204:207], v[104:107], v[72:75]
    v_mfma_f32_16x16x32_bf16 v[76:79], v[204:207], v[108:111], v[76:79]
    ds_read_b64_tr_b16 a[50:51], v252 offset:6528
    s_waitcnt lgkmcnt(10)
    v_mfma_f32_16x16x32_bf16 v[52:55], v[208:211], v[80:83], v[52:55]
    ds_read_b64 v[224:225], v240 offset:2688
    ds_read_b128 v[120:123], v239 offset:1024
    ds_read_b64_tr_b16 a[112:113], v252 offset:6176
    v_mfma_f32_16x16x32_bf16 v[56:59], v[208:211], v[84:87], v[56:59]
    ds_read_b64 v[226:227], v240 offset:2696
    v_mfma_f32_16x16x32_bf16 v[60:63], v[208:211], v[88:91], v[60:63]
    ds_read_b64_tr_b16 a[114:115], v252 offset:6560
    v_mfma_f32_16x16x32_bf16 v[64:67], v[208:211], v[92:95], v[64:67]
    ds_read_b128 v[124:127], v239 offset:1536
    v_mfma_f32_16x16x32_bf16 v[68:71], v[208:211], v[96:99], v[68:71]
    ds_read_b64_tr_b16 a[176:177], v252 offset:6208
    v_mfma_f32_16x16x32_bf16 v[72:75], v[208:211], v[100:103], v[72:75]
    v_mfma_f32_16x16x32_bf16 v[76:79], v[208:211], v[104:107], v[76:79]
    ds_read_b128 v[128:131], v239 offset:2048
    ds_read_b64_tr_b16 a[178:179], v252 offset:6592
    s_waitcnt lgkmcnt(15)
    v_mfma_f32_16x16x32_bf16 v[56:59], v[212:215], v[80:83], v[56:59]
    ds_read_b64 v[228:229], v240 offset:3200
    s_waitcnt vmcnt(15)
    v_mfma_f32_16x16x32_bf16 v[60:63], v[212:215], v[84:87], v[60:63]
    ds_read_b64 v[230:231], v240 offset:3208
    v_mfma_f32_16x16x32_bf16 v[64:67], v[212:215], v[88:91], v[64:67]
    ds_read_b128 v[132:135], v239 offset:2560
    ds_read_b64_tr_b16 a[52:53], v252 offset:9216
    buffer_load_dwordx4 v[160:163], v19, s[96:99], 0 offen
    v_add_u32 v19, 8192, v19
    v_mfma_f32_16x16x32_bf16 v[68:71], v[212:215], v[92:95], v[68:71]
    v_mfma_f32_16x16x32_bf16 v[72:75], v[212:215], v[96:99], v[72:75]
    ds_read_b64_tr_b16 a[54:55], v252 offset:9600
    v_mfma_f32_16x16x32_bf16 v[76:79], v[212:215], v[100:103], v[76:79]
    ds_read_b128 v[136:139], v239 offset:3072
    s_waitcnt lgkmcnt(15)
    v_mfma_f32_16x16x32_bf16 v[60:63], v[216:219], v[80:83], v[60:63]
    ds_read_b64 v[232:233], v240 offset:3712
    ds_read_b64_tr_b16 a[116:117], v252 offset:9248
    v_mfma_f32_16x16x32_bf16 v[64:67], v[216:219], v[84:87], v[64:67]
    ds_read_b64 v[234:235], v240 offset:3720
    ds_read_b64_tr_b16 a[118:119], v252 offset:9632
    v_mfma_f32_16x16x32_bf16 v[68:71], v[216:219], v[88:91], v[68:71]
    ds_read_b128 v[140:143], v239 offset:3584
    v_mfma_f32_16x16x32_bf16 v[72:75], v[216:219], v[92:95], v[72:75]
    ds_read_b64_tr_b16 a[180:181], v252 offset:9280
    v_mfma_f32_16x16x32_bf16 v[76:79], v[216:219], v[96:99], v[76:79]
    s_waitcnt lgkmcnt(15)
    v_mfma_f32_16x16x32_bf16 v[64:67], v[220:223], v[80:83], v[64:67]
    ds_read_b64 v[204:205], v240 offset:192
    ds_read_b64_tr_b16 a[182:183], v252 offset:9664
    v_mfma_f32_16x16x32_bf16 v[68:71], v[220:223], v[84:87], v[68:71]
    ds_read_b64 v[206:207], v240 offset:200
    v_mfma_f32_16x16x32_bf16 v[72:75], v[220:223], v[88:91], v[72:75]
    v_mfma_f32_16x16x32_bf16 v[76:79], v[220:223], v[92:95], v[76:79]
    s_waitcnt lgkmcnt(15)
    v_mfma_f32_16x16x32_bf16 v[68:71], v[224:227], v[80:83], v[68:71]
    ds_read_b64 v[208:209], v240 offset:704
    buffer_load_dwordx4 v[160:163], v19, s[96:99], 0 offen
    v_add_u32 v19, 8192, v19
    v_mfma_f32_16x16x32_bf16 v[72:75], v[224:227], v[84:87], v[72:75]
    ds_read_b64 v[210:211], v240 offset:712
    v_mfma_f32_16x16x32_bf16 v[76:79], v[224:227], v[88:91], v[76:79]
    s_waitcnt lgkmcnt(15)
    v_mfma_f32_16x16x32_bf16 v[72:75], v[228:231], v[80:83], v[72:75]
    ds_read_b64 v[212:213], v240 offset:1216
    v_mfma_f32_16x16x32_bf16 v[76:79], v[228:231], v[84:87], v[76:79]
    ds_read_b64 v[214:215], v240 offset:1224
    s_waitcnt lgkmcnt(10)
    v_mfma_f32_16x16x32_bf16 v[76:79], v[232:235], v[80:83], v[76:79]
    ds_read_b64 v[216:217], v240 offset:1728
    ds_read_b64 v[218:219], v240 offset:1736
    s_waitcnt lgkmcnt(6)
    v_mfma_f32_16x16x32_bf16 v[48:51], v[204:207], v[112:115], v[48:51]
    ds_read_b64 v[220:221], v240 offset:2240
    v_mfma_f32_16x16x32_bf16 v[52:55], v[204:207], v[116:119], v[52:55]
    ds_read_b64 v[222:223], v240 offset:2248
    v_mfma_f32_16x16x32_bf16 v[56:59], v[204:207], v[120:123], v[56:59]
    ds_read_b64 v[96:97], v246 offset:0
    v_mfma_f32_16x16x32_bf16 v[60:63], v[204:207], v[124:127], v[60:63]
    v_mfma_f32_16x16x32_bf16 v[64:67], v[204:207], v[128:131], v[64:67]
    ds_read_b64 v[98:99], v246 offset:512
    v_mfma_f32_16x16x32_bf16 v[68:71], v[204:207], v[132:135], v[68:71]
    v_mfma_f32_16x16x32_bf16 v[72:75], v[204:207], v[136:139], v[72:75]
    ds_read_b64 v[100:101], v246 offset:1024
    buffer_load_dwordx4 v[160:163], v19, s[96:99], 0 offen
    v_add_u32 v19, 8192, v19
    v_mfma_f32_16x16x32_bf16 v[76:79], v[204:207], v[140:143], v[76:79]
    s_waitcnt lgkmcnt(9)
    v_mfma_f32_16x16x32_bf16 v[52:55], v[208:211], v[112:115], v[52:55]
    ds_read_b64 v[224:225], v240 offset:2752
    ds_read_b64 v[102:103], v246 offset:1536
    v_mfma_f32_16x16x32_bf16 v[56:59], v[208:211], v[116:119], v[56:59]
    ds_read_b64 v[226:227], v240 offset:2760
    v_mfma_f32_16x16x32_bf16 v[60:63], v[208:211], v[120:123], v[60:63]
    v_mfma_f32_16x16x32_bf16 v[64:67], v[208:211], v[124:127], v[64:67]
    v_mfma_f32_16x16x32_bf16 v[68:71], v[208:211], v[128:131], v[68:71]
    v_mfma_f32_16x16x32_bf16 v[72:75], v[208:211], v[132:135], v[72:75]
    v_mfma_f32_16x16x32_bf16 v[76:79], v[208:211], v[136:139], v[76:79]
    v_lshlrev_b32 v46, 16, v46
    s_waitcnt lgkmcnt(5)
    v_and_b32_e64 v80, s56, v97
    v_mfma_f32_16x16x32_bf16 v[56:59], v[212:215], v[112:115], v[56:59]
    ds_read_b64 v[228:229], v240 offset:3264
    v_lshlrev_b32 v81, 16, v97
    v_and_b32 v82, s56, v96
    v_mfma_f32_16x16x32_bf16 v[60:63], v[212:215], v[116:119], v[60:63]
    ds_read_b64 v[230:231], v240 offset:3272
    v_lshlrev_b32_e64 v83, 16, v96
    v_mfma_f32_16x16x32_bf16 v[64:67], v[212:215], v[120:123], v[64:67]
    s_waitcnt lgkmcnt(6)
    v_and_b32 v84, s56, v99
    v_lshlrev_b32_e64 v85, 16, v99
    v_mfma_f32_16x16x32_bf16 v[68:71], v[212:215], v[124:127], v[68:71]
    v_and_b32_e64 v86, s56, v98
    v_mfma_f32_16x16x32_bf16 v[72:75], v[212:215], v[128:131], v[72:75]
    v_lshlrev_b32 v87, 16, v98
    s_waitcnt lgkmcnt(5)
    v_and_b32_e64 v88, s56, v101
    buffer_load_dwordx4 v[160:163], v19, s[96:99], 0 offen
    v_add_u32 v19, 8192, v19
    v_mfma_f32_16x16x32_bf16 v[76:79], v[212:215], v[132:135], v[76:79]
    v_lshlrev_b32_e64 v89, 16, v101
    v_mfma_f32_16x16x32_bf16 v[60:63], v[216:219], v[112:115], v[60:63]
    ds_read_b64 v[232:233], v240 offset:3776
    v_and_b32 v90, s56, v100
    v_lshlrev_b32 v91, 16, v100
    v_mfma_f32_16x16x32_bf16 v[64:67], v[216:219], v[116:119], v[64:67]
    ds_read_b64 v[234:235], v240 offset:3784
    s_waitcnt lgkmcnt(5)
    v_and_b32 v92, s56, v103
    v_lshlrev_b32_e64 v93, 16, v103
    v_mfma_f32_16x16x32_bf16 v[68:71], v[216:219], v[120:123], v[68:71]
    v_and_b32_e64 v94, s56, v102
    v_mfma_f32_16x16x32_bf16 v[72:75], v[216:219], v[124:127], v[72:75]
    v_lshlrev_b32 v95, 16, v102
    v_mul_f32 v80, v80, v46
    v_mfma_f32_16x16x32_bf16 v[76:79], v[216:219], v[128:131], v[76:79]
    v_mul_f32_e64 v81, v81, v46
    v_mfma_f32_16x16x32_bf16 v[64:67], v[220:223], v[112:115], v[64:67]
    v_mul_f32 v82, v82, v46
    v_mul_f32 v83, v83, v46
    v_mfma_f32_16x16x32_bf16 v[68:71], v[220:223], v[116:119], v[68:71]
    v_mul_f32_e64 v84, v84, v46
    v_mfma_f32_16x16x32_bf16 v[72:75], v[220:223], v[120:123], v[72:75]
    v_mul_f32 v85, v85, v46
    v_mul_f32 v86, v86, v46
    v_mfma_f32_16x16x32_bf16 v[76:79], v[220:223], v[124:127], v[76:79]
    v_mul_f32 v87, v87, v46
    v_mul_f32_e64 v88, v88, v46
    s_waitcnt lgkmcnt(4)
    v_mfma_f32_16x16x32_bf16 v[68:71], v[224:227], v[112:115], v[68:71]
    v_mul_f32_e64 v89, v89, v46
    v_mfma_f32_16x16x32_bf16 v[72:75], v[224:227], v[116:119], v[72:75]
    v_mul_f32 v90, v90, v46
    v_mul_f32 v91, v91, v46
    v_mfma_f32_16x16x32_bf16 v[76:79], v[224:227], v[120:123], v[76:79]
    v_mul_f32 v92, v92, v46
    s_waitcnt lgkmcnt(2)
    v_mfma_f32_16x16x32_bf16 v[72:75], v[228:231], v[112:115], v[72:75]
    v_mul_f32 v93, v93, v46
    v_mul_f32 v94, v94, v46
    v_mfma_f32_16x16x32_bf16 v[76:79], v[228:231], v[116:119], v[76:79]
    v_mul_f32 v95, v95, v46
    s_waitcnt lgkmcnt(0)
    v_mfma_f32_16x16x32_bf16 v[76:79], v[232:235], v[112:115], v[76:79]
    s_nop 6
    s_cmp_eq_u32 s19, 0
    s_cbranch_scc0 K1_R10
    ds_write_b128 v244, v[64:67] offset:0
    ds_write_b128 v244, v[68:71] offset:1024
    ds_write_b128 v244, v[72:75] offset:2048
    ds_write_b128 v244, v[76:79] offset:3072
    v_pk_add_f32 v[80:81], v[80:81], v[48:49]
    v_pk_add_f32 v[82:83], v[82:83], v[50:51]
    v_pk_add_f32 v[84:85], v[84:85], v[52:53]
    v_pk_add_f32 v[86:87], v[86:87], v[54:55]
    v_pk_add_f32 v[88:89], v[88:89], v[56:57]
    v_pk_add_f32 v[90:91], v[90:91], v[58:59]
    v_pk_add_f32 v[92:93], v[92:93], v[60:61]
    v_pk_add_f32 v[94:95], v[94:95], v[62:63]
    s_branch K1_R11
K1_R10:
    ds_write_b128 v244, v[48:51] offset:0
    ds_write_b128 v244, v[52:55] offset:1024
    ds_write_b128 v244, v[56:59] offset:2048
    ds_write_b128 v244, v[60:63] offset:3072
    v_pk_add_f32 v[80:81], v[80:81], v[64:65]
    v_pk_add_f32 v[82:83], v[82:83], v[66:67]
    v_pk_add_f32 v[84:85], v[84:85], v[68:69]
    v_pk_add_f32 v[86:87], v[86:87], v[70:71]
    v_pk_add_f32 v[88:89], v[88:89], v[72:73]
    v_pk_add_f32 v[90:91], v[90:91], v[74:75]
    v_pk_add_f32 v[92:93], v[92:93], v[76:77]
    v_pk_add_f32 v[94:95], v[94:95], v[78:79]
K1_R11:
    s_waitcnt lgkmcnt(0)
    s_barrier
    ds_read_b128 v[112:115], v245 offset:0
    ds_read_b128 v[116:119], v245 offset:1024
    ds_read_b128 v[120:123], v245 offset:2048
    ds_read_b128 v[124:127], v245 offset:3072
    s_add_u32 s32, s90, 1572864
    s_waitcnt lgkmcnt(3)
    v_pk_add_f32 v[80:81], v[80:81], v[112:113]
    v_pk_add_f32 v[82:83], v[82:83], v[114:115]
    s_waitcnt lgkmcnt(2)
    v_pk_add_f32 v[84:85], v[84:85], v[116:117]
    v_pk_add_f32 v[86:87], v[86:87], v[118:119]
    v_cvt_pk_bf16_f32 v32, v80, v81
    v_cvt_pk_bf16_f32 v33, v82, v83
    v_cvt_pk_bf16_f32 v34, v84, v85
    v_cvt_pk_bf16_f32 v35, v86, v87
    s_nop 0
    v_permlane16_swap_b32 v32, v34
    v_permlane16_swap_b32_e64 v33, v35
    buffer_store_dwordx4 v[32:35], v247, s[4:7], s90 offen sc1
    s_waitcnt lgkmcnt(1)
    v_pk_add_f32 v[88:89], v[88:89], v[120:121]
    v_pk_add_f32 v[90:91], v[90:91], v[122:123]
    s_waitcnt lgkmcnt(0)
    v_pk_add_f32 v[92:93], v[92:93], v[124:125]
    v_pk_add_f32 v[94:95], v[94:95], v[126:127]
    v_cvt_pk_bf16_f32 v36, v88, v89
    v_cvt_pk_bf16_f32 v37, v90, v91
    v_cvt_pk_bf16_f32 v38, v92, v93
    v_cvt_pk_bf16_f32 v39, v94, v95
    s_nop 0
    v_permlane16_swap_b32 v36, v38
    v_permlane16_swap_b32_e64 v37, v39
    buffer_store_dwordx4 v[36:39], v247, s[4:7], s32 offen sc1
    s_nop 1
    v_mov_b32_e64 v39, v248
    s_waitcnt vmcnt(12)
    v_dot2_f32_bf16 v40, v24, s57, 0
    v_dot2_f32_bf16 v41, v24, v24, 0
    s_waitcnt vmcnt(11)
    v_dot2_f32_bf16 v42, v28, s57, 0
    v_dot2_f32_bf16 v43, v28, v28, 0
    v_dot2_f32_bf16 v40, v25, s57, v40
    v_dot2_f32_bf16 v41, v25, v25, v41
    v_dot2_f32_bf16 v42, v29, s57, v42
    v_dot2_f32_bf16 v43, v29, v29, v43
    v_dot2_f32_bf16 v40, v26, s57, v40
    v_dot2_f32_bf16 v41, v26, v26, v41
    v_dot2_f32_bf16 v42, v30, s57, v42
    v_dot2_f32_bf16 v43, v30, v30, v43
    v_dot2_f32_bf16 v40, v27, s57, v40
    v_dot2_f32_bf16 v41, v27, v27, v41
    v_dot2_f32_bf16 v42, v31, s57, v42
    v_dot2_f32_bf16 v43, v31, v31, v43
    v_add_f32_dpp v40, v40, v40 quad_perm:[1,0,3,2] row_mask:0xf bank_mask:0xf
    s_nop 0
    v_add_f32_dpp v42, v42, v42 quad_perm:[1,0,3,2] row_mask:0xf bank_mask:0xf
    v_add_f32_dpp v41, v41, v41 quad_perm:[1,0,3,2] row_mask:0xf bank_mask:0xf
    v_add_f32_dpp v43, v43, v43 quad_perm:[1,0,3,2] row_mask:0xf bank_mask:0xf
    v_add_f32_dpp v40, v40, v40 quad_perm:[2,3,0,1] row_mask:0xf bank_mask:0xf
    v_add_f32_dpp v42, v42, v42 quad_perm:[2,3,0,1] row_mask:0xf bank_mask:0xf
    v_add_f32_dpp v41, v41, v41 quad_perm:[2,3,0,1] row_mask:0xf bank_mask:0xf
    v_add_f32_dpp v43, v43, v43 quad_perm:[2,3,0,1] row_mask:0xf bank_mask:0xf
    v_add_f32_dpp v40, v40, v40 row_half_mirror row_mask:0xf bank_mask:0xf
    v_add_f32_dpp v42, v42, v42 row_half_mirror row_mask:0xf bank_mask:0xf
    v_add_f32_dpp v41, v41, v41 row_half_mirror row_mask:0xf bank_mask:0xf
    v_add_f32_dpp v43, v43, v43 row_half_mirror row_mask:0xf bank_mask:0xf
    s_mov_b32 exec_lo, 0x01010101
    s_mov_b32 exec_hi, 0x01010101
    buffer_store_dwordx2 v[40:41], v5, s[4:7], s44 offen offset:0 sc1
    buffer_store_dwordx2 v[42:43], v5, s[4:7], s44 offen offset:2048 sc1
    s_mov_b64 exec, -1
    s_waitcnt vmcnt(2)
    s_barrier
    s_cmp_eq_u32 s16, 0
    s_cbranch_scc0 K1_F12
    s_add_u32 s35, s93, 0x130e000
    v_mov_b32_e64 v14, s92
    s_mov_b64 exec, 1
    buffer_store_dword v14, v8, s[4:7], s35 offen sc1
    s_mov_b64 exec, -1
K1_F12:
    v_mov_b32 v60, s57
    v_mov_b32 v61, s57
    v_mov_b32 v62, s57
    v_mov_b32 v63, s57
    v_add_u32 v18, s3, v253
    s_add_u32 m0, s91, 3072
    v_add_u32 v19, 7168, v18
    buffer_load_dwordx4 v18, s[96:99], 0 offen lds
    buffer_load_dwordx4 v19, s[96:99], 0 offen offset:1024 lds
    s_add_u32 s3, s3, 16384
    s_cmp_eq_u32 s3, s95
    s_cselect_b32 s39, 360448, 0
    s_sub_u32 s3, s3, s39
    v_add_u32_e64 v18, s3, v253
    s_add_u32 m0, s91, 5120
    v_add_u32 v19, 7168, v18
    buffer_load_dwordx4 v18, s[96:99], 0 offen lds
    buffer_load_dwordx4 v19, s[96:99], 0 offen offset:1024 lds
    s_add_u32 s3, s3, 16384
    s_cmp_eq_u32 s3, s95
    s_cselect_b32 s39, 360448, 0
    s_sub_u32 s3, s3, s39
    v_add_u32_e64 v18, s3, v253
    s_add_u32 m0, s91, 7168
    v_add_u32 v19, 7168, v18
    buffer_load_dwordx4 v18, s[96:99], 0 offen lds
    buffer_load_dwordx4 v19, s[96:99], 0 offen offset:1024 lds
    s_add_u32 s3, s3, 16384
    s_cmp_eq_u32 s3, s95
    s_cselect_b32 s39, 360448, 0
    s_sub_u32 s3, s3, s39
    v_add_u32_e64 v18, s3, v253
    s_add_u32 m0, s91, 9216
    v_add_u32 v19, 7168, v18
    buffer_load_dwordx4 v18, s[96:99], 0 offen lds
    buffer_load_dwordx4 v19, s[96:99], 0 offen offset:1024 lds
    s_cmp_eq_u32 s16, 3
    s_cbranch_scc0 K1_X13
    ds_read_b64_tr_b16 a[56:57], v252 offset:12288
    ds_read_b64_tr_b16 a[58:59], v252 offset:12672
    ds_read_b64_tr_b16 a[120:121], v252 offset:12320
    ds_read_b64_tr_b16 a[122:123], v252 offset:12704
    ds_read_b64_tr_b16 a[184:185], v252 offset:12352
    ds_read_b64_tr_b16 a[186:187], v252 offset:12736
    ds_read_b64_tr_b16 a[60:61], v252 offset:0
    ds_read_b64_tr_b16 a[62:63], v252 offset:384
    ds_read_b64_tr_b16 a[124:125], v252 offset:32
    ds_read_b64_tr_b16 a[126:127], v252 offset:416
    ds_read_b64_tr_b16 a[188:189], v252 offset:64
    ds_read_b64_tr_b16 a[190:191], v252 offset:448
    s_waitcnt lgkmcnt(6)
    s_add_u32 s3, s3, 16384
    s_cmp_eq_u32 s3, s95
    s_cselect_b32 s39, 360448, 0
    s_sub_u32 s3, s3, s39
    v_add_u32 v18, s3, v253
    s_add_u32 m0, s91, 11264
    v_add_u32 v19, 7168, v18
    buffer_load_dwordx4 v18, s[96:99], 0 offen lds
    buffer_load_dwordx4 v19, s[96:99], 0 offen offset:1024 lds
    s_add_u32 s3, s3, 16384
    s_cmp_eq_u32 s3, s95
    s_cselect_b32 s39, 360448, 0
    s_sub_u32 s3, s3, s39
    v_add_u32_e64 v18, s3, v253
    s_add_u32 m0, s91, 13312
    v_add_u32 v19, 7168, v18
    buffer_load_dwordx4 v18, s[96:99], 0 offen lds
    buffer_load_dwordx4 v19, s[96:99], 0 offen offset:1024 lds
    s_waitcnt vmcnt(10)
    ds_read_b64_tr_b16 a[192:193], v17 offset:3072
    ds_read_b64_tr_b16 a[194:195], v17 offset:4096
    ds_read_b64_tr_b16 a[196:197], v17 offset:3136
    ds_read_b64_tr_b16 a[198:199], v17 offset:4160
    s_waitcnt lgkmcnt(4)
    s_add_u32 s3, s3, 16384
    s_cmp_eq_u32 s3, s95
    s_cselect_b32 s39, 360448, 0
    s_sub_u32 s3, s3, s39
    v_add_u32 v18, s3, v253
    s_add_u32 m0, s91, 0
    v_add_u32 v19, 7168, v18
    buffer_load_dwordx4 v18, s[96:99], 0 offen lds
    buffer_load_dwordx4 v19, s[96:99], 0 offen offset:1024 lds
    v_mfma_f32_16x16x32_bf16 v[48:51], a[0:3], v[60:63], 0
    v_mfma_f32_16x16x32_bf16 v[52:55], a[64:67], v[60:63], 0
    v_mfma_f32_16x16x32_bf16 v[56:59], a[128:131], v[60:63], 0
    v_mfma_f32_16x16x32_bf16 v[48:51], a[4:7], v[60:63], v[48:51]
    v_mfma_f32_16x16x32_bf16 v[52:55], a[68:71], v[60:63], v[52:55]
    v_mfma_f32_16x16x32_bf16 v[56:59], a[132:135], v[60:63], v[56:59]
    s_waitcnt vmcnt(10)
    ds_read_b64_tr_b16 a[200:201], v17 offset:5120
    ds_read_b64_tr_b16 a[202:203], v17 offset:6144
    ds_read_b64_tr_b16 a[204:205], v17 offset:5184
    ds_read_b64_tr_b16 a[206:207], v17 offset:6208
    s_waitcnt lgkmcnt(4)
    s_add_u32 s3, s3, 16384
    s_cmp_eq_u32 s3, s95
    s_cselect_b32 s39, 360448, 0
    s_sub_u32 s3, s3, s39
    v_add_u32_e64 v18, s3, v253
    s_add_u32 m0, s91, 3072
    v_add_u32 v19, 7168, v18
    buffer_load_dwordx4 v18, s[96:99], 0 offen lds
    buffer_load_dwordx4 v19, s[96:99], 0 offen offset:1024 lds
    v_mfma_f32_16x16x32_bf16 v[48:51], a[8:11], v[60:63], v[48:51]
    v_mfma_f32_16x16x32_bf16 v[52:55], a[72:75], v[60:63], v[52:55]
    v_mfma_f32_16x16x32_bf16 v[56:59], a[136:139], v[60:63], v[56:59]
    v_mfma_f32_16x16x32_bf16 v[48:51], a[12:15], v[60:63], v[48:51]
    v_mfma_f32_16x16x32_bf16 v[52:55], a[76:79], v[60:63], v[52:55]
    v_mfma_f32_16x16x32_bf16 v[56:59], a[140:143], v[60:63], v[56:59]
    s_waitcnt vmcnt(10)
    ds_read_b64_tr_b16 a[208:209], v17 offset:7168
    ds_read_b64_tr_b16 a[210:211], v17 offset:8192
    ds_read_b64_tr_b16 a[212:213], v17 offset:7232
    ds_read_b64_tr_b16 a[214:215], v17 offset:8256
    s_waitcnt lgkmcnt(4)
    s_add_u32 s3, s3, 16384
    s_cmp_eq_u32 s3, s95
    s_cselect_b32 s39, 360448, 0
    s_sub_u32 s3, s3, s39
    v_add_u32_e64 v18, s3, v253
    s_add_u32 m0, s91, 5120
    v_add_u32 v19, 7168, v18
    buffer_load_dwordx4 v18, s[96:99], 0 offen lds
    buffer_load_dwordx4 v19, s[96:99], 0 offen offset:1024 lds
    v_mfma_f32_16x16x32_bf16 v[48:51], a[16:19], v[60:63], v[48:51]
    v_mfma_f32_16x16x32_bf16 v[52:55], a[80:83], v[60:63], v[52:55]
    v_mfma_f32_16x16x32_bf16 v[56:59], a[144:147], v[60:63], v[56:59]
    v_mfma_f32_16x16x32_bf16 v[48:51], a[20:23], v[60:63], v[48:51]
    v_mfma_f32_16x16x32_bf16 v[52:55], a[84:87], v[60:63], v[52:55]
    v_mfma_f32_16x16x32_bf16 v[56:59], a[148:151], v[60:63], v[56:59]
    s_waitcnt vmcnt(10)
    ds_read_b64_tr_b16 a[216:217], v17 offset:9216
    ds_read_b64_tr_b16 a[218:219], v17 offset:10240
    ds_read_b64_tr_b16 a[220:221], v17 offset:9280
    ds_read_b64_tr_b16 a[222:223], v17 offset:10304
    s_waitcnt lgkmcnt(4)
    s_add_u32 s3, s3, 16384
    s_cmp_eq_u32 s3, s95
    s_cselect_b32 s39, 360448, 0
    s_sub_u32 s3, s3, s39
    v_add_u32_e64 v18, s3, v253
    s_add_u32 m0, s91, 7168
    v_add_u32 v19, 7168, v18
    buffer_load_dwordx4 v18, s[96:99], 0 offen lds
    buffer_load_dwordx4 v19, s[96:99], 0 offen offset:1024 lds
    v_mfma_f32_16x16x32_bf16 v[48:51], a[24:27], v[60:63], v[48:51]
    v_mfma_f32_16x16x32_bf16 v[52:55], a[88:91], v[60:63], v[52:55]
    v_mfma_f32_16x16x32_bf16 v[56:59], a[152:155], v[60:63], v[56:59]
    v_mfma_f32_16x16x32_bf16 v[48:51], a[28:31], v[60:63], v[48:51]
    v_mfma_f32_16x16x32_bf16 v[52:55], a[92:95], v[60:63], v[52:55]
    v_mfma_f32_16x16x32_bf16 v[56:59], a[156:159], v[60:63], v[56:59]
    s_waitcnt vmcnt(10)
    ds_read_b64_tr_b16 a[224:225], v17 offset:11264
    ds_read_b64_tr_b16 a[226:227], v17 offset:12288
    ds_read_b64_tr_b16 a[228:229], v17 offset:11328
    ds_read_b64_tr_b16 a[230:231], v17 offset:12352
    s_waitcnt lgkmcnt(4)
    s_add_u32 s3, s3, 16384
    s_cmp_eq_u32 s3, s95
    s_cselect_b32 s39, 360448, 0
    s_sub_u32 s3, s3, s39
    v_add_u32_e64 v18, s3, v253
    s_add_u32 m0, s91, 9216
    v_add_u32 v19, 7168, v18
    buffer_load_dwordx4 v18, s[96:99], 0 offen lds
    buffer_load_dwordx4 v19, s[96:99], 0 offen offset:1024 lds
    v_mfma_f32_16x16x32_bf16 v[48:51], a[32:35], v[60:63], v[48:51]
    v_mfma_f32_16x16x32_bf16 v[52:55], a[96:99], v[60:63], v[52:55]
    v_mfma_f32_16x16x32_bf16 v[56:59], a[160:163], v[60:63], v[56:59]
    v_mfma_f32_16x16x32_bf16 v[48:51], a[36:39], v[60:63], v[48:51]
    v_mfma_f32_16x16x32_bf16 v[52:55], a[100:103], v[60:63], v[52:55]
    v_mfma_f32_16x16x32_bf16 v[56:59], a[164:167], v[60:63], v[56:59]
    buffer_load_dwordx4 v[32:35], v39, s[4:7], s53 offen offset:0 sc1
    s_waitcnt vmcnt(11)
    ds_read_b64_tr_b16 a[232:233], v17 offset:13312
    ds_read_b64_tr_b16 a[234:235], v17 offset:14336
    ds_read_b64_tr_b16 a[236:237], v17 offset:13376
    ds_read_b64_tr_b16 a[238:239], v17 offset:14400
    s_waitcnt lgkmcnt(4)
    s_add_u32 s3, s3, 16384
    s_cmp_eq_u32 s3, s95
    s_cselect_b32 s39, 360448, 0
    s_sub_u32 s3, s3, s39
    v_add_u32_e64 v18, s3, v253
    s_add_u32 m0, s91, 11264
    v_add_u32 v19, 7168, v18
    buffer_load_dwordx4 v18, s[96:99], 0 offen lds
    buffer_load_dwordx4 v19, s[96:99], 0 offen offset:1024 lds
    v_mfma_f32_16x16x32_bf16 v[48:51], a[40:43], v[60:63], v[48:51]
    v_mfma_f32_16x16x32_bf16 v[52:55], a[104:107], v[60:63], v[52:55]
    v_mfma_f32_16x16x32_bf16 v[56:59], a[168:171], v[60:63], v[56:59]
    v_mfma_f32_16x16x32_bf16 v[48:51], a[44:47], v[60:63], v[48:51]
    v_mfma_f32_16x16x32_bf16 v[52:55], a[108:111], v[60:63], v[52:55]
    v_mfma_f32_16x16x32_bf16 v[56:59], a[172:175], v[60:63], v[56:59]
    s_waitcnt vmcnt(11)
    ds_read_b64_tr_b16 a[240:241], v17 offset:0
    ds_read_b64_tr_b16 a[242:243], v17 offset:1024
    ds_read_b64_tr_b16 a[244:245], v17 offset:64
    ds_read_b64_tr_b16 a[246:247], v17 offset:1088
    s_waitcnt lgkmcnt(4)
    s_add_u32 s3, s3, 16384
    s_cmp_eq_u32 s3, s95
    s_cselect_b32 s39, 360448, 0
    s_sub_u32 s3, s3, s39
    v_add_u32_e64 v18, s3, v253
    s_add_u32 m0, s91, 13312
    v_add_u32 v19, 7168, v18
    buffer_load_dwordx4 v18, s[96:99], 0 offen lds
    buffer_load_dwordx4 v19, s[96:99], 0 offen offset:1024 lds
    v_mfma_f32_16x16x32_bf16 v[48:51], a[48:51], v[60:63], v[48:51]
    v_mfma_f32_16x16x32_bf16 v[52:55], a[112:115], v[60:63], v[52:55]
    v_mfma_f32_16x16x32_bf16 v[56:59], a[176:179], v[60:63], v[56:59]
    v_mfma_f32_16x16x32_bf16 v[48:51], a[52:55], v[60:63], v[48:51]
    v_mfma_f32_16x16x32_bf16 v[52:55], a[116:119], v[60:63], v[52:55]
    v_mfma_f32_16x16x32_bf16 v[56:59], a[180:183], v[60:63], v[56:59]
    buffer_load_dwordx2 v[72:73], v6, s[4:7], s44 offen offset:0 sc1
    buffer_load_dwordx2 v[92:93], v6, s[4:7], s44 offen offset:2048 sc1
    s_waitcnt vmcnt(13)
    ds_read_b64_tr_b16 a[248:249], v17 offset:3072
    ds_read_b64_tr_b16 a[250:251], v17 offset:4096
    ds_read_b64_tr_b16 a[252:253], v17 offset:3136
    ds_read_b64_tr_b16 a[254:255], v17 offset:4160
    s_waitcnt lgkmcnt(4)
    s_add_u32 s3, s3, 16384
    s_cmp_eq_u32 s3, s95
    s_cselect_b32 s39, 360448, 0
    s_sub_u32 s3, s3, s39
    v_add_u32 v18, s3, v253
    s_add_u32 m0, s91, 0
    v_add_u32 v19, 7168, v18
    buffer_load_dwordx4 v18, s[96:99], 0 offen lds
    buffer_load_dwordx4 v19, s[96:99], 0 offen offset:1024 lds
    v_mfma_f32_16x16x32_bf16 v[48:51], a[56:59], v[60:63], v[48:51]
    v_mfma_f32_16x16x32_bf16 v[52:55], a[120:123], v[60:63], v[52:55]
    v_mfma_f32_16x16x32_bf16 v[56:59], a[184:187], v[60:63], v[56:59]
    v_mfma_f32_16x16x32_bf16 v[48:51], a[60:63], v[60:63], v[48:51]
    v_mfma_f32_16x16x32_bf16 v[52:55], a[124:127], v[60:63], v[52:55]
    v_mfma_f32_16x16x32_bf16 v[56:59], a[188:191], v[60:63], v[56:59]
    s_waitcnt vmcnt(8)
    v_xor_b32 v32, s92, v32
    v_xor_b32 v33, s92, v33
    v_xor_b32 v34, s92, v34
    v_xor_b32_e64 v35, s92, v35
    v_or3_b32 v36, v32, v33, v34
    v_or_b32_e64 v36, v36, v35
    v_cmp_ne_u32 vcc, 0, v36
    s_nop 0
    s_and_b64 vcc, exec, vcc
    s_cbranch_vccz K1_PDONE17
    s_mov_b32 s63, 524288
K1_POLL16:
    buffer_load_dwordx4 v[32:35], v39, s[4:7], s53 offen offset:0 sc1
    s_waitcnt vmcnt(0)
    v_xor_b32 v32, s92, v32
    v_xor_b32 v33, s92, v33
    v_xor_b32 v34, s92, v34
    v_xor_b32_e64 v35, s92, v35
    v_or3_b32 v36, v32, v33, v34
    v_or_b32 v36, v36, v35
    v_cmp_ne_u32 vcc, 0, v36
    s_nop 0
    s_and_b64 vcc, exec, vcc
    s_cbranch_vccz K1_PDONE17
    s_sub_u32 s63, s63, 1
    s_cmp_lg_u32 s63, 0
    s_cbranch_scc1 K1_POLL16
K1_PDONE17:
    s_mul_i32 s35, s2, 24576
    s_add_u32 s35, s35, 0x3800
    s_mov_b32 m0, 141056
    s_nop 0
    buffer_load_dwordx4 v11, s[4:7], s35 offen offset:0 sc1 lds
    s_mov_b32 m0, 141072
    s_nop 0
    buffer_load_dwordx4 v11, s[4:7], s35 offen offset:1024 sc1 lds
    s_mov_b32 m0, 141088
    s_nop 0
    buffer_load_dwordx4 v11, s[4:7], s35 offen offset:2048 sc1 lds
    s_mov_b32 m0, 141104
    s_nop 0
    buffer_load_dwordx4 v11, s[4:7], s35 offen offset:3072 sc1 lds
    s_add_u32 s35, s35, 4096
    s_mov_b32 m0, 145216
    s_nop 0
    buffer_load_dwordx4 v11, s[4:7], s35 offen offset:0 sc1 lds
    s_mov_b32 m0, 145232
    s_nop 0
    buffer_load_dwordx4 v11, s[4:7], s35 offen offset:1024 sc1 lds
    s_mov_b32 m0, 145248
    s_nop 0
    buffer_load_dwordx4 v11, s[4:7], s35 offen offset:2048 sc1 lds
    s_mov_b32 m0, 145264
    s_nop 0
    buffer_load_dwordx4 v11, s[4:7], s35 offen offset:3072 sc1 lds
    ds_read_b64_tr_b16 v[144:145], v17 offset:5120
    ds_read_b64_tr_b16 v[146:147], v17 offset:6144
    ds_read_b64_tr_b16 v[148:149], v17 offset:5184
    ds_read_b64_tr_b16 v[150:151], v17 offset:6208
    s_waitcnt lgkmcnt(4)
    s_add_u32 s3, s3, 16384
    s_cmp_eq_u32 s3, s95
    s_cselect_b32 s39, 360448, 0
    s_sub_u32 s3, s3, s39
    v_add_u32 v18, s3, v253
    s_add_u32 m0, s91, 3072
    v_add_u32 v19, 7168, v18
    buffer_load_dwordx4 v18, s[96:99], 0 offen lds
    buffer_load_dwordx4 v19, s[96:99], 0 offen offset:1024 lds
    ds_write_b128 v12, v[48:51] offset:16
    ds_write_b128 v12, v[52:55] offset:144
    ds_write_b128 v12, v[56:59] offset:272
    ds_read_b64_tr_b16 v[152:153], v17 offset:7168
    ds_read_b64_tr_b16 v[154:155], v17 offset:8192
    ds_read_b64_tr_b16 v[156:157], v17 offset:7232
    ds_read_b64_tr_b16 v[158:159], v17 offset:8256
    s_waitcnt lgkmcnt(7)
    s_add_u32 s3, s3, 16384
    s_cmp_eq_u32 s3, s95
    s_cselect_b32 s39, 360448, 0
    s_sub_u32 s3, s3, s39
    v_add_u32 v18, s3, v253
    s_add_u32 m0, s91, 5120
    v_add_u32 v19, 7168, v18
    buffer_load_dwordx4 v18, s[96:99], 0 offen lds
    buffer_load_dwordx4 v19, s[96:99], 0 offen offset:1024 lds
    s_waitcnt vmcnt(15)
    v_max_u32 v74, v72, v73
    v_cmp_eq_u32 vcc, -1, v74
    s_nop 0
    s_and_b64 vcc, exec, vcc
    s_cbranch_vccz K1_PDONE19
    s_mov_b32 s63, 524288
K1_POLL18:
    buffer_load_dwordx2 v[72:73], v6, s[4:7], s44 offen offset:0 sc1
    s_waitcnt vmcnt(0)
    v_max_u32 v74, v72, v73
    v_cmp_eq_u32 vcc, -1, v74
    s_nop 0
    s_and_b64 vcc, exec, vcc
    s_cbranch_vccz K1_PDONE19
    s_sub_u32 s63, s63, 1
    s_cmp_lg_u32 s63, 0
    s_cbranch_scc1 K1_POLL18
K1_PDONE19:
    s_waitcnt vmcnt(14)
    v_max_u32_e64 v94, v92, v93
    v_cmp_eq_u32 vcc, -1, v94
    s_nop 0
    s_and_b64 vcc, exec, vcc
    s_cbranch_vccz K1_PDONE21
    s_mov_b32 s63, 524288
K1_POLL20:
    buffer_load_dwordx2 v[92:93], v6, s[4:7], s44 offen offset:2048 sc1
    s_waitcnt vmcnt(0)
    v_max_u32_e64 v94, v92, v93
    v_cmp_eq_u32 vcc, -1, v94
    s_nop 0
    s_and_b64 vcc, exec, vcc
    s_cbranch_vccz K1_PDONE21
    s_sub_u32 s63, s63, 1
    s_cmp_lg_u32 s63, 0
    s_cbranch_scc1 K1_POLL20
K1_PDONE21:
    v_add_f32_dpp v72, v72, v72 quad_perm:[1,0,3,2] row_mask:0xf bank_mask:0xf
    v_add_f32_dpp v92, v92, v92 quad_perm:[1,0,3,2] row_mask:0xf bank_mask:0xf
    v_add_f32_dpp v73, v73, v73 quad_perm:[1,0,3,2] row_mask:0xf bank_mask:0xf
    v_add_f32_dpp v93, v93, v93 quad_perm:[1,0,3,2] row_mask:0xf bank_mask:0xf
    v_add_f32_dpp v72, v72, v72 quad_perm:[2,3,0,1] row_mask:0xf bank_mask:0xf
    v_add_f32_dpp v92, v92, v92 quad_perm:[2,3,0,1] row_mask:0xf bank_mask:0xf
    v_add_f32_dpp v73, v73, v73 quad_perm:[2,3,0,1] row_mask:0xf bank_mask:0xf
    v_add_f32_dpp v93, v93, v93 quad_perm:[2,3,0,1] row_mask:0xf bank_mask:0xf
    v_add_f32_dpp v72, v72, v72 row_half_mirror row_mask:0xf bank_mask:0xf
    v_add_f32_dpp v92, v92, v92 row_half_mirror row_mask:0xf bank_mask:0xf
    v_add_f32_dpp v73, v73, v73 row_half_mirror row_mask:0xf bank_mask:0xf
    v_add_f32_dpp v93, v93, v93 row_half_mirror row_mask:0xf bank_mask:0xf
    v_mul_f32 v72, s62, v72
    v_mul_f32 v92, s62, v92
    v_mul_f32 v73, s62, v73
    v_mul_f32 v93, s62, v93
    v_fma_f32 v73, -v72, v72, v73
    v_fma_f32 v93, -v92, v92, v93
    v_max_f32 v73, 0, v73
    v_max_f32 v93, 0, v93
    v_add_f32 v73, 0x3727c5ac, v73
    v_add_f32 v93, 0x3727c5ac, v93
    v_rsq_f32 v74, v73
    v_rsq_f32 v94, v93
    v_mul_f32 v72, -1.0, v72
    v_mul_f32 v92, -1.0, v92
    v_mul_f32 v75, v72, v74
    v_mul_f32 v95, v92, v94
    ds_read_b64_tr_b16 v[160:161], v17 offset:9216
    ds_read_b64_tr_b16 v[162:163], v17 offset:10240
    ds_read_b64_tr_b16 v[164:165], v17 offset:9280
    ds_read_b64_tr_b16 v[166:167], v17 offset:10304
    s_waitcnt lgkmcnt(4)
    s_add_u32 s3, s3, 16384
    s_cmp_eq_u32 s3, s95
    s_cselect_b32 s39, 360448, 0
    s_sub_u32 s3, s3, s39
    v_add_u32 v18, s3, v253
    s_add_u32 m0, s91, 7168
    v_add_u32 v19, 7168, v18
    buffer_load_dwordx4 v18, s[96:99], 0 offen lds
    buffer_load_dwordx4 v19, s[96:99], 0 offen offset:1024 lds
    ds_read_b64_tr_b16 v[168:169], v17 offset:11264
    ds_read_b64_tr_b16 v[170:171], v17 offset:12288
    ds_read_b64_tr_b16 v[172:173], v17 offset:11328
    ds_read_b64_tr_b16 v[174:175], v17 offset:12352
    s_waitcnt lgkmcnt(4)
    s_add_u32 s3, s3, 16384
    s_cmp_eq_u32 s3, s95
    s_cselect_b32 s39, 360448, 0
    s_sub_u32 s3, s3, s39
    v_add_u32 v18, s3, v253
    s_add_u32 m0, s91, 9216
    v_add_u32 v19, 7168, v18
    buffer_load_dwordx4 v18, s[96:99], 0 offen lds
    buffer_load_dwordx4 v19, s[96:99], 0 offen offset:1024 lds
    ds_read_b64_tr_b16 v[176:177], v17 offset:13312
    ds_read_b64_tr_b16 v[178:179], v17 offset:14336
    ds_read_b64_tr_b16 v[180:181], v17 offset:13376
    ds_read_b64_tr_b16 v[182:183], v17 offset:14400
    s_waitcnt vmcnt(8)
    s_branch K1_X15
K1_X13:
    ds_read_b64_tr_b16 a[56:57], v252 offset:12288
    ds_read_b64_tr_b16 a[58:59], v252 offset:12672
    ds_read_b64_tr_b16 a[120:121], v252 offset:12320
    ds_read_b64_tr_b16 a[122:123], v252 offset:12704
    ds_read_b64_tr_b16 a[184:185], v252 offset:12352
    ds_read_b64_tr_b16 a[186:187], v252 offset:12736
    ds_read_b64_tr_b16 a[60:61], v252 offset:0
    ds_read_b64_tr_b16 a[62:63], v252 offset:384
    ds_read_b64_tr_b16 a[124:125], v252 offset:32
    ds_read_b64_tr_b16 a[126:127], v252 offset:416
    ds_read_b64_tr_b16 a[188:189], v252 offset:64
    ds_read_b64_tr_b16 a[190:191], v252 offset:448
    s_waitcnt lgkmcnt(6)
    s_add_u32 s3, s3, 16384
    s_cmp_eq_u32 s3, s95
    s_cselect_b32 s39, 360448, 0
    s_sub_u32 s3, s3, s39
    v_add_u32 v18, s3, v253
    s_add_u32 m0, s91, 11264
    v_add_u32 v19, 7168, v18
    buffer_load_dwordx4 v18, s[96:99], 0 offen lds
    buffer_load_dwordx4 v19, s[96:99], 0 offen offset:1024 lds
    s_add_u32 s3, s3, 16384
    s_cmp_eq_u32 s3, s95
    s_cselect_b32 s39, 360448, 0
    s_sub_u32 s3, s3, s39
    v_add_u32_e64 v18, s3, v253
    s_add_u32 m0, s91, 13312
    v_add_u32 v19, 7168, v18
    buffer_load_dwordx4 v18, s[96:99], 0 offen lds
    buffer_load_dwordx4 v19, s[96:99], 0 offen offset:1024 lds
    s_waitcnt vmcnt(10)
    ds_read_b64_tr_b16 a[192:193], v17 offset:3072
    ds_read_b64_tr_b16 a[194:195], v17 offset:4096
    ds_read_b64_tr_b16 a[196:197], v17 offset:3136
    ds_read_b64_tr_b16 a[198:199], v17 offset:4160
    s_waitcnt lgkmcnt(4)
    s_add_u32 s3, s3, 16384
    s_cmp_eq_u32 s3, s95
    s_cselect_b32 s39, 360448, 0
    s_sub_u32 s3, s3, s39
    v_add_u32 v18, s3, v253
    s_add_u32 m0, s91, 0
    v_add_u32 v19, 7168, v18
    buffer_load_dwordx4 v18, s[96:99], 0 offen lds
    buffer_load_dwordx4 v19, s[96:99], 0 offen offset:1024 lds
    v_mfma_f32_16x16x32_bf16 v[48:51], a[0:3], v[60:63], 0
    v_mfma_f32_16x16x32_bf16 v[52:55], a[64:67], v[60:63], 0
    v_mfma_f32_16x16x32_bf16 v[56:59], a[128:131], v[60:63], 0
    v_mfma_f32_16x16x32_bf16 v[48:51], a[4:7], v[60:63], v[48:51]
    v_mfma_f32_16x16x32_bf16 v[52:55], a[68:71], v[60:63], v[52:55]
    v_mfma_f32_16x16x32_bf16 v[56:59], a[132:135], v[60:63], v[56:59]
    s_waitcnt vmcnt(10)
    ds_read_b64_tr_b16 a[200:201], v17 offset:5120
    ds_read_b64_tr_b16 a[202:203], v17 offset:6144
    ds_read_b64_tr_b16 a[204:205], v17 offset:5184
    ds_read_b64_tr_b16 a[206:207], v17 offset:6208
    s_waitcnt lgkmcnt(4)
    s_add_u32 s3, s3, 16384
    s_cmp_eq_u32 s3, s95
    s_cselect_b32 s39, 360448, 0
    s_sub_u32 s3, s3, s39
    v_add_u32_e64 v18, s3, v253
    s_add_u32 m0, s91, 3072
    v_add_u32 v19, 7168, v18
    buffer_load_dwordx4 v18, s[96:99], 0 offen lds
    buffer_load_dwordx4 v19, s[96:99], 0 offen offset:1024 lds
    v_mfma_f32_16x16x32_bf16 v[48:51], a[8:11], v[60:63], v[48:51]
    v_mfma_f32_16x16x32_bf16 v[52:55], a[72:75], v[60:63], v[52:55]
    v_mfma_f32_16x16x32_bf16 v[56:59], a[136:139], v[60:63], v[56:59]
    v_mfma_f32_16x16x32_bf16 v[48:51], a[12:15], v[60:63], v[48:51]
    v_mfma_f32_16x16x32_bf16 v[52:55], a[76:79], v[60:63], v[52:55]
    v_mfma_f32_16x16x32_bf16 v[56:59], a[140:143], v[60:63], v[56:59]
    s_waitcnt vmcnt(10)
    ds_read_b64_tr_b16 a[208:209], v17 offset:7168
    ds_read_b64_tr_b16 a[210:211], v17 offset:8192
    ds_read_b64_tr_b16 a[212:213], v17 offset:7232
    ds_read_b64_tr_b16 a[214:215], v17 offset:8256
    s_waitcnt lgkmcnt(4)
    s_add_u32 s3, s3, 16384
    s_cmp_eq_u32 s3, s95
    s_cselect_b32 s39, 360448, 0
    s_sub_u32 s3, s3, s39
    v_add_u32_e64 v18, s3, v253
    s_add_u32 m0, s91, 5120
    v_add_u32 v19, 7168, v18
    buffer_load_dwordx4 v18, s[96:99], 0 offen lds
    buffer_load_dwordx4 v19, s[96:99], 0 offen offset:1024 lds
    v_mfma_f32_16x16x32_bf16 v[48:51], a[16:19], v[60:63], v[48:51]
    v_mfma_f32_16x16x32_bf16 v[52:55], a[80:83], v[60:63], v[52:55]
    v_mfma_f32_16x16x32_bf16 v[56:59], a[144:147], v[60:63], v[56:59]
    v_mfma_f32_16x16x32_bf16 v[48:51], a[20:23], v[60:63], v[48:51]
    v_mfma_f32_16x16x32_bf16 v[52:55], a[84:87], v[60:63], v[52:55]
    v_mfma_f32_16x16x32_bf16 v[56:59], a[148:151], v[60:63], v[56:59]
    s_waitcnt vmcnt(10)
    ds_read_b64_tr_b16 a[216:217], v17 offset:9216
    ds_read_b64_tr_b16 a[218:219], v17 offset:10240
    ds_read_b64_tr_b16 a[220:221], v17 offset:9280
    ds_read_b64_tr_b16 a[222:223], v17 offset:10304
    s_waitcnt lgkmcnt(4)
    s_add_u32 s3, s3, 16384
    s_cmp_eq_u32 s3, s95
    s_cselect_b32 s39, 360448, 0
    s_sub_u32 s3, s3, s39
    v_add_u32_e64 v18, s3, v253
    s_add_u32 m0, s91, 7168
    v_add_u32 v19, 7168, v18
    buffer_load_dwordx4 v18, s[96:99], 0 offen lds
    buffer_load_dwordx4 v19, s[96:99], 0 offen offset:1024 lds
    v_mfma_f32_16x16x32_bf16 v[48:51], a[24:27], v[60:63], v[48:51]
    v_mfma_f32_16x16x32_bf16 v[52:55], a[88:91], v[60:63], v[52:55]
    v_mfma_f32_16x16x32_bf16 v[56:59], a[152:155], v[60:63], v[56:59]
    v_mfma_f32_16x16x32_bf16 v[48:51], a[28:31], v[60:63], v[48:51]
    v_mfma_f32_16x16x32_bf16 v[52:55], a[92:95], v[60:63], v[52:55]
    v_mfma_f32_16x16x32_bf16 v[56:59], a[156:159], v[60:63], v[56:59]
    s_waitcnt vmcnt(10)
    ds_read_b64_tr_b16 a[224:225], v17 offset:11264
    ds_read_b64_tr_b16 a[226:227], v17 offset:12288
    ds_read_b64_tr_b16 a[228:229], v17 offset:11328
    ds_read_b64_tr_b16 a[230:231], v17 offset:12352
    s_waitcnt lgkmcnt(4)
    s_add_u32 s3, s3, 16384
    s_cmp_eq_u32 s3, s95
    s_cselect_b32 s39, 360448, 0
    s_sub_u32 s3, s3, s39
    v_add_u32_e64 v18, s3, v253
    s_add_u32 m0, s91, 9216
    v_add_u32 v19, 7168, v18
    buffer_load_dwordx4 v18, s[96:99], 0 offen lds
    buffer_load_dwordx4 v19, s[96:99], 0 offen offset:1024 lds
    v_mfma_f32_16x16x32_bf16 v[48:51], a[32:35], v[60:63], v[48:51]
    v_mfma_f32_16x16x32_bf16 v[52:55], a[96:99], v[60:63], v[52:55]
    v_mfma_f32_16x16x32_bf16 v[56:59], a[160:163], v[60:63], v[56:59]
    v_mfma_f32_16x16x32_bf16 v[48:51], a[36:39], v[60:63], v[48:51]
    v_mfma_f32_16x16x32_bf16 v[52:55], a[100:103], v[60:63], v[52:55]
    v_mfma_f32_16x16x32_bf16 v[56:59], a[164:167], v[60:63], v[56:59]
    s_waitcnt vmcnt(10)
    ds_read_b64_tr_b16 a[232:233], v17 offset:13312
    ds_read_b64_tr_b16 a[234:235], v17 offset:14336
    ds_read_b64_tr_b16 a[236:237], v17 offset:13376
    ds_read_b64_tr_b16 a[238:239], v17 offset:14400
    s_waitcnt lgkmcnt(4)
    s_add_u32 s3, s3, 16384
    s_cmp_eq_u32 s3, s95
    s_cselect_b32 s39, 360448, 0
    s_sub_u32 s3, s3, s39
    v_add_u32_e64 v18, s3, v253
    s_add_u32 m0, s91, 11264
    v_add_u32 v19, 7168, v18
    buffer_load_dwordx4 v18, s[96:99], 0 offen lds
    buffer_load_dwordx4 v19, s[96:99], 0 offen offset:1024 lds
    v_mfma_f32_16x16x32_bf16 v[48:51], a[40:43], v[60:63], v[48:51]
    v_mfma_f32_16x16x32_bf16 v[52:55], a[104:107], v[60:63], v[52:55]
    v_mfma_f32_16x16x32_bf16 v[56:59], a[168:171], v[60:63], v[56:59]
    v_mfma_f32_16x16x32_bf16 v[48:51], a[44:47], v[60:63], v[48:51]
    v_mfma_f32_16x16x32_bf16 v[52:55], a[108:111], v[60:63], v[52:55]
    v_mfma_f32_16x16x32_bf16 v[56:59], a[172:175], v[60:63], v[56:59]
    s_waitcnt vmcnt(10)
    ds_read_b64_tr_b16 a[240:241], v17 offset:0
    ds_read_b64_tr_b16 a[242:243], v17 offset:1024
    ds_read_b64_tr_b16 a[244:245], v17 offset:64
    ds_read_b64_tr_b16 a[246:247], v17 offset:1088
    s_waitcnt lgkmcnt(4)
    s_add_u32 s3, s3, 16384
    s_cmp_eq_u32 s3, s95
    s_cselect_b32 s39, 360448, 0
    s_sub_u32 s3, s3, s39
    v_add_u32_e64 v18, s3, v253
    s_add_u32 m0, s91, 13312
    v_add_u32 v19, 7168, v18
    buffer_load_dwordx4 v18, s[96:99], 0 offen lds
    buffer_load_dwordx4 v19, s[96:99], 0 offen offset:1024 lds
    v_mfma_f32_16x16x32_bf16 v[48:51], a[48:51], v[60:63], v[48:51]
    v_mfma_f32_16x16x32_bf16 v[52:55], a[112:115], v[60:63], v[52:55]
    v_mfma_f32_16x16x32_bf16 v[56:59], a[176:179], v[60:63], v[56:59]
    v_mfma_f32_16x16x32_bf16 v[48:51], a[52:55], v[60:63], v[48:51]
    v_mfma_f32_16x16x32_bf16 v[52:55], a[116:119], v[60:63], v[52:55]
    v_mfma_f32_16x16x32_bf16 v[56:59], a[180:183], v[60:63], v[56:59]
    buffer_load_dwordx2 v[72:73], v6, s[4:7], s44 offen offset:0 sc1
    buffer_load_dwordx2 v[92:93], v6, s[4:7], s44 offen offset:2048 sc1
    s_waitcnt vmcnt(12)
    ds_read_b64_tr_b16 a[248:249], v17 offset:3072
    ds_read_b64_tr_b16 a[250:251], v17 offset:4096
    ds_read_b64_tr_b16 a[252:253], v17 offset:3136
    ds_read_b64_tr_b16 a[254:255], v17 offset:4160
    s_waitcnt lgkmcnt(4)
    s_add_u32 s3, s3, 16384
    s_cmp_eq_u32 s3, s95
    s_cselect_b32 s39, 360448, 0
    s_sub_u32 s3, s3, s39
    v_add_u32 v18, s3, v253
    s_add_u32 m0, s91, 0
    v_add_u32 v19, 7168, v18
    buffer_load_dwordx4 v18, s[96:99], 0 offen lds
    buffer_load_dwordx4 v19, s[96:99], 0 offen offset:1024 lds
    v_mfma_f32_16x16x32_bf16 v[48:51], a[56:59], v[60:63], v[48:51]
    v_mfma_f32_16x16x32_bf16 v[52:55], a[120:123], v[60:63], v[52:55]
    v_mfma_f32_16x16x32_bf16 v[56:59], a[184:187], v[60:63], v[56:59]
    v_mfma_f32_16x16x32_bf16 v[48:51], a[60:63], v[60:63], v[48:51]
    v_mfma_f32_16x16x32_bf16 v[52:55], a[124:127], v[60:63], v[52:55]
    v_mfma_f32_16x16x32_bf16 v[56:59], a[188:191], v[60:63], v[56:59]
    s_waitcnt vmcnt(12)
    ds_read_b64_tr_b16 v[144:145], v17 offset:5120
    ds_read_b64_tr_b16 v[146:147], v17 offset:6144
    ds_read_b64_tr_b16 v[148:149], v17 offset:5184
    ds_read_b64_tr_b16 v[150:151], v17 offset:6208
    s_waitcnt lgkmcnt(4)
    s_add_u32 s3, s3, 16384
    s_cmp_eq_u32 s3, s95
    s_cselect_b32 s39, 360448, 0
    s_sub_u32 s3, s3, s39
    v_add_u32_e64 v18, s3, v253
    s_add_u32 m0, s91, 3072
    v_add_u32 v19, 7168, v18
    buffer_load_dwordx4 v18, s[96:99], 0 offen lds
    buffer_load_dwordx4 v19, s[96:99], 0 offen offset:1024 lds
    ds_write_b128 v12, v[48:51] offset:16
    ds_write_b128 v12, v[52:55] offset:144
    ds_write_b128 v12, v[56:59] offset:272
    s_waitcnt vmcnt(12)
    ds_read_b64_tr_b16 v[152:153], v17 offset:7168
    ds_read_b64_tr_b16 v[154:155], v17 offset:8192
    ds_read_b64_tr_b16 v[156:157], v17 offset:7232
    ds_read_b64_tr_b16 v[158:159], v17 offset:8256
    s_waitcnt lgkmcnt(7)
    s_add_u32 s3, s3, 16384
    s_cmp_eq_u32 s3, s95
    s_cselect_b32 s39, 360448, 0
    s_sub_u32 s3, s3, s39
    v_add_u32_e64 v18, s3, v253
    s_add_u32 m0, s91, 5120
    v_add_u32 v19, 7168, v18
    buffer_load_dwordx4 v18, s[96:99], 0 offen lds
    buffer_load_dwordx4 v19, s[96:99], 0 offen offset:1024 lds
    s_waitcnt vmcnt(7)
    v_max_u32 v74, v72, v73
    v_cmp_eq_u32 vcc, -1, v74
    s_nop 0
    s_and_b64 vcc, exec, vcc
    s_cbranch_vccz K1_PDONE23
    s_mov_b32 s63, 524288
K1_POLL22:
    buffer_load_dwordx2 v[72:73], v6, s[4:7], s44 offen offset:0 sc1
    s_waitcnt vmcnt(0)
    v_max_u32 v74, v72, v73
    v_cmp_eq_u32 vcc, -1, v74
    s_nop 0
    s_and_b64 vcc, exec, vcc
    s_cbranch_vccz K1_PDONE23
    s_sub_u32 s63, s63, 1
    s_cmp_lg_u32 s63, 0
    s_cbranch_scc1 K1_POLL22
K1_PDONE23:
    s_waitcnt vmcnt(6)
    v_max_u32_e64 v94, v92, v93
    v_cmp_eq_u32 vcc, -1, v94
    s_nop 0
    s_and_b64 vcc, exec, vcc
    s_cbranch_vccz K1_PDONE25
    s_mov_b32 s63, 524288
K1_POLL24:
    buffer_load_dwordx2 v[92:93], v6, s[4:7], s44 offen offset:2048 sc1
    s_waitcnt vmcnt(0)
    v_max_u32_e64 v94, v92, v93
    v_cmp_eq_u32 vcc, -1, v94
    s_nop 0
    s_and_b64 vcc, exec, vcc
    s_cbranch_vccz K1_PDONE25
    s_sub_u32 s63, s63, 1
    s_cmp_lg_u32 s63, 0
    s_cbranch_scc1 K1_POLL24
K1_PDONE25:
    v_add_f32_dpp v72, v72, v72 quad_perm:[1,0,3,2] row_mask:0xf bank_mask:0xf
    v_add_f32_dpp v92, v92, v92 quad_perm:[1,0,3,2] row_mask:0xf bank_mask:0xf
    v_add_f32_dpp v73, v73, v73 quad_perm:[1,0,3,2] row_mask:0xf bank_mask:0xf
    v_add_f32_dpp v93, v93, v93 quad_perm:[1,0,3,2] row_mask:0xf bank_mask:0xf
    v_add_f32_dpp v72, v72, v72 quad_perm:[2,3,0,1] row_mask:0xf bank_mask:0xf
    v_add_f32_dpp v92, v92, v92 quad_perm:[2,3,0,1] row_mask:0xf bank_mask:0xf
    v_add_f32_dpp v73, v73, v73 quad_perm:[2,3,0,1] row_mask:0xf bank_mask:0xf
    v_add_f32_dpp v93, v93, v93 quad_perm:[2,3,0,1] row_mask:0xf bank_mask:0xf
    v_add_f32_dpp v72, v72, v72 row_half_mirror row_mask:0xf bank_mask:0xf
    v_add_f32_dpp v92, v92, v92 row_half_mirror row_mask:0xf bank_mask:0xf
    v_add_f32_dpp v73, v73, v73 row_half_mirror row_mask:0xf bank_mask:0xf
    v_add_f32_dpp v93, v93, v93 row_half_mirror row_mask:0xf bank_mask:0xf
    v_mul_f32 v72, s62, v72
    v_mul_f32 v92, s62, v92
    v_mul_f32 v73, s62, v73
    v_mul_f32 v93, s62, v93
    v_fma_f32 v73, -v72, v72, v73
    v_fma_f32 v93, -v92, v92, v93
    v_max_f32 v73, 0, v73
    v_max_f32 v93, 0, v93
    v_add_f32 v73, 0x3727c5ac, v73
    v_add_f32 v93, 0x3727c5ac, v93
    v_rsq_f32 v74, v73
    v_rsq_f32 v94, v93
    v_mul_f32 v72, -1.0, v72
    v_mul_f32 v92, -1.0, v92
    v_mul_f32 v75, v72, v74
    v_mul_f32 v95, v92, v94
    ds_read_b64_tr_b16 v[160:161], v17 offset:9216
    ds_read_b64_tr_b16 v[162:163], v17 offset:10240
    ds_read_b64_tr_b16 v[164:165], v17 offset:9280
    ds_read_b64_tr_b16 v[166:167], v17 offset:10304
    s_waitcnt lgkmcnt(4)
    s_add_u32 s3, s3, 16384
    s_cmp_eq_u32 s3, s95
    s_cselect_b32 s39, 360448, 0
    s_sub_u32 s3, s3, s39
    v_add_u32 v18, s3, v253
    s_add_u32 m0, s91, 7168
    v_add_u32 v19, 7168, v18
    buffer_load_dwordx4 v18, s[96:99], 0 offen lds
    buffer_load_dwordx4 v19, s[96:99], 0 offen offset:1024 lds
    ds_read_b64_tr_b16 v[168:169], v17 offset:11264
    ds_read_b64_tr_b16 v[170:171], v17 offset:12288
    ds_read_b64_tr_b16 v[172:173], v17 offset:11328
    ds_read_b64_tr_b16 v[174:175], v17 offset:12352
    s_waitcnt lgkmcnt(4)
    s_add_u32 s3, s3, 16384
    s_cmp_eq_u32 s3, s95
    s_cselect_b32 s39, 360448, 0
    s_sub_u32 s3, s3, s39
    v_add_u32 v18, s3, v253
    s_add_u32 m0, s91, 9216
    v_add_u32 v19, 7168, v18
    buffer_load_dwordx4 v18, s[96:99], 0 offen lds
    buffer_load_dwordx4 v19, s[96:99], 0 offen offset:1024 lds
    ds_read_b64_tr_b16 v[176:177], v17 offset:13312
    ds_read_b64_tr_b16 v[178:179], v17 offset:14336
    ds_read_b64_tr_b16 v[180:181], v17 offset:13376
    ds_read_b64_tr_b16 v[182:183], v17 offset:14400
K1_X15:
    s_add_u32 s37, s46, 0
    buffer_load_dword v14, v20, s[4:7], s37 offen offset:0 sc1
    s_add_u32 s37, s46, 16384
    buffer_load_dword v14, v20, s[4:7], s37 offen offset:0 sc1
    s_waitcnt lgkmcnt(0)
    s_barrier
    v_mov_b32 v33, 149376
    ds_read_b32 v34, v33
    ds_read_u16 v76, v23 offset:0
    ds_read_u16 v77, v23 offset:128
    ds_read_u16 v78, v23 offset:256
    ds_read_u16 v79, v23 offset:384
    ds_read_u16 v80, v23 offset:512
    ds_read_u16 v81, v23 offset:640
    ds_read_u16 v82, v23 offset:768
    ds_read_u16 v83, v23 offset:896
    ds_read_u16 v104, v23 offset:64
    ds_read_u16 v105, v23 offset:192
    ds_read_u16 v106, v23 offset:320
    ds_read_u16 v107, v23 offset:448
    ds_read_u16 v108, v23 offset:576
    ds_read_u16 v109, v23 offset:704
    ds_read_u16 v110, v23 offset:832
    ds_read_u16 v111, v23 offset:960
    v_lshlrev_b32 v64, 16, v24
    v_and_b32 v65, s56, v24
    v_lshlrev_b32 v66, 16, v25
    v_and_b32 v67, s56, v25
    v_lshlrev_b32 v68, 16, v26
    v_and_b32 v69, s56, v26
    v_lshlrev_b32 v70, 16, v27
    v_and_b32 v71, s56, v27
    s_waitcnt lgkmcnt(15)
    v_readfirstlane_b32 s88, v34
    s_lshl_b32 s94, s18, 8
    s_add_u32 s90, s50, 20480
    s_cmp_eq_u32 s88, 0
    s_cbranch_scc1 K1_SLOW
    s_waitcnt lgkmcnt(15)
    v_lshlrev_b32 v76, 16, v76
    s_waitcnt lgkmcnt(14)
    v_lshlrev_b32 v77, 16, v77
    s_waitcnt lgkmcnt(13)
    v_lshlrev_b32 v78, 16, v78
    s_waitcnt lgkmcnt(12)
    v_lshlrev_b32 v79, 16, v79
    s_waitcnt lgkmcnt(11)
    v_lshlrev_b32 v80, 16, v80
    s_waitcnt lgkmcnt(10)
    v_lshlrev_b32 v81, 16, v81
    s_waitcnt lgkmcnt(9)
    v_lshlrev_b32 v82, 16, v82
    s_waitcnt lgkmcnt(8)
    v_lshlrev_b32 v83, 16, v83
    v_pk_fma_f32 v[84:85], v[64:65], v[74:75], v[74:75] op_sel:[0,0,1] op_sel_hi:[1,0,1]
    v_pk_fma_f32 v[86:87], v[66:67], v[74:75], v[74:75] op_sel:[0,0,1] op_sel_hi:[1,0,1]
    v_pk_fma_f32 v[88:89], v[68:69], v[74:75], v[74:75] op_sel:[0,0,1] op_sel_hi:[1,0,1]
    v_pk_fma_f32 v[90:91], v[70:71], v[74:75], v[74:75] op_sel:[0,0,1] op_sel_hi:[1,0,1]
    v_pk_fma_f32 v[64:65], v[84:85], v[76:77], v[64:65]
    v_pk_fma_f32 v[66:67], v[86:87], v[78:79], v[66:67]
    v_pk_fma_f32 v[68:69], v[88:89], v[80:81], v[68:69]
    v_pk_fma_f32 v[70:71], v[90:91], v[82:83], v[70:71]
    v_cvt_pk_bf16_f32 v24, v64, v65
    v_cvt_pk_bf16_f32 v25, v66, v67
    v_cvt_pk_bf16_f32 v26, v68, v69
    v_cvt_pk_bf16_f32 v27, v70, v71
    s_add_u32 s35, s50, 0x2c00
    buffer_store_dwordx4 v[24:27], v10, s[4:7], s35 offen
    v_dot2_f32_bf16 v84, v24, s57, 0
    v_dot2_f32_bf16 v85, v24, v24, 0
    v_dot2_f32_bf16 v84, v25, s57, v84
    v_dot2_f32_bf16 v85, v25, v25, v85
    v_dot2_f32_bf16 v84, v26, s57, v84
    v_dot2_f32_bf16 v85, v26, v26, v85
    v_dot2_f32_bf16 v84, v27, s57, v84
    v_dot2_f32_bf16 v85, v27, v27, v85
    s_nop 1
    v_add_f32_dpp v84, v84, v84 quad_perm:[1,0,3,2] row_mask:0xf bank_mask:0xf
    v_add_f32_dpp v85, v85, v85 quad_perm:[1,0,3,2] row_mask:0xf bank_mask:0xf
    s_nop 0
    v_add_f32_dpp v84, v84, v84 quad_perm:[2,3,0,1] row_mask:0xf bank_mask:0xf
    v_add_f32_dpp v85, v85, v85 quad_perm:[2,3,0,1] row_mask:0xf bank_mask:0xf
    s_nop 0
    v_add_f32_dpp v84, v84, v84 row_half_mirror row_mask:0xf bank_mask:0xf
    v_add_f32_dpp v85, v85, v85 row_half_mirror row_mask:0xf bank_mask:0xf
    s_add_u32 s35, s50, 0x4c00
    s_sub_u32 s35, s35, s94
    s_mov_b32 exec_lo, 0x01010101
    s_mov_b32 exec_hi, 0x01010101
    buffer_store_dwordx2 v[84:85], v5, s[4:7], s35 offen
    s_mov_b64 exec, -1
    s_waitcnt lgkmcnt(7)
    v_lshlrev_b32 v76, 16, v104
    s_waitcnt lgkmcnt(6)
    v_lshlrev_b32 v77, 16, v105
    s_waitcnt lgkmcnt(5)
    v_lshlrev_b32 v78, 16, v106
    s_waitcnt lgkmcnt(4)
    v_lshlrev_b32 v79, 16, v107
    s_waitcnt lgkmcnt(3)
    v_lshlrev_b32 v80, 16, v108
    s_waitcnt lgkmcnt(2)
    v_lshlrev_b32 v81, 16, v109
    s_waitcnt lgkmcnt(1)
    v_lshlrev_b32 v82, 16, v110
    s_waitcnt lgkmcnt(0)
    v_lshlrev_b32 v83, 16, v111
    v_lshlrev_b32 v64, 16, v28
    v_and_b32 v65, s56, v28
    v_lshlrev_b32 v66, 16, v29
    v_and_b32 v67, s56, v29
    v_lshlrev_b32 v68, 16, v30
    v_and_b32 v69, s56, v30
    v_lshlrev_b32 v70, 16, v31
    v_and_b32_e64 v71, s56, v31
    v_pk_fma_f32 v[84:85], v[64:65], v[94:95], v[94:95] op_sel:[0,0,1] op_sel_hi:[1,0,1]
    v_pk_fma_f32 v[86:87], v[66:67], v[94:95], v[94:95] op_sel:[0,0,1] op_sel_hi:[1,0,1]
    v_pk_fma_f32 v[88:89], v[68:69], v[94:95], v[94:95] op_sel:[0,0,1] op_sel_hi:[1,0,1]
    v_pk_fma_f32 v[90:91], v[70:71], v[94:95], v[94:95] op_sel:[0,0,1] op_sel_hi:[1,0,1]
    v_pk_fma_f32 v[64:65], v[84:85], v[76:77], v[64:65]
    v_pk_fma_f32 v[66:67], v[86:87], v[78:79], v[66:67]
    v_pk_fma_f32 v[68:69], v[88:89], v[80:81], v[68:69]
    v_pk_fma_f32 v[70:71], v[90:91], v[82:83], v[70:71]
    v_cvt_pk_bf16_f32 v28, v64, v65
    v_cvt_pk_bf16_f32 v29, v66, v67
    v_cvt_pk_bf16_f32 v30, v68, v69
    v_cvt_pk_bf16_f32 v31, v70, v71
    s_add_u32 s35, s50, 0x3c00
    buffer_store_dwordx4 v[28:31], v10, s[4:7], s35 offen
    v_dot2_f32_bf16 v84, v28, s57, 0
    v_dot2_f32_bf16 v85, v28, v28, 0
    v_dot2_f32_bf16 v84, v29, s57, v84
    v_dot2_f32_bf16 v85, v29, v29, v85
    v_dot2_f32_bf16 v84, v30, s57, v84
    v_dot2_f32_bf16 v85, v30, v30, v85
    v_dot2_f32_bf16 v84, v31, s57, v84
    v_dot2_f32_bf16 v85, v31, v31, v85
    s_nop 1
    v_add_f32_dpp v84, v84, v84 quad_perm:[1,0,3,2] row_mask:0xf bank_mask:0xf
    v_add_f32_dpp v85, v85, v85 quad_perm:[1,0,3,2] row_mask:0xf bank_mask:0xf
    s_nop 0
    v_add_f32_dpp v84, v84, v84 quad_perm:[2,3,0,1] row_mask:0xf bank_mask:0xf
    v_add_f32_dpp v85, v85, v85 quad_perm:[2,3,0,1] row_mask:0xf bank_mask:0xf
    s_nop 0
    v_add_f32_dpp v84, v84, v84 row_half_mirror row_mask:0xf bank_mask:0xf
    v_add_f32_dpp v85, v85, v85 row_half_mirror row_mask:0xf bank_mask:0xf
    s_add_u32 s35, s50, 0x4d00
    s_sub_u32 s35, s35, s94
    s_mov_b32 exec_lo, 0x01010101
    s_mov_b32 exec_hi, 0x01010101
    buffer_store_dwordx2 v[84:85], v5, s[4:7], s35 offen
    s_mov_b64 exec, -1
    s_waitcnt vmcnt(2)
    s_mov_b64 exec, 1
    buffer_store_dword v8, v8, s[4:7], s45 offen offset:0
    s_mov_b64 exec, -1
    s_add_u32 s35, s29, 0
    s_and_b32 s35, s35, 3
    s_lshl_b32 s52, s35, 8
    s_add_u32 s35, s29, 1
    s_and_b32 s35, s35, 3
    s_lshl_b32 s53, s35, 8
    s_add_u32 s35, s29, 2
    s_and_b32 s35, s35, 3
    s_lshl_b32 s54, s35, 8
    s_add_u32 s35, s29, 3
    s_and_b32 s35, s35, 3
    s_lshl_b32 s55, s35, 8
    v_and_b32_e64 v14, 15, v1
    v_mul_u32_u24 v14, 1056, v14
    v_lshrrev_b32_e64 v15, 4, v1
    v_lshl_add_u32 v14, v15, 4, v14
    v_add_u32 v64, s52, v14
    v_add_u32 v65, s53, v14
    v_add_u32 v66, s54, v14
    v_add_u32 v67, s55, v14
    ds_read_b64_tr_b16 v[184:185], v17 offset:0
    ds_read_b64_tr_b16 v[186:187], v17 offset:1024
    ds_read_b64_tr_b16 v[188:189], v17 offset:64
    ds_read_b64_tr_b16 v[190:191], v17 offset:1088
    s_waitcnt vmcnt(1)
    s_add_u32 s36, s45, 16384
    s_mov_b64 exec, 1
    buffer_store_dword v8, v8, s[4:7], s36 offen offset:0
    s_mov_b64 exec, -1
    buffer_load_dword v22, v20, s[4:7], s46 offen offset:0 sc1
    ds_read_b64_tr_b16 v[192:193], v17 offset:3072
    ds_read_b64_tr_b16 v[194:195], v17 offset:4096
    ds_read_b64_tr_b16 v[196:197], v17 offset:3136
    ds_read_b64_tr_b16 v[198:199], v17 offset:4160
    s_waitcnt vmcnt(0)
    v_cmp_eq_u32 vcc, -1, v22
    s_nop 0
    s_and_b64 vcc, exec, vcc
    s_cbranch_vccz K1_PDONE27
    s_mov_b32 s63, 524288
K1_POLL26:
    buffer_load_dword v22, v20, s[4:7], s46 offen offset:0 sc1
    s_waitcnt vmcnt(0)
    v_cmp_eq_u32 vcc, -1, v22
    s_nop 0
    s_and_b64 vcc, exec, vcc
    s_cbranch_vccz K1_PDONE27
    s_sub_u32 s63, s63, 1
    s_cmp_lg_u32 s63, 0
    s_cbranch_scc1 K1_POLL26
K1_PDONE27:
    s_add_u32 s36, s47, 0x2c00
    v_lshrrev_b32_e64 v15, 3, v1
    v_mul_u32_u24 v15, 196608, v15
    v_lshl_add_u32 v15, v20, 2, v15
    s_add_u32 m0, s48, 0
    s_nop 0
    buffer_load_dwordx4 v15, s[4:7], s36 offen offset:0 sc1 lds
    s_add_u32 m0, s48, 928
    s_nop 0
    buffer_load_dwordx4 v15, s[4:7], s36 offen offset:128 sc1 lds
    s_add_u32 m0, s48, 1856
    s_nop 0
    buffer_load_dwordx4 v15, s[4:7], s36 offen offset:256 sc1 lds
    s_add_u32 m0, s48, 2784
    s_nop 0
    buffer_load_dwordx4 v15, s[4:7], s36 offen offset:384 sc1 lds
    s_add_u32 m0, s48, 3712
    s_nop 0
    buffer_load_dwordx4 v15, s[4:7], s36 offen offset:512 sc1 lds
    s_add_u32 m0, s48, 4640
    s_nop 0
    buffer_load_dwordx4 v15, s[4:7], s36 offen offset:640 sc1 lds
    s_add_u32 m0, s48, 5568
    s_nop 0
    buffer_load_dwordx4 v15, s[4:7], s36 offen offset:768 sc1 lds
    s_add_u32 m0, s48, 6496
    s_nop 0
    buffer_load_dwordx4 v15, s[4:7], s36 offen offset:896 sc1 lds
    s_waitcnt lgkmcnt(0)
    s_add_u32 s37, s46, 16384
    buffer_load_dword v22, v20, s[4:7], s37 offen offset:0 sc1
    ds_read_b64_tr_b16 v[200:201], v17 offset:5120
    ds_read_b64_tr_b16 v[202:203], v17 offset:6144
    ds_read_b64_tr_b16 v[204:205], v17 offset:5184
    ds_read_b64_tr_b16 v[206:207], v17 offset:6208
    ds_read_b64_tr_b16 v[208:209], v17 offset:7168
    ds_read_b64_tr_b16 v[210:211], v17 offset:8192
    ds_read_b64_tr_b16 v[212:213], v17 offset:7232
    ds_read_b64_tr_b16 v[214:215], v17 offset:8256
    ds_read_b64_tr_b16 v[216:217], v17 offset:9216
    ds_read_b64_tr_b16 v[218:219], v17 offset:10240
    ds_read_b64_tr_b16 v[220:221], v17 offset:9280
    ds_read_b64_tr_b16 v[222:223], v17 offset:10304
    s_waitcnt vmcnt(1)
    s_barrier
    s_add_u32 s38, s51, 19456
    s_add_u32 s39, s38, 196608
    ds_read_b128 v[84:87], v64 offset:0
    ds_read_b128 v[88:91], v64 offset:16896
    ds_read_b128 v[56:59], v64 offset:64
    ds_read_b128 v[60:63], v64 offset:16960
    s_waitcnt lgkmcnt(2)
    v_mfma_f32_16x16x32_bf16 v[96:99], a[0:3], v[84:87], 0
    ds_read_b128 v[76:79], v64 offset:128
    v_mfma_f32_16x16x32_bf16 v[100:103], a[64:67], v[84:87], 0
    buffer_load_dwordx2 v[72:73], v9, s[4:7], s38 offen offset:128 sc1
    v_mfma_f32_16x16x32_bf16 v[104:107], a[128:131], v[84:87], 0
    ds_read_b128 v[80:83], v64 offset:17024
    s_waitcnt vmcnt(1)
    v_cmp_eq_u32 vcc, -1, v22
    s_nop 0
    s_and_b64 vcc, exec, vcc
    s_cbranch_vccz K1_PDONE29
    s_mov_b32 s63, 524288
K1_POLL28:
    buffer_load_dword v22, v20, s[4:7], s37 offen offset:0 sc1
    s_waitcnt vmcnt(0)
    v_cmp_eq_u32 vcc, -1, v22
    s_nop 0
    s_and_b64 vcc, exec, vcc
    s_cbranch_vccz K1_PDONE29
    s_sub_u32 s63, s63, 1
    s_cmp_lg_u32 s63, 0
    s_cbranch_scc1 K1_POLL28
K1_PDONE29:
    v_mfma_f32_16x16x32_bf16 v[108:111], a[0:3], v[88:91], 0
    buffer_load_dwordx2 v[74:75], v9, s[4:7], s39 offen offset:128 sc1
    s_add_u32 s36, s47, 0x3c00
    v_lshrrev_b32_e64 v15, 3, v1
    v_mul_u32_u24 v15, 196608, v15
    v_lshl_add_u32 v15, v20, 2, v15
    v_mfma_f32_16x16x32_bf16 v[112:115], a[64:67], v[88:91], 0
    v_mfma_f32_16x16x32_bf16 v[116:119], a[128:131], v[88:91], 0
    buffer_load_dwordx2 v[92:93], v9, s[4:7], s38 offen offset:0 sc1
    s_waitcnt lgkmcnt(2)
    v_mfma_f32_16x16x32_bf16 v[96:99], a[4:7], v[56:59], v[96:99]
    ds_read_b128 v[84:87], v64 offset:192
    v_mfma_f32_16x16x32_bf16 v[100:103], a[68:71], v[56:59], v[100:103]
    buffer_load_dwordx2 v[94:95], v9, s[4:7], s39 offen offset:0 sc1
    v_mfma_f32_16x16x32_bf16 v[104:107], a[132:135], v[56:59], v[104:107]
    ds_read_b128 v[88:91], v64 offset:17088
    v_mfma_f32_16x16x32_bf16 v[108:111], a[4:7], v[60:63], v[108:111]
    s_add_u32 m0, s48, 33792
    s_nop 0
    buffer_load_dwordx4 v15, s[4:7], s36 offen offset:0 sc1 lds
    v_mfma_f32_16x16x32_bf16 v[112:115], a[68:71], v[60:63], v[112:115]
    s_add_u32 m0, s48, 34720
    s_nop 0
    buffer_load_dwordx4 v15, s[4:7], s36 offen offset:128 sc1 lds
    v_mfma_f32_16x16x32_bf16 v[116:119], a[132:135], v[60:63], v[116:119]
    s_waitcnt lgkmcnt(2)
    v_mfma_f32_16x16x32_bf16 v[96:99], a[8:11], v[76:79], v[96:99]
    ds_read_b128 v[56:59], v65 offset:0
    v_mfma_f32_16x16x32_bf16 v[100:103], a[72:75], v[76:79], v[100:103]
    s_add_u32 m0, s48, 35648
    s_nop 0
    buffer_load_dwordx4 v15, s[4:7], s36 offen offset:256 sc1 lds
    v_mfma_f32_16x16x32_bf16 v[104:107], a[136:139], v[76:79], v[104:107]
    ds_read_b128 v[60:63], v65 offset:16896
    v_mfma_f32_16x16x32_bf16 v[108:111], a[8:11], v[80:83], v[108:111]
    s_add_u32 m0, s48, 36576
    s_nop 0
    buffer_load_dwordx4 v15, s[4:7], s36 offen offset:384 sc1 lds
    v_mfma_f32_16x16x32_bf16 v[112:115], a[72:75], v[80:83], v[112:115]
    s_add_u32 m0, s48, 37504
    s_nop 0
    buffer_load_dwordx4 v15, s[4:7], s36 offen offset:512 sc1 lds
    v_mfma_f32_16x16x32_bf16 v[116:119], a[136:139], v[80:83], v[116:119]
    s_waitcnt lgkmcnt(2)
    v_mfma_f32_16x16x32_bf16 v[96:99], a[12:15], v[84:87], v[96:99]
    ds_read_b128 v[76:79], v65 offset:64
    v_mfma_f32_16x16x32_bf16 v[100:103], a[76:79], v[84:87], v[100:103]
    s_add_u32 m0, s48, 38432
    s_nop 0
    buffer_load_dwordx4 v15, s[4:7], s36 offen offset:640 sc1 lds
    v_mfma_f32_16x16x32_bf16 v[104:107], a[140:143], v[84:87], v[104:107]
    ds_read_b128 v[80:83], v65 offset:16960
    v_mfma_f32_16x16x32_bf16 v[108:111], a[12:15], v[88:91], v[108:111]
    s_add_u32 m0, s48, 39360
    s_nop 0
    buffer_load_dwordx4 v15, s[4:7], s36 offen offset:768 sc1 lds
    v_mfma_f32_16x16x32_bf16 v[112:115], a[76:79], v[88:91], v[112:115]
    s_add_u32 m0, s48, 40288
    s_nop 0
    buffer_load_dwordx4 v15, s[4:7], s36 offen offset:896 sc1 lds
    v_mfma_f32_16x16x32_bf16 v[116:119], a[140:143], v[88:91], v[116:119]
    s_waitcnt lgkmcnt(2)
    v_mfma_f32_16x16x32_bf16 v[96:99], a[16:19], v[56:59], v[96:99]
    ds_read_b128 v[84:87], v65 offset:128
    v_mfma_f32_16x16x32_bf16 v[100:103], a[80:83], v[56:59], v[100:103]
    v_mfma_f32_16x16x32_bf16 v[104:107], a[144:147], v[56:59], v[104:107]
    ds_read_b128 v[88:91], v65 offset:17024
    v_mfma_f32_16x16x32_bf16 v[108:111], a[16:19], v[60:63], v[108:111]
    v_mfma_f32_16x16x32_bf16 v[112:115], a[80:83], v[60:63], v[112:115]
    v_mfma_f32_16x16x32_bf16 v[116:119], a[144:147], v[60:63], v[116:119]
    s_waitcnt lgkmcnt(2)
    v_mfma_f32_16x16x32_bf16 v[96:99], a[20:23], v[76:79], v[96:99]
    ds_read_b128 v[56:59], v65 offset:192
    v_mfma_f32_16x16x32_bf16 v[100:103], a[84:87], v[76:79], v[100:103]
    v_mfma_f32_16x16x32_bf16 v[104:107], a[148:151], v[76:79], v[104:107]
    ds_read_b128 v[60:63], v65 offset:17088
    v_mfma_f32_16x16x32_bf16 v[108:111], a[20:23], v[80:83], v[108:111]
    v_mfma_f32_16x16x32_bf16 v[112:115], a[84:87], v[80:83], v[112:115]
    v_mfma_f32_16x16x32_bf16 v[116:119], a[148:151], v[80:83], v[116:119]
    s_waitcnt lgkmcnt(2)
    v_mfma_f32_16x16x32_bf16 v[96:99], a[24:27], v[84:87], v[96:99]
    ds_read_b128 v[76:79], v66 offset:0
    v_mfma_f32_16x16x32_bf16 v[100:103], a[88:91], v[84:87], v[100:103]
    v_mfma_f32_16x16x32_bf16 v[104:107], a[152:155], v[84:87], v[104:107]
    ds_read_b128 v[80:83], v66 offset:16896
    v_mfma_f32_16x16x32_bf16 v[108:111], a[24:27], v[88:91], v[108:111]
    v_mfma_f32_16x16x32_bf16 v[112:115], a[88:91], v[88:91], v[112:115]
    s_waitcnt vmcnt(10)
    v_add_f32 v72, v72, v74
    v_mfma_f32_16x16x32_bf16 v[116:119], a[152:155], v[88:91], v[116:119]
    v_add_f32 v73, v73, v75
    s_waitcnt lgkmcnt(2)
    v_mfma_f32_16x16x32_bf16 v[96:99], a[28:31], v[56:59], v[96:99]
    ds_read_b128 v[84:87], v66 offset:64
    v_mov_b32_e64 v74, v72
    v_mfma_f32_16x16x32_bf16 v[100:103], a[92:95], v[56:59], v[100:103]
    s_add_u32 s3, s3, 16384
    s_cmp_eq_u32 s3, s95
    s_cselect_b32 s39, 360448, 0
    s_sub_u32 s3, s3, s39
    v_add_u32_e64 v18, s3, v253
    s_add_u32 m0, s91, 11264
    v_add_u32 v19, 7168, v18
    buffer_load_dwordx4 v18, s[96:99], 0 offen lds
    buffer_load_dwordx4 v19, s[96:99], 0 offen offset:1024 lds
    v_mfma_f32_16x16x32_bf16 v[104:107], a[156:159], v[56:59], v[104:107]
    ds_read_b128 v[88:91], v66 offset:16960
    v_mov_b32_e64 v75, v73
    v_mfma_f32_16x16x32_bf16 v[108:111], a[28:31], v[60:63], v[108:111]
    v_permlane32_swap_b32_e64 v74, v72
    v_mfma_f32_16x16x32_bf16 v[112:115], a[92:95], v[60:63], v[112:115]
    v_permlane32_swap_b32_e64 v75, v73
    v_mfma_f32_16x16x32_bf16 v[116:119], a[156:159], v[60:63], v[116:119]
    v_add_f32 v72, v72, v74
    s_waitcnt lgkmcnt(2)
    v_mfma_f32_16x16x32_bf16 v[96:99], a[32:35], v[76:79], v[96:99]
    ds_read_b128 v[56:59], v66 offset:128
    v_add_f32_e64 v73, v73, v75
    v_mfma_f32_16x16x32_bf16 v[100:103], a[96:99], v[76:79], v[100:103]
    v_mov_b32_e64 v74, v72
    v_mfma_f32_16x16x32_bf16 v[104:107], a[160:163], v[76:79], v[104:107]
    ds_read_b128 v[60:63], v66 offset:17024
    v_mfma_f32_16x16x32_bf16 v[108:111], a[32:35], v[80:83], v[108:111]
    v_mov_b32_e64 v75, v73
    v_mfma_f32_16x16x32_bf16 v[112:115], a[96:99], v[80:83], v[112:115]
    v_permlane16_swap_b32_e64 v74, v72
    v_mfma_f32_16x16x32_bf16 v[116:119], a[160:163], v[80:83], v[116:119]
    v_permlane16_swap_b32 v75, v73
    s_waitcnt lgkmcnt(2)
    v_mfma_f32_16x16x32_bf16 v[96:99], a[36:39], v[84:87], v[96:99]
    ds_read_b128 v[76:79], v66 offset:192
    s_add_u32 s3, s3, 16384
    s_cmp_eq_u32 s3, s95
    s_cselect_b32 s39, 360448, 0
    s_sub_u32 s3, s3, s39
    v_add_u32_e64 v18, s3, v253
    s_add_u32 m0, s91, 13312
    v_add_u32 v19, 7168, v18
    buffer_load_dwordx4 v18, s[96:99], 0 offen lds
    buffer_load_dwordx4 v19, s[96:99], 0 offen offset:1024 lds
    v_mfma_f32_16x16x32_bf16 v[100:103], a[100:103], v[84:87], v[100:103]
    v_add_f32 v72, v72, v74
    v_add_f32 v73, v73, v75
    v_mfma_f32_16x16x32_bf16 v[104:107], a[164:167], v[84:87], v[104:107]
    ds_read_b128 v[80:83], v66 offset:17088
    v_mfma_f32_16x16x32_bf16 v[108:111], a[36:39], v[88:91], v[108:111]
    v_mul_f32_e64 v72, s62, v72
    v_mfma_f32_16x16x32_bf16 v[112:115], a[100:103], v[88:91], v[112:115]
    v_mul_f32_e64 v73, s62, v73
    v_mfma_f32_16x16x32_bf16 v[116:119], a[164:167], v[88:91], v[116:119]
    v_fma_f32 v73, -v72, v72, v73
    s_waitcnt lgkmcnt(2)
    v_mfma_f32_16x16x32_bf16 v[96:99], a[40:43], v[56:59], v[96:99]
    ds_read_b128 v[84:87], v67 offset:0
    v_max_f32 v73, 0, v73
    v_mfma_f32_16x16x32_bf16 v[100:103], a[104:107], v[56:59], v[100:103]
    v_mfma_f32_16x16x32_bf16 v[104:107], a[168:171], v[56:59], v[104:107]
    ds_read_b128 v[88:91], v67 offset:16896
    v_add_f32 v73, 0x3727c5ac, v73
    v_mfma_f32_16x16x32_bf16 v[108:111], a[40:43], v[60:63], v[108:111]
    v_rsq_f32_e64 v70, v73
    v_mfma_f32_16x16x32_bf16 v[112:115], a[104:107], v[60:63], v[112:115]
    v_mul_f32_e64 v72, -1.0, v72
    v_mfma_f32_16x16x32_bf16 v[116:119], a[168:171], v[60:63], v[116:119]
    s_add_u32 s3, s3, 16384
    s_cmp_eq_u32 s3, s95
    s_cselect_b32 s39, 360448, 0
    s_sub_u32 s3, s3, s39
    v_add_u32 v18, s3, v253
    s_add_u32 m0, s91, 0
    v_add_u32 v19, 7168, v18
    buffer_load_dwordx4 v18, s[96:99], 0 offen lds
    buffer_load_dwordx4 v19, s[96:99], 0 offen offset:1024 lds
    s_waitcnt lgkmcnt(2)
    v_mfma_f32_16x16x32_bf16 v[96:99], a[44:47], v[76:79], v[96:99]
    ds_read_b128 v[56:59], v67 offset:64
    v_mul_f32 v71, v72, v70
    v_mfma_f32_16x16x32_bf16 v[100:103], a[108:111], v[76:79], v[100:103]
    s_waitcnt vmcnt(14)
    v_add_f32 v92, v92, v94
    v_mfma_f32_16x16x32_bf16 v[104:107], a[172:175], v[76:79], v[104:107]
    ds_read_b128 v[60:63], v67 offset:16960
    v_add_f32_e64 v93, v93, v95
    v_mfma_f32_16x16x32_bf16 v[108:111], a[44:47], v[80:83], v[108:111]
    v_mov_b32_e64 v94, v92
    v_mfma_f32_16x16x32_bf16 v[112:115], a[108:111], v[80:83], v[112:115]
    v_mov_b32_e64 v95, v93
    v_mfma_f32_16x16x32_bf16 v[116:119], a[172:175], v[80:83], v[116:119]
    v_permlane32_swap_b32 v94, v92
    s_waitcnt lgkmcnt(2)
    v_mfma_f32_16x16x32_bf16 v[96:99], a[48:51], v[84:87], v[96:99]
    ds_read_b128 v[76:79], v67 offset:128
    v_mfma_f32_16x16x32_bf16 v[100:103], a[112:115], v[84:87], v[100:103]
    v_permlane32_swap_b32_e64 v95, v93
    v_mfma_f32_16x16x32_bf16 v[104:107], a[176:179], v[84:87], v[104:107]
    ds_read_b128 v[80:83], v67 offset:17024
    v_add_f32_e64 v92, v92, v94
    v_mfma_f32_16x16x32_bf16 v[108:111], a[48:51], v[88:91], v[108:111]
    v_add_f32_e64 v93, v93, v95
    v_mfma_f32_16x16x32_bf16 v[112:115], a[112:115], v[88:91], v[112:115]
    s_add_u32 s3, s3, 16384
    s_cmp_eq_u32 s3, s95
    s_cselect_b32 s39, 360448, 0
    s_sub_u32 s3, s3, s39
    v_add_u32_e64 v18, s3, v253
    s_add_u32 m0, s91, 3072
    v_add_u32 v19, 7168, v18
    buffer_load_dwordx4 v18, s[96:99], 0 offen lds
    buffer_load_dwordx4 v19, s[96:99], 0 offen offset:1024 lds
    v_mfma_f32_16x16x32_bf16 v[116:119], a[176:179], v[88:91], v[116:119]
    v_mov_b32 v94, v92
    s_waitcnt lgkmcnt(2)
    v_mfma_f32_16x16x32_bf16 v[96:99], a[52:55], v[56:59], v[96:99]
    ds_read_b128 v[84:87], v67 offset:192
    v_mov_b32_e64 v95, v93
    v_mfma_f32_16x16x32_bf16 v[100:103], a[116:119], v[56:59], v[100:103]
    v_permlane16_swap_b32_e64 v94, v92
    v_mfma_f32_16x16x32_bf16 v[104:107], a[180:183], v[56:59], v[104:107]
    ds_read_b128 v[88:91], v67 offset:17088
    v_permlane16_swap_b32_e64 v95, v93
    v_mfma_f32_16x16x32_bf16 v[108:111], a[52:55], v[60:63], v[108:111]
    v_add_f32_e64 v92, v92, v94
    v_mfma_f32_16x16x32_bf16 v[112:115], a[116:119], v[60:63], v[112:115]
    v_add_f32_e64 v93, v93, v95
    v_mfma_f32_16x16x32_bf16 v[116:119], a[180:183], v[60:63], v[116:119]
    s_waitcnt lgkmcnt(2)
    v_mfma_f32_16x16x32_bf16 v[96:99], a[56:59], v[76:79], v[96:99]
    v_mul_f32 v92, s62, v92
    v_mfma_f32_16x16x32_bf16 v[100:103], a[120:123], v[76:79], v[100:103]
    ds_read_b128 v[136:139], v12 offset:0
    v_mul_f32_e64 v93, s62, v93
    v_mfma_f32_16x16x32_bf16 v[104:107], a[184:187], v[76:79], v[104:107]
    v_fma_f32 v93, -v92, v92, v93
    v_mfma_f32_16x16x32_bf16 v[108:111], a[56:59], v[80:83], v[108:111]
    ds_read_b128 v[140:143], v12 offset:16
    v_max_f32_e64 v93, 0, v93
    v_mfma_f32_16x16x32_bf16 v[112:115], a[120:123], v[80:83], v[112:115]
    s_add_u32 s37, s42, 0
    buffer_load_dword v14, v20, s[4:7], s37 offen offset:0 sc1
    v_mfma_f32_16x16x32_bf16 v[116:119], a[184:187], v[80:83], v[116:119]
    v_add_f32 v93, 0x3727c5ac, v93
    s_waitcnt lgkmcnt(2)
    v_mfma_f32_16x16x32_bf16 v[96:99], a[60:63], v[84:87], v[96:99]
    s_add_u32 s37, s42, 16384
    buffer_load_dword v14, v20, s[4:7], s37 offen offset:0 sc1
    v_mfma_f32_16x16x32_bf16 v[100:103], a[124:127], v[84:87], v[100:103]
    s_add_u32 s37, s42, 32768
    buffer_load_dword v14, v20, s[4:7], s37 offen offset:0 sc1
    v_mfma_f32_16x16x32_bf16 v[104:107], a[188:191], v[84:87], v[104:107]
    s_add_u32 s37, s42, 49152
    buffer_load_dword v14, v20, s[4:7], s37 offen offset:0 sc1
    v_mfma_f32_16x16x32_bf16 v[108:111], a[60:63], v[88:91], v[108:111]
    s_add_u32 s37, s46, 32768
    buffer_load_dword v14, v20, s[4:7], s37 offen offset:0 sc1
    v_mfma_f32_16x16x32_bf16 v[112:115], a[124:127], v[88:91], v[112:115]
    s_add_u32 s37, s46, 49152
    buffer_load_dword v14, v20, s[4:7], s37 offen offset:0 sc1
    v_mfma_f32_16x16x32_bf16 v[116:119], a[188:191], v[88:91], v[116:119]
    s_add_u32 s37, s44, 131072
    buffer_load_dwordx2 v[14:15], v6, s[4:7], s37 offen offset:0 sc1
    buffer_load_dwordx2 v[14:15], v6, s[4:7], s37 offen offset:2048 sc1
    v_rsq_f32 v68, v93
    v_mul_f32 v92, -1.0, v92
    v_mul_f32_e64 v69, v92, v68
    s_add_u32 s35, s40, 0
    s_cmp_eq_u32 s16, 3
    s_cselect_b32 s39, s90, s35
    s_waitcnt lgkmcnt(0)
    v_pk_fma_f32 v[120:121], v[68:69], v[140:141], v[136:137] op_sel:[1,0,0] op_sel_hi:[1,1,1]
    v_pk_fma_f32 v[122:123], v[68:69], v[142:143], v[138:139] op_sel:[1,0,0] op_sel_hi:[1,1,1]
    v_pk_fma_f32 v[124:125], v[70:71], v[140:141], v[136:137] op_sel:[1,0,0] op_sel_hi:[1,1,1]
    v_pk_fma_f32 v[126:127], v[70:71], v[142:143], v[138:139] op_sel:[1,0,0] op_sel_hi:[1,1,1]
    ds_read_b128 v[136:139], v12 offset:128
    ds_read_b128 v[140:143], v12 offset:144
    v_pk_fma_f32 v[120:121], v[68:69], v[96:97], v[120:121] op_sel_hi:[0,1,1]
    v_pk_fma_f32 v[122:123], v[68:69], v[98:99], v[122:123] op_sel_hi:[0,1,1]
    v_pk_fma_f32 v[124:125], v[70:71], v[108:109], v[124:125] op_sel_hi:[0,1,1]
    v_pk_fma_f32 v[126:127], v[70:71], v[110:111], v[126:127] op_sel_hi:[0,1,1]
    v_pk_mul_f32 v[128:129], v[120:121], v[120:121]
    v_pk_mul_f32 v[130:131], v[122:123], v[122:123]
    v_pk_mul_f32 v[132:133], v[124:125], v[124:125]
    v_pk_mul_f32 v[134:135], v[126:127], v[126:127]
    v_pk_fma_f32 v[128:129], v[128:129], s[58:59], v[0:1] op_sel_hi:[1,1,0]
    v_pk_fma_f32 v[130:131], v[130:131], s[58:59], v[0:1] op_sel_hi:[1,1,0]
    v_pk_fma_f32 v[132:133], v[132:133], s[58:59], v[0:1] op_sel_hi:[1,1,0]
    v_pk_fma_f32 v[134:135], v[134:135], s[58:59], v[0:1] op_sel_hi:[1,1,0]
    v_pk_mul_f32 v[128:129], v[120:121], v[128:129]
    v_pk_mul_f32 v[130:131], v[122:123], v[130:131]
    v_pk_mul_f32 v[132:133], v[124:125], v[132:133]
    v_pk_mul_f32 v[134:135], v[126:127], v[134:135]
    v_exp_f32 v128, v128
    v_exp_f32 v129, v129
    v_exp_f32 v130, v130
    v_exp_f32 v131, v131
    v_exp_f32 v132, v132
    v_exp_f32 v133, v133
    v_exp_f32 v134, v134
    v_exp_f32 v135, v135
    v_pk_add_f32 v[128:129], v[128:129], 1.0 op_sel_hi:[1,0]
    v_pk_add_f32 v[130:131], v[130:131], 1.0 op_sel_hi:[1,0]
    v_pk_add_f32 v[132:133], v[132:133], 1.0 op_sel_hi:[1,0]
    v_pk_add_f32 v[134:135], v[134:135], 1.0 op_sel_hi:[1,0]
    v_rcp_f32 v128, v128
    v_rcp_f32 v129, v129
    v_rcp_f32 v130, v130
    v_rcp_f32 v131, v131
    v_rcp_f32 v132, v132
    v_rcp_f32 v133, v133
    v_rcp_f32 v134, v134
    v_rcp_f32 v135, v135
    v_pk_mul_f32 v[120:121], v[120:121], v[128:129]
    v_pk_mul_f32 v[122:123], v[122:123], v[130:131]
    v_pk_mul_f32 v[124:125], v[124:125], v[132:133]
    v_pk_mul_f32 v[126:127], v[126:127], v[134:135]
    v_cvt_pk_bf16_f32 v128, v120, v121
    v_cvt_pk_bf16_f32 v129, v122, v123
    v_cvt_pk_bf16_f32 v130, v124, v125
    v_cvt_pk_bf16_f32 v131, v126, v127
    s_nop 0
    v_permlane32_swap_b32 v128, v130
    v_permlane32_swap_b32_e64 v129, v131
    buffer_store_dwordx4 v[128:131], v2, s[4:7], s35 offen offset:0
    s_waitcnt lgkmcnt(0)
    v_pk_fma_f32 v[120:121], v[68:69], v[140:141], v[136:137] op_sel:[1,0,0] op_sel_hi:[1,1,1]
    v_pk_fma_f32 v[122:123], v[68:69], v[142:143], v[138:139] op_sel:[1,0,0] op_sel_hi:[1,1,1]
    v_pk_fma_f32 v[124:125], v[70:71], v[140:141], v[136:137] op_sel:[1,0,0] op_sel_hi:[1,1,1]
    v_pk_fma_f32 v[126:127], v[70:71], v[142:143], v[138:139] op_sel:[1,0,0] op_sel_hi:[1,1,1]
    ds_read_b128 v[136:139], v12 offset:256
    ds_read_b128 v[140:143], v12 offset:272
    v_pk_fma_f32 v[120:121], v[68:69], v[100:101], v[120:121] op_sel_hi:[0,1,1]
    v_pk_fma_f32 v[122:123], v[68:69], v[102:103], v[122:123] op_sel_hi:[0,1,1]
    v_pk_fma_f32 v[124:125], v[70:71], v[112:113], v[124:125] op_sel_hi:[0,1,1]
    v_pk_fma_f32 v[126:127], v[70:71], v[114:115], v[126:127] op_sel_hi:[0,1,1]
    v_pk_mul_f32 v[128:129], v[120:121], v[120:121]
    v_pk_mul_f32 v[130:131], v[122:123], v[122:123]
    v_pk_mul_f32 v[132:133], v[124:125], v[124:125]
    v_pk_mul_f32 v[134:135], v[126:127], v[126:127]
    v_pk_fma_f32 v[128:129], v[128:129], s[58:59], v[0:1] op_sel_hi:[1,1,0]
    v_pk_fma_f32 v[130:131], v[130:131], s[58:59], v[0:1] op_sel_hi:[1,1,0]
    v_pk_fma_f32 v[132:133], v[132:133], s[58:59], v[0:1] op_sel_hi:[1,1,0]
    v_pk_fma_f32 v[134:135], v[134:135], s[58:59], v[0:1] op_sel_hi:[1,1,0]
    v_pk_mul_f32 v[128:129], v[120:121], v[128:129]
    v_pk_mul_f32 v[130:131], v[122:123], v[130:131]
    v_pk_mul_f32 v[132:133], v[124:125], v[132:133]
    v_pk_mul_f32 v[134:135], v[126:127], v[134:135]
    v_exp_f32 v128, v128
    v_exp_f32 v129, v129
    v_exp_f32 v130, v130
    v_exp_f32 v131, v131
    v_exp_f32 v132, v132
    v_exp_f32 v133, v133
    v_exp_f32 v134, v134
    v_exp_f32_e64 v135, v135
    v_pk_add_f32 v[128:129], v[128:129], 1.0 op_sel_hi:[1,0]
    v_pk_add_f32 v[130:131], v[130:131], 1.0 op_sel_hi:[1,0]
    v_pk_add_f32 v[132:133], v[132:133], 1.0 op_sel_hi:[1,0]
    v_pk_add_f32 v[134:135], v[134:135], 1.0 op_sel_hi:[1,0]
    v_rcp_f32 v128, v128
    v_rcp_f32 v129, v129
    v_rcp_f32 v130, v130
    v_rcp_f32 v131, v131
    v_rcp_f32 v132, v132
    v_rcp_f32 v133, v133
    v_rcp_f32 v134, v134
    v_rcp_f32 v135, v135
    v_pk_mul_f32 v[120:121], v[120:121], v[128:129]
    v_pk_mul_f32 v[122:123], v[122:123], v[130:131]
    v_pk_mul_f32 v[124:125], v[124:125], v[132:133]
    v_pk_mul_f32 v[126:127], v[126:127], v[134:135]
    v_cvt_pk_bf16_f32 v128, v120, v121
    v_cvt_pk_bf16_f32 v129, v122, v123
    v_cvt_pk_bf16_f32 v130, v124, v125
    v_cvt_pk_bf16_f32 v131, v126, v127
    s_nop 0
    v_permlane32_swap_b32 v128, v130
    v_permlane32_swap_b32_e64 v129, v131
    buffer_store_dwordx4 v[128:131], v2, s[4:7], s35 offen offset:1024
    s_waitcnt lgkmcnt(0)
    v_pk_fma_f32 v[120:121], v[68:69], v[140:141], v[136:137] op_sel:[1,0,0] op_sel_hi:[1,1,1]
    v_pk_fma_f32 v[122:123], v[68:69], v[142:143], v[138:139] op_sel:[1,0,0] op_sel_hi:[1,1,1]
    v_pk_fma_f32 v[124:125], v[70:71], v[140:141], v[136:137] op_sel:[1,0,0] op_sel_hi:[1,1,1]
    v_pk_fma_f32 v[126:127], v[70:71], v[142:143], v[138:139] op_sel:[1,0,0] op_sel_hi:[1,1,1]
    v_pk_fma_f32 v[120:121], v[68:69], v[104:105], v[120:121] op_sel_hi:[0,1,1]
    v_pk_fma_f32 v[122:123], v[68:69], v[106:107], v[122:123] op_sel_hi:[0,1,1]
    v_pk_fma_f32 v[124:125], v[70:71], v[116:117], v[124:125] op_sel_hi:[0,1,1]
    v_pk_fma_f32 v[126:127], v[70:71], v[118:119], v[126:127] op_sel_hi:[0,1,1]
    v_pk_mul_f32 v[128:129], v[120:121], v[120:121]
    v_pk_mul_f32 v[130:131], v[122:123], v[122:123]
    v_pk_mul_f32 v[132:133], v[124:125], v[124:125]
    v_pk_mul_f32 v[134:135], v[126:127], v[126:127]
    v_pk_fma_f32 v[128:129], v[128:129], s[58:59], v[0:1] op_sel_hi:[1,1,0]
    s_waitcnt vmcnt(18)
    s_barrier
    ds_read_b128 v[84:87], v64 offset:33792
    ds_read_b128 v[88:91], v64 offset:50688
    ds_read_b128 v[56:59], v64 offset:33856
    ds_read_b128 v[60:63], v64 offset:50752
    v_pk_fma_f32 v[130:131], v[130:131], s[58:59], v[0:1] op_sel_hi:[1,1,0]
    v_pk_fma_f32 v[132:133], v[132:133], s[58:59], v[0:1] op_sel_hi:[1,1,0]
    v_pk_fma_f32 v[134:135], v[134:135], s[58:59], v[0:1] op_sel_hi:[1,1,0]
    v_pk_mul_f32 v[128:129], v[120:121], v[128:129]
    v_pk_mul_f32 v[130:131], v[122:123], v[130:131]
    v_pk_mul_f32 v[132:133], v[124:125], v[132:133]
    v_pk_mul_f32 v[134:135], v[126:127], v[134:135]
    v_exp_f32 v128, v128
    v_exp_f32 v129, v129
    v_exp_f32 v130, v130
    v_exp_f32 v131, v131
    v_exp_f32 v132, v132
    v_exp_f32 v133, v133
    v_exp_f32 v134, v134
    v_exp_f32_e64 v135, v135
    v_pk_add_f32 v[128:129], v[128:129], 1.0 op_sel_hi:[1,0]
    v_pk_add_f32 v[130:131], v[130:131], 1.0 op_sel_hi:[1,0]
    v_pk_add_f32 v[132:133], v[132:133], 1.0 op_sel_hi:[1,0]
    v_pk_add_f32 v[134:135], v[134:135], 1.0 op_sel_hi:[1,0]
    v_rcp_f32 v128, v128
    v_rcp_f32 v129, v129
    v_rcp_f32 v130, v130
    v_rcp_f32 v131, v131
    v_rcp_f32 v132, v132
    v_rcp_f32 v133, v133
    v_rcp_f32 v134, v134
    v_rcp_f32 v135, v135
    v_pk_mul_f32 v[120:121], v[120:121], v[128:129]
    v_pk_mul_f32 v[122:123], v[122:123], v[130:131]
    v_pk_mul_f32 v[124:125], v[124:125], v[132:133]
    v_pk_mul_f32 v[126:127], v[126:127], v[134:135]
    v_cvt_pk_bf16_f32 v128, v120, v121
    v_cvt_pk_bf16_f32 v129, v122, v123
    v_cvt_pk_bf16_f32 v130, v124, v125
    v_cvt_pk_bf16_f32 v131, v126, v127
    s_nop 0
    v_permlane32_swap_b32 v128, v130
    v_permlane32_swap_b32_e64 v129, v131
    buffer_store_dwordx4 v[128:131], v2, s[4:7], s39 offen offset:2048
    s_add_u32 s38, s51, 19712
    s_add_u32 s39, s38, 196608
    s_waitcnt lgkmcnt(2)
    v_mfma_f32_16x16x32_bf16 v[32:35], a[0:3], v[84:87], 0
    ds_read_b128 v[76:79], v64 offset:33920
    v_mfma_f32_16x16x32_bf16 v[36:39], a[64:67], v[84:87], 0
    buffer_load_dwordx2 v[72:73], v9, s[4:7], s38 offen offset:128 sc1
    v_mfma_f32_16x16x32_bf16 v[40:43], a[128:131], v[84:87], 0
    ds_read_b128 v[80:83], v64 offset:50816
    v_mfma_f32_16x16x32_bf16 v[44:47], a[0:3], v[88:91], 0
    buffer_load_dwordx2 v[74:75], v9, s[4:7], s39 offen offset:128 sc1
    v_mfma_f32_16x16x32_bf16 v[48:51], a[64:67], v[88:91], 0
    v_mfma_f32_16x16x32_bf16 v[52:55], a[128:131], v[88:91], 0
    buffer_load_dwordx2 v[92:93], v9, s[4:7], s38 offen offset:0 sc1
    s_waitcnt lgkmcnt(2)
    v_mfma_f32_16x16x32_bf16 v[32:35], a[4:7], v[56:59], v[32:35]
    ds_read_b128 v[84:87], v64 offset:33984
    v_mfma_f32_16x16x32_bf16 v[36:39], a[68:71], v[56:59], v[36:39]
    buffer_load_dwordx2 v[94:95], v9, s[4:7], s39 offen offset:0 sc1
    v_mfma_f32_16x16x32_bf16 v[40:43], a[132:135], v[56:59], v[40:43]
    ds_read_b128 v[88:91], v64 offset:50880
    v_mfma_f32_16x16x32_bf16 v[44:47], a[4:7], v[60:63], v[44:47]
    v_mfma_f32_16x16x32_bf16 v[48:51], a[68:71], v[60:63], v[48:51]
    v_mfma_f32_16x16x32_bf16 v[52:55], a[132:135], v[60:63], v[52:55]
    s_waitcnt lgkmcnt(2)
    v_mfma_f32_16x16x32_bf16 v[32:35], a[8:11], v[76:79], v[32:35]
    ds_read_b128 v[56:59], v65 offset:33792
    v_mfma_f32_16x16x32_bf16 v[36:39], a[72:75], v[76:79], v[36:39]
    v_mfma_f32_16x16x32_bf16 v[40:43], a[136:139], v[76:79], v[40:43]
    ds_read_b128 v[60:63], v65 offset:50688
    v_mfma_f32_16x16x32_bf16 v[44:47], a[8:11], v[80:83], v[44:47]
    v_mfma_f32_16x16x32_bf16 v[48:51], a[72:75], v[80:83], v[48:51]
    v_mfma_f32_16x16x32_bf16 v[52:55], a[136:139], v[80:83], v[52:55]
    s_waitcnt lgkmcnt(2)
    v_mfma_f32_16x16x32_bf16 v[32:35], a[12:15], v[84:87], v[32:35]
    ds_read_b128 v[76:79], v65 offset:33856
    v_mfma_f32_16x16x32_bf16 v[36:39], a[76:79], v[84:87], v[36:39]
    v_mfma_f32_16x16x32_bf16 v[40:43], a[140:143], v[84:87], v[40:43]
    ds_read_b128 v[80:83], v65 offset:50752
    v_mfma_f32_16x16x32_bf16 v[44:47], a[12:15], v[88:91], v[44:47]
    v_mfma_f32_16x16x32_bf16 v[48:51], a[76:79], v[88:91], v[48:51]
    v_mfma_f32_16x16x32_bf16 v[52:55], a[140:143], v[88:91], v[52:55]
    s_waitcnt lgkmcnt(2)
    v_mfma_f32_16x16x32_bf16 v[32:35], a[16:19], v[56:59], v[32:35]
    ds_read_b128 v[84:87], v65 offset:33920
    v_mfma_f32_16x16x32_bf16 v[36:39], a[80:83], v[56:59], v[36:39]
    v_mfma_f32_16x16x32_bf16 v[40:43], a[144:147], v[56:59], v[40:43]
    ds_read_b128 v[88:91], v65 offset:50816
    v_mfma_f32_16x16x32_bf16 v[44:47], a[16:19], v[60:63], v[44:47]
    v_mfma_f32_16x16x32_bf16 v[48:51], a[80:83], v[60:63], v[48:51]
    v_mfma_f32_16x16x32_bf16 v[52:55], a[144:147], v[60:63], v[52:55]
    s_waitcnt lgkmcnt(2)
    v_mfma_f32_16x16x32_bf16 v[32:35], a[20:23], v[76:79], v[32:35]
    ds_read_b128 v[56:59], v65 offset:33984
    v_mfma_f32_16x16x32_bf16 v[36:39], a[84:87], v[76:79], v[36:39]
    v_mfma_f32_16x16x32_bf16 v[40:43], a[148:151], v[76:79], v[40:43]
    ds_read_b128 v[60:63], v65 offset:50880
    s_waitcnt vmcnt(4)
    s_add_u32 s36, s41, 0
    s_mov_b64 exec, 1
    buffer_store_dword v8, v8, s[4:7], s36 offen offset:0
    s_mov_b64 exec, -1
    v_mfma_f32_16x16x32_bf16 v[44:47], a[20:23], v[80:83], v[44:47]
    v_mfma_f32_16x16x32_bf16 v[48:51], a[84:87], v[80:83], v[48:51]
    v_mfma_f32_16x16x32_bf16 v[52:55], a[148:151], v[80:83], v[52:55]
    s_waitcnt lgkmcnt(2)
    v_mfma_f32_16x16x32_bf16 v[32:35], a[24:27], v[84:87], v[32:35]
    ds_read_b128 v[76:79], v66 offset:33792
    v_mfma_f32_16x16x32_bf16 v[36:39], a[88:91], v[84:87], v[36:39]
    v_mfma_f32_16x16x32_bf16 v[40:43], a[152:155], v[84:87], v[40:43]
    ds_read_b128 v[80:83], v66 offset:50688
    v_mfma_f32_16x16x32_bf16 v[44:47], a[24:27], v[88:91], v[44:47]
    v_mfma_f32_16x16x32_bf16 v[48:51], a[88:91], v[88:91], v[48:51]
    s_waitcnt vmcnt(3)
    v_add_f32_e64 v72, v72, v74
    v_mfma_f32_16x16x32_bf16 v[52:55], a[152:155], v[88:91], v[52:55]
    v_add_f32 v73, v73, v75
    s_waitcnt lgkmcnt(2)
    v_mfma_f32_16x16x32_bf16 v[32:35], a[28:31], v[56:59], v[32:35]
    ds_read_b128 v[84:87], v66 offset:33856
    v_mov_b32_e64 v74, v72
    v_mfma_f32_16x16x32_bf16 v[36:39], a[92:95], v[56:59], v[36:39]
    v_mov_b32_e64 v75, v73
    v_mfma_f32_16x16x32_bf16 v[40:43], a[156:159], v[56:59], v[40:43]
    ds_read_b128 v[88:91], v66 offset:50752
    v_permlane32_swap_b32_e64 v74, v72
    v_mfma_f32_16x16x32_bf16 v[44:47], a[28:31], v[60:63], v[44:47]
    v_mfma_f32_16x16x32_bf16 v[48:51], a[92:95], v[60:63], v[48:51]
    v_permlane32_swap_b32_e64 v75, v73
    v_mfma_f32_16x16x32_bf16 v[52:55], a[156:159], v[60:63], v[52:55]
    v_add_f32 v72, v72, v74
    s_waitcnt lgkmcnt(2)
    v_mfma_f32_16x16x32_bf16 v[32:35], a[32:35], v[76:79], v[32:35]
    ds_read_b128 v[56:59], v66 offset:33920
    v_add_f32_e64 v73, v73, v75
    v_mfma_f32_16x16x32_bf16 v[36:39], a[96:99], v[76:79], v[36:39]
    v_mov_b32_e64 v74, v72
    v_mfma_f32_16x16x32_bf16 v[40:43], a[160:163], v[76:79], v[40:43]
    ds_read_b128 v[60:63], v66 offset:50816
    v_mfma_f32_16x16x32_bf16 v[44:47], a[32:35], v[80:83], v[44:47]
    v_mov_b32_e64 v75, v73
    v_mfma_f32_16x16x32_bf16 v[48:51], a[96:99], v[80:83], v[48:51]
    s_add_u32 s37, s42, 0
    buffer_load_dword v22, v20, s[4:7], s37 offen offset:0 sc1
    s_add_u32 s36, s49, 0
    v_add_u32_e64 v21, s36, v11
    v_mfma_f32_16x16x32_bf16 v[52:55], a[160:163], v[80:83], v[52:55]
    v_permlane16_swap_b32 v74, v72
    s_waitcnt lgkmcnt(2)
    v_mfma_f32_16x16x32_bf16 v[32:35], a[36:39], v[84:87], v[32:35]
    ds_read_b128 v[76:79], v66 offset:33984
    v_permlane16_swap_b32_e64 v75, v73
    v_mfma_f32_16x16x32_bf16 v[36:39], a[100:103], v[84:87], v[36:39]
    v_add_f32 v72, v72, v74
    v_add_f32 v73, v73, v75
    v_mfma_f32_16x16x32_bf16 v[40:43], a[164:167], v[84:87], v[40:43]
    ds_read_b128 v[80:83], v66 offset:50880
    v_mfma_f32_16x16x32_bf16 v[44:47], a[36:39], v[88:91], v[44:47]
    v_mul_f32_e64 v72, s62, v72
    v_mfma_f32_16x16x32_bf16 v[48:51], a[100:103], v[88:91], v[48:51]
    v_mul_f32_e64 v73, s62, v73
    v_mfma_f32_16x16x32_bf16 v[52:55], a[164:167], v[88:91], v[52:55]
    v_fma_f32 v73, -v72, v72, v73
    s_waitcnt lgkmcnt(2)
    v_mfma_f32_16x16x32_bf16 v[32:35], a[40:43], v[56:59], v[32:35]
    ds_read_b128 v[84:87], v67 offset:33792
    v_max_f32 v73, 0, v73
    v_mfma_f32_16x16x32_bf16 v[36:39], a[104:107], v[56:59], v[36:39]
    v_mfma_f32_16x16x32_bf16 v[40:43], a[168:171], v[56:59], v[40:43]
    ds_read_b128 v[88:91], v67 offset:50688
    v_add_f32 v73, 0x3727c5ac, v73
    v_mfma_f32_16x16x32_bf16 v[44:47], a[40:43], v[60:63], v[44:47]
    v_rsq_f32_e64 v74, v73
    v_mfma_f32_16x16x32_bf16 v[48:51], a[104:107], v[60:63], v[48:51]
    v_mul_f32_e64 v72, -1.0, v72
    v_mfma_f32_16x16x32_bf16 v[52:55], a[168:171], v[60:63], v[52:55]
    v_mul_f32 v75, v72, v74
    s_waitcnt lgkmcnt(2)
    v_mfma_f32_16x16x32_bf16 v[32:35], a[44:47], v[76:79], v[32:35]
    ds_read_b128 v[56:59], v67 offset:33856
    v_mfma_f32_16x16x32_bf16 v[36:39], a[108:111], v[76:79], v[36:39]
    s_waitcnt vmcnt(2)
    v_add_f32 v92, v92, v94
    v_mfma_f32_16x16x32_bf16 v[40:43], a[172:175], v[76:79], v[40:43]
    ds_read_b128 v[60:63], v67 offset:50752
    v_add_f32_e64 v93, v93, v95
    v_mfma_f32_16x16x32_bf16 v[44:47], a[44:47], v[80:83], v[44:47]
    v_mov_b32_e64 v94, v92
    v_mfma_f32_16x16x32_bf16 v[48:51], a[108:111], v[80:83], v[48:51]
    v_mov_b32_e64 v95, v93
    v_mfma_f32_16x16x32_bf16 v[52:55], a[172:175], v[80:83], v[52:55]
    v_permlane32_swap_b32 v94, v92
    s_waitcnt lgkmcnt(2)
    v_mfma_f32_16x16x32_bf16 v[32:35], a[48:51], v[84:87], v[32:35]
    ds_read_b128 v[76:79], v67 offset:33920
    v_mfma_f32_16x16x32_bf16 v[36:39], a[112:115], v[84:87], v[36:39]
    v_permlane32_swap_b32_e64 v95, v93
    v_mfma_f32_16x16x32_bf16 v[40:43], a[176:179], v[84:87], v[40:43]
    ds_read_b128 v[80:83], v67 offset:50816
    s_waitcnt vmcnt(0)
    v_cmp_eq_u32 vcc, -1, v22
    s_nop 0
    s_and_b64 vcc, exec, vcc
    s_cbranch_vccz K1_PDONE31
    s_mov_b32 s63, 524288
K1_POLL30:
    buffer_load_dword v22, v20, s[4:7], s37 offen offset:0 sc1
    s_waitcnt vmcnt(0)
    v_cmp_eq_u32 vcc, -1, v22
    s_nop 0
    s_and_b64 vcc, exec, vcc
    s_cbranch_vccz K1_PDONE31
    s_sub_u32 s63, s63, 1
    s_cmp_lg_u32 s63, 0
    s_cbranch_scc1 K1_POLL30
K1_PDONE31:
    v_mfma_f32_16x16x32_bf16 v[44:47], a[48:51], v[88:91], v[44:47]
    buffer_load_dwordx4 v[96:99], v21, s[4:7], s64 offen sc1
    v_add_f32 v92, v92, v94
    v_mfma_f32_16x16x32_bf16 v[48:51], a[112:115], v[88:91], v[48:51]
    v_add_f32 v93, v93, v95
    v_mov_b32 v94, v92
    v_mfma_f32_16x16x32_bf16 v[52:55], a[176:179], v[88:91], v[52:55]
    s_waitcnt lgkmcnt(2)
    v_mfma_f32_16x16x32_bf16 v[32:35], a[52:55], v[56:59], v[32:35]
    ds_read_b128 v[84:87], v67 offset:33984
    v_mov_b32 v95, v93
    v_mfma_f32_16x16x32_bf16 v[36:39], a[116:119], v[56:59], v[36:39]
    buffer_load_dwordx4 v[100:103], v21, s[4:7], s65 offen sc1
    v_permlane16_swap_b32_e64 v94, v92
    v_mfma_f32_16x16x32_bf16 v[40:43], a[180:183], v[56:59], v[40:43]
    ds_read_b128 v[88:91], v67 offset:50880
    v_permlane16_swap_b32_e64 v95, v93
    v_mfma_f32_16x16x32_bf16 v[44:47], a[52:55], v[60:63], v[44:47]
    v_add_f32_e64 v92, v92, v94
    v_mfma_f32_16x16x32_bf16 v[48:51], a[116:119], v[60:63], v[48:51]
    v_add_f32_e64 v93, v93, v95
    v_mfma_f32_16x16x32_bf16 v[52:55], a[180:183], v[60:63], v[52:55]
    buffer_load_dwordx4 v[104:107], v21, s[4:7], s66 offen sc1
    s_waitcnt lgkmcnt(2)
    v_mfma_f32_16x16x32_bf16 v[32:35], a[56:59], v[76:79], v[32:35]
    v_mul_f32 v92, s62, v92
    v_mfma_f32_16x16x32_bf16 v[36:39], a[120:123], v[76:79], v[36:39]
    ds_read_b128 v[56:59], v12 offset:0
    v_mul_f32_e64 v93, s62, v93
    v_mfma_f32_16x16x32_bf16 v[40:43], a[184:187], v[76:79], v[40:43]
    v_fma_f32 v93, -v92, v92, v93
    v_mfma_f32_16x16x32_bf16 v[44:47], a[56:59], v[80:83], v[44:47]
    ds_read_b128 v[60:63], v12 offset:16
    buffer_load_dwordx4 v[108:111], v21, s[4:7], s67 offen sc1
    v_mfma_f32_16x16x32_bf16 v[48:51], a[120:123], v[80:83], v[48:51]
    v_max_f32_e64 v93, 0, v93
    v_mfma_f32_16x16x32_bf16 v[52:55], a[184:187], v[80:83], v[52:55]
    v_add_f32 v93, 0x3727c5ac, v93
    s_waitcnt lgkmcnt(2)
    v_mfma_f32_16x16x32_bf16 v[32:35], a[60:63], v[84:87], v[32:35]
    v_rsq_f32 v72, v93
    v_mfma_f32_16x16x32_bf16 v[36:39], a[124:127], v[84:87], v[36:39]
    buffer_load_dwordx4 v[112:115], v21, s[4:7], s68 offen sc1
    v_mul_f32_e64 v92, -1.0, v92
    v_mfma_f32_16x16x32_bf16 v[40:43], a[188:191], v[84:87], v[40:43]
    v_mul_f32_e64 v73, v92, v72
    v_mfma_f32_16x16x32_bf16 v[44:47], a[60:63], v[88:91], v[44:47]
    v_mfma_f32_16x16x32_bf16 v[48:51], a[124:127], v[88:91], v[48:51]
    v_mfma_f32_16x16x32_bf16 v[52:55], a[188:191], v[88:91], v[52:55]
    s_barrier
    s_add_u32 s35, s40, 11264
    s_cmp_eq_u32 s16, 3
    s_cselect_b32 s39, s90, s35
    s_waitcnt lgkmcnt(0)
    v_pk_fma_f32 v[76:77], v[72:73], v[60:61], v[56:57] op_sel:[1,0,0] op_sel_hi:[1,1,1]
    buffer_load_dwordx4 v[116:119], v21, s[4:7], s69 offen sc1
    v_pk_fma_f32 v[78:79], v[72:73], v[62:63], v[58:59] op_sel:[1,0,0] op_sel_hi:[1,1,1]
    v_pk_fma_f32 v[80:81], v[74:75], v[60:61], v[56:57] op_sel:[1,0,0] op_sel_hi:[1,1,1]
    v_pk_fma_f32 v[82:83], v[74:75], v[62:63], v[58:59] op_sel:[1,0,0] op_sel_hi:[1,1,1]
    ds_read_b128 v[56:59], v12 offset:128
    ds_read_b128 v[60:63], v12 offset:144
    v_pk_fma_f32 v[76:77], v[72:73], v[32:33], v[76:77] op_sel_hi:[0,1,1]
    v_pk_fma_f32 v[78:79], v[72:73], v[34:35], v[78:79] op_sel_hi:[0,1,1]
    v_pk_fma_f32 v[80:81], v[74:75], v[44:45], v[80:81] op_sel_hi:[0,1,1]
    v_pk_fma_f32 v[82:83], v[74:75], v[46:47], v[82:83] op_sel_hi:[0,1,1]
    v_pk_mul_f32 v[84:85], v[76:77], v[76:77]
    v_pk_mul_f32 v[86:87], v[78:79], v[78:79]
    v_pk_mul_f32 v[88:89], v[80:81], v[80:81]
    v_pk_mul_f32 v[90:91], v[82:83], v[82:83]
    v_pk_fma_f32 v[84:85], v[84:85], s[58:59], v[0:1] op_sel_hi:[1,1,0]
    v_pk_fma_f32 v[86:87], v[86:87], s[58:59], v[0:1] op_sel_hi:[1,1,0]
    v_pk_fma_f32 v[88:89], v[88:89], s[58:59], v[0:1] op_sel_hi:[1,1,0]
    v_pk_fma_f32 v[90:91], v[90:91], s[58:59], v[0:1] op_sel_hi:[1,1,0]
    v_pk_mul_f32 v[84:85], v[76:77], v[84:85]
    v_pk_mul_f32 v[86:87], v[78:79], v[86:87]
    v_pk_mul_f32 v[88:89], v[80:81], v[88:89]
    v_pk_mul_f32 v[90:91], v[82:83], v[90:91]
    v_exp_f32_e64 v84, v84
    buffer_load_dwordx4 v[120:123], v21, s[4:7], s70 offen sc1
    v_exp_f32 v85, v85
    v_exp_f32 v86, v86
    v_exp_f32 v87, v87
    v_exp_f32 v88, v88
    v_exp_f32 v89, v89
    v_exp_f32 v90, v90
    v_exp_f32_e64 v91, v91
    v_pk_add_f32 v[84:85], v[84:85], 1.0 op_sel_hi:[1,0]
    v_pk_add_f32 v[86:87], v[86:87], 1.0 op_sel_hi:[1,0]
    v_pk_add_f32 v[88:89], v[88:89], 1.0 op_sel_hi:[1,0]
    v_pk_add_f32 v[90:91], v[90:91], 1.0 op_sel_hi:[1,0]
    v_rcp_f32 v84, v84
    v_rcp_f32 v85, v85
    v_rcp_f32 v86, v86
    v_rcp_f32 v87, v87
    v_rcp_f32 v88, v88
    v_rcp_f32 v89, v89
    v_rcp_f32 v90, v90
    v_rcp_f32 v91, v91
    v_pk_mul_f32 v[76:77], v[76:77], v[84:85]
    v_pk_mul_f32 v[78:79], v[78:79], v[86:87]
    v_pk_mul_f32 v[80:81], v[80:81], v[88:89]
    buffer_load_dwordx4 v[124:127], v21, s[4:7], s71 offen sc1
    v_pk_mul_f32 v[82:83], v[82:83], v[90:91]
    v_cvt_pk_bf16_f32 v84, v76, v77
    v_cvt_pk_bf16_f32 v85, v78, v79
    v_cvt_pk_bf16_f32 v86, v80, v81
    v_cvt_pk_bf16_f32 v87, v82, v83
    s_nop 0
    v_permlane32_swap_b32 v84, v86
    v_permlane32_swap_b32_e64 v85, v87
    buffer_store_dwordx4 v[84:87], v2, s[4:7], s35 offen offset:0
    s_waitcnt lgkmcnt(0)
    v_pk_fma_f32 v[76:77], v[72:73], v[60:61], v[56:57] op_sel:[1,0,0] op_sel_hi:[1,1,1]
    v_pk_fma_f32 v[78:79], v[72:73], v[62:63], v[58:59] op_sel:[1,0,0] op_sel_hi:[1,1,1]
    v_pk_fma_f32 v[80:81], v[74:75], v[60:61], v[56:57] op_sel:[1,0,0] op_sel_hi:[1,1,1]
    v_pk_fma_f32 v[82:83], v[74:75], v[62:63], v[58:59] op_sel:[1,0,0] op_sel_hi:[1,1,1]
    ds_read_b128 v[56:59], v12 offset:256
    ds_read_b128 v[60:63], v12 offset:272
    v_pk_fma_f32 v[76:77], v[72:73], v[36:37], v[76:77] op_sel_hi:[0,1,1]
    v_pk_fma_f32 v[78:79], v[72:73], v[38:39], v[78:79] op_sel_hi:[0,1,1]
    v_pk_fma_f32 v[80:81], v[74:75], v[48:49], v[80:81] op_sel_hi:[0,1,1]
    v_pk_fma_f32 v[82:83], v[74:75], v[50:51], v[82:83] op_sel_hi:[0,1,1]
    v_pk_mul_f32 v[84:85], v[76:77], v[76:77]
    v_pk_mul_f32 v[86:87], v[78:79], v[78:79]
    v_pk_mul_f32 v[88:89], v[80:81], v[80:81]
    v_pk_mul_f32 v[90:91], v[82:83], v[82:83]
    buffer_load_dwordx4 v[128:131], v21, s[4:7], s72 offen sc1
    v_pk_fma_f32 v[84:85], v[84:85], s[58:59], v[0:1] op_sel_hi:[1,1,0]
    v_pk_fma_f32 v[86:87], v[86:87], s[58:59], v[0:1] op_sel_hi:[1,1,0]
    v_pk_fma_f32 v[88:89], v[88:89], s[58:59], v[0:1] op_sel_hi:[1,1,0]
    v_pk_fma_f32 v[90:91], v[90:91], s[58:59], v[0:1] op_sel_hi:[1,1,0]
    v_pk_mul_f32 v[84:85], v[76:77], v[84:85]
    v_pk_mul_f32 v[86:87], v[78:79], v[86:87]
    v_pk_mul_f32 v[88:89], v[80:81], v[88:89]
    v_pk_mul_f32 v[90:91], v[82:83], v[90:91]
    v_exp_f32 v84, v84
    v_exp_f32 v85, v85
    v_exp_f32 v86, v86
    v_exp_f32 v87, v87
    v_exp_f32 v88, v88
    v_exp_f32 v89, v89
    v_exp_f32 v90, v90
    v_exp_f32_e64 v91, v91
    v_pk_add_f32 v[84:85], v[84:85], 1.0 op_sel_hi:[1,0]
    v_pk_add_f32 v[86:87], v[86:87], 1.0 op_sel_hi:[1,0]
    v_pk_add_f32 v[88:89], v[88:89], 1.0 op_sel_hi:[1,0]
    v_pk_add_f32 v[90:91], v[90:91], 1.0 op_sel_hi:[1,0]
    v_rcp_f32 v84, v84
    v_rcp_f32 v85, v85
    buffer_load_dwordx4 v[132:135], v21, s[4:7], s73 offen sc1
    v_rcp_f32 v86, v86
    v_rcp_f32 v87, v87
    v_rcp_f32 v88, v88
    v_rcp_f32 v89, v89
    v_rcp_f32 v90, v90
    v_rcp_f32 v91, v91
    v_pk_mul_f32 v[76:77], v[76:77], v[84:85]
    v_pk_mul_f32 v[78:79], v[78:79], v[86:87]
    v_pk_mul_f32 v[80:81], v[80:81], v[88:89]
    v_pk_mul_f32 v[82:83], v[82:83], v[90:91]
    v_cvt_pk_bf16_f32 v84, v76, v77
    v_cvt_pk_bf16_f32 v85, v78, v79
    v_cvt_pk_bf16_f32 v86, v80, v81
    v_cvt_pk_bf16_f32 v87, v82, v83
    s_nop 0
    v_permlane32_swap_b32 v84, v86
    v_permlane32_swap_b32_e64 v85, v87
    buffer_store_dwordx4 v[84:87], v2, s[4:7], s35 offen offset:1024
    s_waitcnt lgkmcnt(0)
    v_pk_fma_f32 v[76:77], v[72:73], v[60:61], v[56:57] op_sel:[1,0,0] op_sel_hi:[1,1,1]
    v_pk_fma_f32 v[78:79], v[72:73], v[62:63], v[58:59] op_sel:[1,0,0] op_sel_hi:[1,1,1]
    v_pk_fma_f32 v[80:81], v[74:75], v[60:61], v[56:57] op_sel:[1,0,0] op_sel_hi:[1,1,1]
    v_pk_fma_f32 v[82:83], v[74:75], v[62:63], v[58:59] op_sel:[1,0,0] op_sel_hi:[1,1,1]
    v_pk_fma_f32 v[76:77], v[72:73], v[40:41], v[76:77] op_sel_hi:[0,1,1]
    buffer_load_dwordx4 v[136:139], v21, s[4:7], s74 offen sc1
    v_pk_fma_f32 v[78:79], v[72:73], v[42:43], v[78:79] op_sel_hi:[0,1,1]
    v_pk_fma_f32 v[80:81], v[74:75], v[52:53], v[80:81] op_sel_hi:[0,1,1]
    v_pk_fma_f32 v[82:83], v[74:75], v[54:55], v[82:83] op_sel_hi:[0,1,1]
    v_pk_mul_f32 v[84:85], v[76:77], v[76:77]
    v_pk_mul_f32 v[86:87], v[78:79], v[78:79]
    v_pk_mul_f32 v[88:89], v[80:81], v[80:81]
    v_pk_mul_f32 v[90:91], v[82:83], v[82:83]
    v_pk_fma_f32 v[84:85], v[84:85], s[58:59], v[0:1] op_sel_hi:[1,1,0]
    v_pk_fma_f32 v[86:87], v[86:87], s[58:59], v[0:1] op_sel_hi:[1,1,0]
    v_pk_fma_f32 v[88:89], v[88:89], s[58:59], v[0:1] op_sel_hi:[1,1,0]
    v_pk_fma_f32 v[90:91], v[90:91], s[58:59], v[0:1] op_sel_hi:[1,1,0]
    v_pk_mul_f32 v[84:85], v[76:77], v[84:85]
    v_pk_mul_f32 v[86:87], v[78:79], v[86:87]
    v_pk_mul_f32 v[88:89], v[80:81], v[88:89]
    v_pk_mul_f32 v[90:91], v[82:83], v[90:91]
    v_exp_f32 v84, v84
    v_exp_f32 v85, v85
    v_exp_f32 v86, v86
    v_exp_f32 v87, v87
    v_exp_f32 v88, v88
    v_exp_f32 v89, v89
    v_exp_f32 v90, v90
    buffer_load_dwordx4 v[140:143], v21, s[4:7], s75 offen sc1
    v_exp_f32_e64 v91, v91
    v_pk_add_f32 v[84:85], v[84:85], 1.0 op_sel_hi:[1,0]
    v_pk_add_f32 v[86:87], v[86:87], 1.0 op_sel_hi:[1,0]
    v_pk_add_f32 v[88:89], v[88:89], 1.0 op_sel_hi:[1,0]
    v_pk_add_f32 v[90:91], v[90:91], 1.0 op_sel_hi:[1,0]
    v_rcp_f32 v84, v84
    v_rcp_f32 v85, v85
    v_rcp_f32 v86, v86
    v_rcp_f32 v87, v87
    v_rcp_f32 v88, v88
    v_rcp_f32 v89, v89
    v_rcp_f32 v90, v90
    v_rcp_f32 v91, v91
    v_pk_mul_f32 v[76:77], v[76:77], v[84:85]
    v_pk_mul_f32 v[78:79], v[78:79], v[86:87]
    v_pk_mul_f32 v[80:81], v[80:81], v[88:89]
    v_pk_mul_f32 v[82:83], v[82:83], v[90:91]
    v_cvt_pk_bf16_f32 v84, v76, v77
    v_cvt_pk_bf16_f32 v85, v78, v79
    v_cvt_pk_bf16_f32 v86, v80, v81
    v_cvt_pk_bf16_f32 v87, v82, v83
    s_nop 0
    v_permlane32_swap_b32 v84, v86
    v_permlane32_swap_b32_e64 v85, v87
    buffer_store_dwordx4 v[84:87], v2, s[4:7], s39 offen offset:2048
    s_waitcnt vmcnt(14)
    v_mfma_f32_32x32x16_bf16 v[32:47], a[192:195], v[96:99], 0
    v_mfma_f32_32x32x16_bf16 v[48:63], a[196:199], v[96:99], 0
    buffer_load_dwordx4 v[96:99], v21, s[4:7], s76 offen sc1
    s_waitcnt vmcnt(14)
    v_mfma_f32_32x32x16_bf16 v[32:47], a[200:203], v[100:103], v[32:47]
    ds_read_b64_tr_b16 v[224:225], v17 offset:11264
    v_mfma_f32_32x32x16_bf16 v[48:63], a[204:207], v[100:103], v[48:63]
    buffer_load_dwordx4 v[100:103], v21, s[4:7], s77 offen sc1
    ds_read_b64_tr_b16 v[226:227], v17 offset:12288
    s_waitcnt vmcnt(14)
    v_mfma_f32_32x32x16_bf16 v[32:47], a[208:211], v[104:107], v[32:47]
    ds_read_b64_tr_b16 v[228:229], v17 offset:11328
    v_mfma_f32_32x32x16_bf16 v[48:63], a[212:215], v[104:107], v[48:63]
    buffer_load_dwordx4 v[104:107], v21, s[4:7], s78 offen sc1
    ds_read_b64_tr_b16 v[230:231], v17 offset:12352
    s_waitcnt vmcnt(14)
    v_mfma_f32_32x32x16_bf16 v[32:47], a[216:219], v[108:111], v[32:47]
    v_mfma_f32_32x32x16_bf16 v[48:63], a[220:223], v[108:111], v[48:63]
    buffer_load_dwordx4 v[108:111], v21, s[4:7], s79 offen sc1
    s_waitcnt vmcnt(14)
    v_mfma_f32_32x32x16_bf16 v[32:47], a[224:227], v[112:115], v[32:47]
    ds_read_b64_tr_b16 v[232:233], v17 offset:13312
    v_mfma_f32_32x32x16_bf16 v[48:63], a[228:231], v[112:115], v[48:63]
    buffer_load_dwordx4 v[112:115], v21, s[4:7], s80 offen sc1
    ds_read_b64_tr_b16 v[234:235], v17 offset:14336
    s_waitcnt vmcnt(14)
    v_mfma_f32_32x32x16_bf16 v[32:47], a[232:235], v[116:119], v[32:47]
    ds_read_b64_tr_b16 v[236:237], v17 offset:13376
    v_mfma_f32_32x32x16_bf16 v[48:63], a[236:239], v[116:119], v[48:63]
    buffer_load_dwordx4 v[116:119], v21, s[4:7], s81 offen sc1
    s_waitcnt vmcnt(14)
    v_mfma_f32_32x32x16_bf16 v[32:47], a[240:243], v[120:123], v[32:47]
    ds_read_b64_tr_b16 v[238:239], v17 offset:14400
    v_mfma_f32_32x32x16_bf16 v[48:63], a[244:247], v[120:123], v[48:63]
    buffer_load_dwordx4 v[120:123], v21, s[4:7], s82 offen sc1
    s_waitcnt vmcnt(14)
    v_mfma_f32_32x32x16_bf16 v[32:47], a[248:251], v[124:127], v[32:47]
    ds_read_b64_tr_b16 v[240:241], v17 offset:0
    v_mfma_f32_32x32x16_bf16 v[48:63], a[252:255], v[124:127], v[48:63]
    buffer_load_dwordx4 v[124:127], v21, s[4:7], s83 offen sc1
    ds_read_b64_tr_b16 v[242:243], v17 offset:1024
    s_waitcnt vmcnt(13)
    v_mfma_f32_32x32x16_bf16 v[32:47], v[144:147], v[128:131], v[32:47]
    v_mfma_f32_32x32x16_bf16 v[48:63], v[148:151], v[128:131], v[48:63]
    buffer_load_dwordx4 v[128:131], v21, s[4:7], s84 offen sc1
    ds_read_b64_tr_b16 v[244:245], v17 offset:64
    s_waitcnt vmcnt(13)
    v_mfma_f32_32x32x16_bf16 v[32:47], v[152:155], v[132:135], v[32:47]
    s_waitcnt vmcnt(9)
    s_add_u32 s36, s41, 16384
    s_mov_b64 exec, 1
    buffer_store_dword v8, v8, s[4:7], s36 offen offset:0
    s_mov_b64 exec, -1
    v_mfma_f32_32x32x16_bf16 v[48:63], v[156:159], v[132:135], v[48:63]
    buffer_load_dwordx4 v[132:135], v21, s[4:7], s85 offen sc1
    ds_read_b64_tr_b16 v[246:247], v17 offset:1088
    v_mfma_f32_32x32x16_bf16 v[32:47], v[160:163], v[136:139], v[32:47]
    ds_read_b64_tr_b16 v[248:249], v17 offset:3072
    v_mfma_f32_32x32x16_bf16 v[48:63], v[164:167], v[136:139], v[48:63]
    v_mfma_f32_32x32x16_bf16 v[32:47], v[168:171], v[140:143], v[32:47]
    ds_read_b64_tr_b16 v[250:251], v17 offset:4096
    v_mfma_f32_32x32x16_bf16 v[48:63], v[172:175], v[140:143], v[48:63]
    ds_read_b64_tr_b16 v[252:253], v17 offset:3136
    s_waitcnt vmcnt(10)
    v_mfma_f32_32x32x16_bf16 v[32:47], v[176:179], v[96:99], v[32:47]
    ds_read_b64_tr_b16 v[254:255], v17 offset:4160
    v_mfma_f32_32x32x16_bf16 v[48:63], v[180:183], v[96:99], v[48:63]
    s_waitcnt lgkmcnt(0)
    s_barrier
    s_waitcnt vmcnt(9)
    v_mfma_f32_32x32x16_bf16 v[32:47], v[184:187], v[100:103], v[32:47]
    v_mfma_f32_32x32x16_bf16 v[48:63], v[188:191], v[100:103], v[48:63]
    s_waitcnt vmcnt(8)
    v_mfma_f32_32x32x16_bf16 v[32:47], v[192:195], v[104:107], v[32:47]
    s_add_u32 s37, s42, 16384
    buffer_load_dword v22, v20, s[4:7], s37 offen offset:0 sc1
    s_add_u32 s36, s49, 11264
    v_add_u32 v21, s36, v11
    s_waitcnt vmcnt(8)
    v_mfma_f32_32x32x16_bf16 v[32:47], v[200:203], v[108:111], v[32:47]
    v_mfma_f32_32x32x16_bf16 v[48:63], v[196:199], v[104:107], v[48:63]
    s_waitcnt vmcnt(7)
    v_mfma_f32_32x32x16_bf16 v[32:47], v[208:211], v[112:115], v[32:47]
    s_waitcnt vmcnt(6)
    v_mfma_f32_32x32x16_bf16 v[32:47], v[216:219], v[116:119], v[32:47]
    v_mfma_f32_32x32x16_bf16 v[48:63], v[204:207], v[108:111], v[48:63]
    s_waitcnt vmcnt(5)
    v_mfma_f32_32x32x16_bf16 v[32:47], v[224:227], v[120:123], v[32:47]
    s_waitcnt vmcnt(4)
    v_mfma_f32_32x32x16_bf16 v[32:47], v[232:235], v[124:127], v[32:47]
    v_mfma_f32_32x32x16_bf16 v[48:63], v[212:215], v[112:115], v[48:63]
    s_waitcnt vmcnt(3)
    v_mfma_f32_32x32x16_bf16 v[32:47], v[240:243], v[128:131], v[32:47]
    s_waitcnt vmcnt(1)
    v_mfma_f32_32x32x16_bf16 v[32:47], v[248:251], v[132:135], v[32:47]
    v_mfma_f32_32x32x16_bf16 v[48:63], v[220:223], v[116:119], v[48:63]
    s_waitcnt vmcnt(0)
    v_cmp_eq_u32 vcc, -1, v22
    s_nop 0
    s_and_b64 vcc, exec, vcc
    s_cbranch_vccz K1_PDONE33
    s_mov_b32 s63, 524288
K1_POLL32:
    buffer_load_dword v22, v20, s[4:7], s37 offen offset:0 sc1
    s_waitcnt vmcnt(0)
    v_cmp_eq_u32 vcc, -1, v22
    s_nop 0
    s_and_b64 vcc, exec, vcc
    s_cbranch_vccz K1_PDONE33
    s_sub_u32 s63, s63, 1
    s_cmp_lg_u32 s63, 0
    s_cbranch_scc1 K1_POLL32
K1_PDONE33:
    v_mfma_f32_32x32x16_bf16 v[48:63], v[228:231], v[120:123], v[48:63]
    buffer_load_dwordx4 v[136:139], v21, s[4:7], s64 offen sc1
    buffer_load_dwordx4 v[140:143], v21, s[4:7], s65 offen sc1
    v_mfma_f32_32x32x16_bf16 v[48:63], v[236:239], v[124:127], v[48:63]
    s_nop 1
    ds_write_b128 v3, v[32:35] offset:0
    buffer_load_dwordx4 v[96:99], v21, s[4:7], s66 offen sc1
    v_mfma_f32_32x32x16_bf16 v[48:63], v[244:247], v[128:131], v[48:63]
    ds_write_b128 v3, v[36:39] offset:16
    ds_write_b128 v3, v[40:43] offset:32
    buffer_load_dwordx4 v[100:103], v21, s[4:7], s67 offen sc1
    v_mfma_f32_32x32x16_bf16 v[48:63], v[252:255], v[132:135], v[48:63]
    ds_write_b128 v3, v[44:47] offset:48
    buffer_load_dwordx4 v[104:107], v21, s[4:7], s68 offen sc1
    s_nop 9
    ds_write_b128 v3, v[48:51] offset:128
    buffer_load_dwordx4 v[108:111], v21, s[4:7], s69 offen sc1
    ds_write_b128 v3, v[52:55] offset:144
    buffer_load_dwordx4 v[112:115], v21, s[4:7], s70 offen sc1
    ds_write_b128 v3, v[56:59] offset:160
    buffer_load_dwordx4 v[116:119], v21, s[4:7], s71 offen sc1
    ds_write_b128 v3, v[60:63] offset:176
    buffer_load_dwordx4 v[120:123], v21, s[4:7], s72 offen sc1
    s_waitcnt lgkmcnt(0)
    s_barrier
    s_add_u32 s44, s44, 131072
    ds_read_b128 v[32:35], v4 offset:0
    ds_read_b128 v[36:39], v4 offset:16
    ds_read_b128 v[40:43], v4 offset:8704
    ds_read_b128 v[44:47], v4 offset:8720
    ds_read_b128 v[48:51], v4 offset:17408
    ds_read_b128 v[52:55], v4 offset:17424
    ds_read_b128 v[56:59], v4 offset:26112
    ds_read_b128 v[60:63], v4 offset:26128
    ds_read_b128 v[76:79], v13 offset:0
    ds_read_b128 v[80:83], v13 offset:16
    v_lshlrev_b32 v64, 16, v24
    buffer_load_dwordx4 v[124:127], v21, s[4:7], s73 offen sc1
    v_and_b32 v65, s56, v24
    v_lshlrev_b32 v66, 16, v25
    v_and_b32 v67, s56, v25
    v_lshlrev_b32 v68, 16, v26
    v_and_b32 v69, s56, v26
    v_lshlrev_b32 v70, 16, v27
    v_and_b32 v71, s56, v27
    s_waitcnt lgkmcnt(7)
    v_pk_add_f32 v[32:33], v[32:33], v[40:41]
    v_pk_add_f32 v[34:35], v[34:35], v[42:43]
    s_waitcnt lgkmcnt(6)
    v_pk_add_f32 v[36:37], v[36:37], v[44:45]
    buffer_load_dwordx4 v[128:131], v21, s[4:7], s74 offen sc1
    v_pk_add_f32 v[38:39], v[38:39], v[46:47]
    s_waitcnt lgkmcnt(3)
    v_pk_add_f32 v[48:49], v[48:49], v[56:57]
    v_pk_add_f32 v[50:51], v[50:51], v[58:59]
    s_waitcnt lgkmcnt(2)
    v_pk_add_f32 v[52:53], v[52:53], v[60:61]
    v_pk_add_f32 v[54:55], v[54:55], v[62:63]
    v_pk_add_f32 v[64:65], v[64:65], v[32:33]
    v_pk_add_f32 v[66:67], v[66:67], v[34:35]
    v_pk_add_f32 v[68:69], v[68:69], v[36:37]
    v_pk_add_f32 v[70:71], v[70:71], v[38:39]
    v_pk_add_f32 v[64:65], v[64:65], v[48:49]
    buffer_load_dwordx4 v[132:135], v21, s[4:7], s75 offen sc1
    v_pk_add_f32 v[66:67], v[66:67], v[50:51]
    v_pk_add_f32 v[68:69], v[68:69], v[52:53]
    v_pk_add_f32 v[70:71], v[70:71], v[54:55]
    s_waitcnt lgkmcnt(1)
    v_pk_add_f32 v[64:65], v[64:65], v[76:77]
    v_pk_add_f32 v[66:67], v[66:67], v[78:79]
    s_waitcnt lgkmcnt(0)
    v_pk_add_f32 v[68:69], v[68:69], v[80:81]
    v_pk_add_f32 v[70:71], v[70:71], v[82:83]
    v_cvt_pk_bf16_f32 v24, v64, v65
    v_cvt_pk_bf16_f32 v25, v66, v67
    v_cvt_pk_bf16_f32 v26, v68, v69
    v_cvt_pk_bf16_f32 v27, v70, v71
    v_dot2_f32_bf16 v72, v24, s57, 0
    v_dot2_f32_bf16 v73, v24, v24, 0
    v_dot2_f32_bf16 v72, v25, s57, v72
    v_dot2_f32_bf16 v73, v25, v25, v73
    v_dot2_f32_bf16 v72, v26, s57, v72
    v_dot2_f32_bf16 v73, v26, v26, v73
    v_dot2_f32_bf16 v72, v27, s57, v72
    v_dot2_f32_bf16 v73, v27, v27, v73
    s_nop 1
    v_add_f32_dpp v72, v72, v72 quad_perm:[1,0,3,2] row_mask:0xf bank_mask:0xf
    v_add_f32_dpp v73, v73, v73 quad_perm:[1,0,3,2] row_mask:0xf bank_mask:0xf
    s_nop 0
    v_add_f32_dpp v72, v72, v72 quad_perm:[2,3,0,1] row_mask:0xf bank_mask:0xf
    v_add_f32_dpp v73, v73, v73 quad_perm:[2,3,0,1] row_mask:0xf bank_mask:0xf
    s_nop 0
    v_add_f32_dpp v72, v72, v72 row_half_mirror row_mask:0xf bank_mask:0xf
    v_add_f32_dpp v73, v73, v73 row_half_mirror row_mask:0xf bank_mask:0xf
    s_mov_b32 exec_lo, 0x01010101
    s_mov_b32 exec_hi, 0x01010101
    buffer_store_dwordx2 v[72:73], v5, s[4:7], s44 offen offset:0
    s_mov_b64 exec, -1
    v_lshlrev_b32 v64, 16, v24
    v_and_b32 v65, s56, v24
    v_lshlrev_b32 v66, 16, v25
    v_and_b32 v67, s56, v25
    v_lshlrev_b32 v68, 16, v26
    v_and_b32 v69, s56, v26
    v_lshlrev_b32 v70, 16, v27
    v_and_b32 v71, s56, v27
    s_waitcnt vmcnt(12)
    v_mfma_f32_32x32x16_bf16 v[32:47], a[192:195], v[136:139], 0
    ds_read_u16 v76, v23 offset:0
    ds_read_u16 v77, v23 offset:128
    ds_read_u16 v78, v23 offset:256
    ds_read_u16 v79, v23 offset:384
    ds_read_u16 v80, v23 offset:512
    v_mfma_f32_32x32x16_bf16 v[48:63], a[196:199], v[136:139], 0
    buffer_load_dwordx4 v[136:139], v21, s[4:7], s76 offen sc1
    ds_read_u16 v81, v23 offset:640
    ds_read_u16 v82, v23 offset:768
    ds_read_u16 v83, v23 offset:896
    s_waitcnt lgkmcnt(7)
    v_lshlrev_b32_e64 v76, 16, v76
    s_waitcnt vmcnt(12)
    v_mfma_f32_32x32x16_bf16 v[32:47], a[200:203], v[140:143], v[32:47]
    s_waitcnt lgkmcnt(6)
    v_lshlrev_b32 v77, 16, v77
    s_waitcnt lgkmcnt(5)
    v_lshlrev_b32 v78, 16, v78
    s_waitcnt lgkmcnt(4)
    v_lshlrev_b32 v79, 16, v79
    s_waitcnt lgkmcnt(3)
    v_lshlrev_b32 v80, 16, v80
    s_waitcnt lgkmcnt(2)
    v_lshlrev_b32 v81, 16, v81
    v_mfma_f32_32x32x16_bf16 v[48:63], a[204:207], v[140:143], v[48:63]
    buffer_load_dwordx4 v[140:143], v21, s[4:7], s77 offen sc1
    s_waitcnt lgkmcnt(1)
    v_lshlrev_b32 v82, 16, v82
    s_waitcnt lgkmcnt(0)
    v_lshlrev_b32_e64 v83, 16, v83
    s_waitcnt vmcnt(12)
    v_mfma_f32_32x32x16_bf16 v[32:47], a[208:211], v[96:99], v[32:47]
    v_mfma_f32_32x32x16_bf16 v[48:63], a[212:215], v[96:99], v[48:63]
    buffer_load_dwordx4 v[96:99], v21, s[4:7], s78 offen sc1
    s_waitcnt vmcnt(12)
    v_mfma_f32_32x32x16_bf16 v[32:47], a[216:219], v[100:103], v[32:47]
    v_mfma_f32_32x32x16_bf16 v[48:63], a[220:223], v[100:103], v[48:63]
    buffer_load_dwordx4 v[100:103], v21, s[4:7], s79 offen sc1
    s_waitcnt vmcnt(12)
    v_mfma_f32_32x32x16_bf16 v[32:47], a[224:227], v[104:107], v[32:47]
    v_mfma_f32_32x32x16_bf16 v[48:63], a[228:231], v[104:107], v[48:63]
    buffer_load_dwordx4 v[104:107], v21, s[4:7], s80 offen sc1
    s_waitcnt vmcnt(12)
    v_mfma_f32_32x32x16_bf16 v[32:47], a[232:235], v[108:111], v[32:47]
    buffer_load_dwordx2 v[72:73], v6, s[4:7], s44 offen offset:0 sc1
    v_mfma_f32_32x32x16_bf16 v[48:63], a[236:239], v[108:111], v[48:63]
    buffer_load_dwordx4 v[108:111], v21, s[4:7], s81 offen sc1
    s_waitcnt vmcnt(13)
    v_mfma_f32_32x32x16_bf16 v[32:47], a[240:243], v[112:115], v[32:47]
    v_mfma_f32_32x32x16_bf16 v[48:63], a[244:247], v[112:115], v[48:63]
    buffer_load_dwordx4 v[112:115], v21, s[4:7], s82 offen sc1
    s_waitcnt vmcnt(13)
    v_mfma_f32_32x32x16_bf16 v[32:47], a[248:251], v[116:119], v[32:47]
    v_mfma_f32_32x32x16_bf16 v[48:63], a[252:255], v[116:119], v[48:63]
    buffer_load_dwordx4 v[116:119], v21, s[4:7], s83 offen sc1
    s_waitcnt vmcnt(13)
    v_mfma_f32_32x32x16_bf16 v[32:47], v[144:147], v[120:123], v[32:47]
    v_mfma_f32_32x32x16_bf16 v[48:63], v[148:151], v[120:123], v[48:63]
    buffer_load_dwordx4 v[120:123], v21, s[4:7], s84 offen sc1
    s_waitcnt vmcnt(13)
    v_mfma_f32_32x32x16_bf16 v[32:47], v[152:155], v[124:127], v[32:47]
    v_mfma_f32_32x32x16_bf16 v[48:63], v[156:159], v[124:127], v[48:63]
    buffer_load_dwordx4 v[124:127], v21, s[4:7], s85 offen sc1
    s_waitcnt vmcnt(13)
    v_mfma_f32_32x32x16_bf16 v[32:47], v[160:163], v[128:131], v[32:47]
    v_mfma_f32_32x32x16_bf16 v[48:63], v[164:167], v[128:131], v[48:63]
    s_waitcnt vmcnt(12)
    v_mfma_f32_32x32x16_bf16 v[32:47], v[168:171], v[132:135], v[32:47]
    s_waitcnt vmcnt(5)
    v_max_u32_e64 v74, v72, v73
    v_cmp_eq_u32 vcc, -1, v74
    s_nop 0
    s_and_b64 vcc, exec, vcc
    s_cbranch_vccz K1_PDONE35
    s_mov_b32 s63, 524288
K1_POLL34:
    buffer_load_dwordx2 v[72:73], v6, s[4:7], s44 offen offset:0 sc1
    s_waitcnt vmcnt(0)
    v_max_u32_e64 v74, v72, v73
    v_cmp_eq_u32 vcc, -1, v74
    s_nop 0
    s_and_b64 vcc, exec, vcc
    s_cbranch_vccz K1_PDONE35
    s_sub_u32 s63, s63, 1
    s_cmp_lg_u32 s63, 0
    s_cbranch_scc1 K1_POLL34
K1_PDONE35:
    v_mfma_f32_32x32x16_bf16 v[48:63], v[172:175], v[132:135], v[48:63]
    v_add_f32_dpp v72, v72, v72 quad_perm:[1,0,3,2] row_mask:0xf bank_mask:0xf
    v_add_f32_dpp v73, v73, v73 quad_perm:[1,0,3,2] row_mask:0xf bank_mask:0xf
    s_nop 0
    v_add_f32_dpp v72, v72, v72 quad_perm:[2,3,0,1] row_mask:0xf bank_mask:0xf
    v_add_f32_dpp v73, v73, v73 quad_perm:[2,3,0,1] row_mask:0xf bank_mask:0xf
    s_nop 0
    v_add_f32_dpp v72, v72, v72 row_half_mirror row_mask:0xf bank_mask:0xf
    v_mfma_f32_32x32x16_bf16 v[32:47], v[176:179], v[136:139], v[32:47]
    v_add_f32_dpp v73, v73, v73 row_half_mirror row_mask:0xf bank_mask:0xf
    v_mul_f32 v72, s62, v72
    v_mul_f32 v73, s62, v73
    v_fma_f32 v73, -v72, v72, v73
    v_max_f32_e64 v73, 0, v73
    v_mfma_f32_32x32x16_bf16 v[48:63], v[180:183], v[136:139], v[48:63]
    v_add_f32 v73, 0x3727c5ac, v73
    v_rsq_f32 v74, v73
    v_mul_f32 v72, -1.0, v72
    v_mul_f32_e64 v75, v72, v74
    v_mfma_f32_32x32x16_bf16 v[32:47], v[184:187], v[140:143], v[32:47]
    v_fma_f32 v84, v64, v74, v75
    v_fma_f32 v85, v65, v74, v75
    v_fma_f32 v86, v66, v74, v75
    v_fma_f32 v87, v67, v74, v75
    v_fma_f32 v88, v68, v74, v75
    v_mfma_f32_32x32x16_bf16 v[48:63], v[188:191], v[140:143], v[48:63]
    v_fma_f32 v89, v69, v74, v75
    v_fma_f32 v90, v70, v74, v75
    v_fma_f32 v91, v71, v74, v75
    v_fmac_f32 v64, v84, v76
    v_fmac_f32 v65, v85, v77
    v_mfma_f32_32x32x16_bf16 v[32:47], v[192:195], v[96:99], v[32:47]
    v_fmac_f32 v66, v86, v78
    v_fmac_f32 v67, v87, v79
    v_fmac_f32 v68, v88, v80
    v_fmac_f32 v69, v89, v81
    v_fmac_f32_e64 v70, v90, v82
    v_mfma_f32_32x32x16_bf16 v[32:47], v[200:203], v[100:103], v[32:47]
    v_fmac_f32_e64 v71, v91, v83
    v_cvt_pk_bf16_f32 v24, v64, v65
    v_cvt_pk_bf16_f32 v25, v66, v67
    v_cvt_pk_bf16_f32 v26, v68, v69
    v_cvt_pk_bf16_f32 v27, v70, v71
    v_mfma_f32_32x32x16_bf16 v[48:63], v[196:199], v[96:99], v[48:63]
    s_add_u32 s35, s50, 0x0
    buffer_store_dwordx4 v[24:27], v10, s[4:7], s35 offen
    v_lshlrev_b32 v64, 16, v24
    v_and_b32 v65, s56, v24
    v_lshlrev_b32 v66, 16, v25
    v_mfma_f32_32x32x16_bf16 v[32:47], v[208:211], v[104:107], v[32:47]
    v_and_b32 v67, s56, v25
    v_lshlrev_b32 v68, 16, v26
    v_and_b32 v69, s56, v26
    v_lshlrev_b32 v70, 16, v27
    v_and_b32 v71, s56, v27
    s_waitcnt vmcnt(5)
    v_mfma_f32_32x32x16_bf16 v[32:47], v[216:219], v[108:111], v[32:47]
    v_add_f32 v84, v64, v65
    v_mul_f32 v85, v64, v64
    v_fmac_f32 v85, v65, v65
    v_add_f32 v84, v84, v66
    v_fmac_f32_e64 v85, v66, v66
    v_mfma_f32_32x32x16_bf16 v[48:63], v[204:207], v[100:103], v[48:63]
    v_add_f32 v84, v84, v67
    v_fmac_f32 v85, v67, v67
    v_add_f32 v84, v84, v68
    v_fmac_f32 v85, v68, v68
    v_add_f32 v84, v84, v69
    s_waitcnt vmcnt(4)
    v_mfma_f32_32x32x16_bf16 v[32:47], v[224:227], v[112:115], v[32:47]
    v_fmac_f32 v85, v69, v69
    v_add_f32 v84, v84, v70
    v_fmac_f32 v85, v70, v70
    v_add_f32 v84, v84, v71
    v_fmac_f32 v85, v71, v71
    s_waitcnt vmcnt(3)
    v_mfma_f32_32x32x16_bf16 v[32:47], v[232:235], v[116:119], v[32:47]
    v_add_f32_dpp v84, v84, v84 quad_perm:[1,0,3,2] row_mask:0xf bank_mask:0xf
    v_add_f32_dpp v85, v85, v85 quad_perm:[1,0,3,2] row_mask:0xf bank_mask:0xf
    s_nop 0
    v_add_f32_dpp v84, v84, v84 quad_perm:[2,3,0,1] row_mask:0xf bank_mask:0xf
    v_add_f32_dpp v85, v85, v85 quad_perm:[2,3,0,1] row_mask:0xf bank_mask:0xf
    s_nop 0
    v_add_f32_dpp v84, v84, v84 row_half_mirror row_mask:0xf bank_mask:0xf
    v_mfma_f32_32x32x16_bf16 v[48:63], v[212:215], v[104:107], v[48:63]
    v_add_f32_dpp v85, v85, v85 row_half_mirror row_mask:0xf bank_mask:0xf
    s_add_u32 s35, s50, 0x2000
    s_sub_u32 s35, s35, s94
    s_mov_b32 exec_lo, 0x01010101
    s_mov_b32 exec_hi, 0x01010101
    buffer_store_dwordx2 v[84:85], v5, s[4:7], s35 offen
    s_mov_b64 exec, -1
    s_waitcnt vmcnt(3)
    v_mfma_f32_32x32x16_bf16 v[32:47], v[240:243], v[120:123], v[32:47]
    s_waitcnt vmcnt(2)
    v_mfma_f32_32x32x16_bf16 v[32:47], v[248:251], v[124:127], v[32:47]
    v_mfma_f32_32x32x16_bf16 v[48:63], v[220:223], v[108:111], v[48:63]
    v_mfma_f32_32x32x16_bf16 v[48:63], v[228:231], v[112:115], v[48:63]
    v_mfma_f32_32x32x16_bf16 v[48:63], v[236:239], v[116:119], v[48:63]
    s_nop 8
    ds_write_b128 v3, v[32:35] offset:34816
    v_mfma_f32_32x32x16_bf16 v[48:63], v[244:247], v[120:123], v[48:63]
    ds_write_b128 v3, v[36:39] offset:34832
    ds_write_b128 v3, v[40:43] offset:34848
    v_mfma_f32_32x32x16_bf16 v[48:63], v[252:255], v[124:127], v[48:63]
    ds_write_b128 v3, v[44:47] offset:34864
    s_nop 10
    ds_write_b128 v3, v[48:51] offset:34944
    ds_write_b128 v3, v[52:55] offset:34960
    ds_write_b128 v3, v[56:59] offset:34976
    ds_write_b128 v3, v[60:63] offset:34992
    s_waitcnt lgkmcnt(0)
    s_barrier
    ds_read_b128 v[32:35], v4 offset:34816
    ds_read_b128 v[36:39], v4 offset:34832
    ds_read_b128 v[40:43], v4 offset:43520
    ds_read_b128 v[44:47], v4 offset:43536
    ds_read_b128 v[48:51], v4 offset:52224
    ds_read_b128 v[52:55], v4 offset:52240
    ds_read_b128 v[56:59], v4 offset:60928
    ds_read_b128 v[60:63], v4 offset:60944
    ds_read_b128 v[76:79], v13 offset:0
    ds_read_b128 v[80:83], v13 offset:16
    v_lshlrev_b32 v64, 16, v28
    v_and_b32 v65, s56, v28
    v_lshlrev_b32 v66, 16, v29
    v_and_b32 v67, s56, v29
    v_lshlrev_b32 v68, 16, v30
    s_waitcnt vmcnt(0)
    s_add_u32 s36, s45, 32768
    s_mov_b64 exec, 1
    buffer_store_dword v8, v8, s[4:7], s36 offen offset:0
    s_mov_b64 exec, -1
    v_and_b32 v69, s56, v30
    v_lshlrev_b32 v70, 16, v31
    v_and_b32 v71, s56, v31
    s_waitcnt lgkmcnt(7)
    v_pk_add_f32 v[32:33], v[32:33], v[40:41]
    v_pk_add_f32 v[34:35], v[34:35], v[42:43]
    s_waitcnt lgkmcnt(6)
    v_pk_add_f32 v[36:37], v[36:37], v[44:45]
    v_pk_add_f32 v[38:39], v[38:39], v[46:47]
    s_waitcnt lgkmcnt(3)
    v_pk_add_f32 v[48:49], v[48:49], v[56:57]
    v_pk_add_f32 v[50:51], v[50:51], v[58:59]
    s_waitcnt lgkmcnt(2)
    v_pk_add_f32 v[52:53], v[52:53], v[60:61]
    v_pk_add_f32 v[54:55], v[54:55], v[62:63]
    v_pk_add_f32 v[64:65], v[64:65], v[32:33]
    v_pk_add_f32 v[66:67], v[66:67], v[34:35]
    v_pk_add_f32 v[68:69], v[68:69], v[36:37]
    v_pk_add_f32 v[70:71], v[70:71], v[38:39]
    v_pk_add_f32 v[64:65], v[64:65], v[48:49]
    v_pk_add_f32 v[66:67], v[66:67], v[50:51]
    v_pk_add_f32 v[68:69], v[68:69], v[52:53]
    v_pk_add_f32 v[70:71], v[70:71], v[54:55]
    s_waitcnt lgkmcnt(1)
    v_pk_add_f32 v[64:65], v[64:65], v[76:77]
    v_pk_add_f32 v[66:67], v[66:67], v[78:79]
    s_waitcnt lgkmcnt(0)
    v_pk_add_f32 v[68:69], v[68:69], v[80:81]
    v_pk_add_f32 v[70:71], v[70:71], v[82:83]
    v_cvt_pk_bf16_f32 v28, v64, v65
    v_cvt_pk_bf16_f32 v29, v66, v67
    v_cvt_pk_bf16_f32 v30, v68, v69
    v_cvt_pk_bf16_f32 v31, v70, v71
    v_dot2_f32_bf16 v72, v28, s57, 0
    v_dot2_f32_bf16 v73, v28, v28, 0
    v_dot2_f32_bf16 v72, v29, s57, v72
    v_dot2_f32_bf16 v73, v29, v29, v73
    v_dot2_f32_bf16 v72, v30, s57, v72
    v_dot2_f32_bf16 v73, v30, v30, v73
    v_dot2_f32_bf16 v72, v31, s57, v72
    v_dot2_f32_bf16 v73, v31, v31, v73
    s_nop 1
    v_add_f32_dpp v72, v72, v72 quad_perm:[1,0,3,2] row_mask:0xf bank_mask:0xf
    v_add_f32_dpp v73, v73, v73 quad_perm:[1,0,3,2] row_mask:0xf bank_mask:0xf
    s_nop 0
    v_add_f32_dpp v72, v72, v72 quad_perm:[2,3,0,1] row_mask:0xf bank_mask:0xf
    v_add_f32_dpp v73, v73, v73 quad_perm:[2,3,0,1] row_mask:0xf bank_mask:0xf
    s_nop 0
    v_add_f32_dpp v72, v72, v72 row_half_mirror row_mask:0xf bank_mask:0xf
    v_add_f32_dpp v73, v73, v73 row_half_mirror row_mask:0xf bank_mask:0xf
    s_mov_b32 exec_lo, 0x01010101
    s_mov_b32 exec_hi, 0x01010101
    buffer_store_dwordx2 v[72:73], v5, s[4:7], s44 offen offset:2048
    s_mov_b64 exec, -1
    v_and_b32 v14, 15, v1
    v_mul_u32_u24 v14, 1056, v14
    v_lshrrev_b32_e64 v15, 4, v1
    v_lshl_add_u32 v14, v15, 4, v14
    v_add_u32 v64, s52, v14
    v_add_u32 v65, s53, v14
    v_add_u32 v66, s54, v14
    v_add_u32 v67, s55, v14
    s_add_u32 s37, s46, 32768
    buffer_load_dword v22, v20, s[4:7], s37 offen offset:0 sc1
    ds_read_u16 v40, v23 offset:64
    ds_read_u16 v41, v23 offset:192
    ds_read_u16 v42, v23 offset:320
    ds_read_u16 v43, v23 offset:448
    ds_read_u16 v44, v23 offset:576
    ds_read_u16 v45, v23 offset:704
    ds_read_u16 v46, v23 offset:832
    ds_read_u16 v47, v23 offset:960
    v_lshlrev_b32 v32, 16, v28
    v_and_b32 v33, s56, v28
    v_lshlrev_b32 v34, 16, v29
    v_and_b32 v35, s56, v29
    v_lshlrev_b32 v36, 16, v30
    v_and_b32 v37, s56, v30
    v_lshlrev_b32 v38, 16, v31
    v_and_b32 v39, s56, v31
    s_waitcnt lgkmcnt(7)
    v_lshlrev_b32 v40, 16, v40
    s_waitcnt lgkmcnt(6)
    v_lshlrev_b32 v41, 16, v41
    s_waitcnt lgkmcnt(5)
    v_lshlrev_b32 v42, 16, v42
    s_waitcnt lgkmcnt(4)
    v_lshlrev_b32 v43, 16, v43
    s_waitcnt lgkmcnt(3)
    v_lshlrev_b32 v44, 16, v44
    s_waitcnt lgkmcnt(2)
    v_lshlrev_b32 v45, 16, v45
    s_waitcnt lgkmcnt(1)
    v_lshlrev_b32 v46, 16, v46
    s_waitcnt lgkmcnt(0)
    v_lshlrev_b32_e64 v47, 16, v47
    s_waitcnt vmcnt(0)
    v_cmp_eq_u32 vcc, -1, v22
    s_nop 0
    s_and_b64 vcc, exec, vcc
    s_cbranch_vccz K1_PDONE37
    s_mov_b32 s63, 524288
K1_POLL36:
    buffer_load_dword v22, v20, s[4:7], s37 offen offset:0 sc1
    s_waitcnt vmcnt(0)
    v_cmp_eq_u32 vcc, -1, v22
    s_nop 0
    s_and_b64 vcc, exec, vcc
    s_cbranch_vccz K1_PDONE37
    s_sub_u32 s63, s63, 1
    s_cmp_lg_u32 s63, 0
    s_cbranch_scc1 K1_POLL36
K1_PDONE37:
    s_add_u32 s36, s47, 0x0
    v_lshrrev_b32 v15, 3, v1
    v_mul_u32_u24 v15, 196608, v15
    v_lshl_add_u32 v15, v20, 2, v15
    s_add_u32 m0, s48, 0
    s_nop 0
    buffer_load_dwordx4 v15, s[4:7], s36 offen offset:0 sc1 lds
    s_add_u32 m0, s48, 928
    s_nop 0
    buffer_load_dwordx4 v15, s[4:7], s36 offen offset:128 sc1 lds
    s_add_u32 m0, s48, 1856
    s_nop 0
    buffer_load_dwordx4 v15, s[4:7], s36 offen offset:256 sc1 lds
    s_add_u32 m0, s48, 2784
    s_nop 0
    buffer_load_dwordx4 v15, s[4:7], s36 offen offset:384 sc1 lds
    s_add_u32 m0, s48, 3712
    s_nop 0
    buffer_load_dwordx4 v15, s[4:7], s36 offen offset:512 sc1 lds
    s_add_u32 m0, s48, 4640
    s_nop 0
    buffer_load_dwordx4 v15, s[4:7], s36 offen offset:640 sc1 lds
    s_add_u32 m0, s48, 5568
    s_nop 0
    buffer_load_dwordx4 v15, s[4:7], s36 offen offset:768 sc1 lds
    s_add_u32 m0, s48, 6496
    s_nop 0
    buffer_load_dwordx4 v15, s[4:7], s36 offen offset:896 sc1 lds
    buffer_load_dwordx2 v[120:121], v6, s[4:7], s44 offen offset:2048 sc1
    s_waitcnt vmcnt(1)
    s_barrier
    s_add_u32 s38, s51, 8192
    s_add_u32 s39, s38, 196608
    ds_read_b128 v[84:87], v64 offset:0
    ds_read_b128 v[88:91], v64 offset:16896
    ds_read_b128 v[56:59], v64 offset:64
    ds_read_b128 v[60:63], v64 offset:16960
    s_waitcnt lgkmcnt(2)
    v_mfma_f32_16x16x32_bf16 v[96:99], a[0:3], v[84:87], 0
    ds_read_b128 v[76:79], v64 offset:128
    v_mfma_f32_16x16x32_bf16 v[100:103], a[64:67], v[84:87], 0
    buffer_load_dwordx2 v[72:73], v9, s[4:7], s38 offen offset:128 sc1
    v_mfma_f32_16x16x32_bf16 v[104:107], a[128:131], v[84:87], 0
    ds_read_b128 v[80:83], v64 offset:17024
    s_waitcnt vmcnt(1)
    v_max_u32 v122, v120, v121
    v_cmp_eq_u32 vcc, -1, v122
    s_nop 0
    s_and_b64 vcc, exec, vcc
    s_cbranch_vccz K1_PDONE39
    s_mov_b32 s63, 524288
K1_POLL38:
    buffer_load_dwordx2 v[120:121], v6, s[4:7], s44 offen offset:2048 sc1
    s_waitcnt vmcnt(0)
    v_max_u32_e64 v122, v120, v121
    v_cmp_eq_u32 vcc, -1, v122
    s_nop 0
    s_and_b64 vcc, exec, vcc
    s_cbranch_vccz K1_PDONE39
    s_sub_u32 s63, s63, 1
    s_cmp_lg_u32 s63, 0
    s_cbranch_scc1 K1_POLL38
K1_PDONE39:
    v_mfma_f32_16x16x32_bf16 v[108:111], a[0:3], v[88:91], 0
    buffer_load_dwordx2 v[74:75], v9, s[4:7], s39 offen offset:128 sc1
    v_add_f32_dpp v120, v120, v120 quad_perm:[1,0,3,2] row_mask:0xf bank_mask:0xf
    v_mfma_f32_16x16x32_bf16 v[112:115], a[64:67], v[88:91], 0
    v_add_f32_dpp v121, v121, v121 quad_perm:[1,0,3,2] row_mask:0xf bank_mask:0xf
    v_add_f32_dpp v120, v120, v120 quad_perm:[2,3,0,1] row_mask:0xf bank_mask:0xf
    v_mfma_f32_16x16x32_bf16 v[116:119], a[128:131], v[88:91], 0
    buffer_load_dwordx2 v[92:93], v9, s[4:7], s38 offen offset:0 sc1
    s_waitcnt lgkmcnt(2)
    v_mfma_f32_16x16x32_bf16 v[96:99], a[4:7], v[56:59], v[96:99]
    ds_read_b128 v[84:87], v64 offset:192
    v_add_f32_dpp v121, v121, v121 quad_perm:[2,3,0,1] row_mask:0xf bank_mask:0xf
    v_mfma_f32_16x16x32_bf16 v[100:103], a[68:71], v[56:59], v[100:103]
    buffer_load_dwordx2 v[94:95], v9, s[4:7], s39 offen offset:0 sc1
    v_add_f32_dpp v120, v120, v120 row_half_mirror row_mask:0xf bank_mask:0xf
    v_mfma_f32_16x16x32_bf16 v[104:107], a[132:135], v[56:59], v[104:107]
    ds_read_b128 v[88:91], v64 offset:17088
    v_add_f32_dpp v121, v121, v121 row_half_mirror row_mask:0xf bank_mask:0xf
    v_mfma_f32_16x16x32_bf16 v[108:111], a[4:7], v[60:63], v[108:111]
    v_mul_f32 v120, s62, v120
    v_mul_f32_e64 v121, s62, v121
    v_mfma_f32_16x16x32_bf16 v[112:115], a[68:71], v[60:63], v[112:115]
    v_fma_f32 v121, -v120, v120, v121
    v_max_f32_e64 v121, 0, v121
    v_mfma_f32_16x16x32_bf16 v[116:119], a[132:135], v[60:63], v[116:119]
    v_add_f32 v121, 0x3727c5ac, v121
    s_waitcnt lgkmcnt(2)
    v_mfma_f32_16x16x32_bf16 v[96:99], a[8:11], v[76:79], v[96:99]
    ds_read_b128 v[56:59], v65 offset:0
    v_mfma_f32_16x16x32_bf16 v[100:103], a[72:75], v[76:79], v[100:103]
    v_rsq_f32 v122, v121
    v_mfma_f32_16x16x32_bf16 v[104:107], a[136:139], v[76:79], v[104:107]
    ds_read_b128 v[60:63], v65 offset:16896
    v_mul_f32_e64 v120, -1.0, v120
    v_mfma_f32_16x16x32_bf16 v[108:111], a[8:11], v[80:83], v[108:111]
    v_mul_f32_e64 v123, v120, v122
    v_fma_f32 v48, v32, v122, v123
    v_mfma_f32_16x16x32_bf16 v[112:115], a[72:75], v[80:83], v[112:115]
    v_fma_f32 v49, v33, v122, v123
    v_fma_f32 v50, v34, v122, v123
    v_mfma_f32_16x16x32_bf16 v[116:119], a[136:139], v[80:83], v[116:119]
    v_fma_f32 v51, v35, v122, v123
    s_waitcnt lgkmcnt(2)
    v_mfma_f32_16x16x32_bf16 v[96:99], a[12:15], v[84:87], v[96:99]
    ds_read_b128 v[76:79], v65 offset:64
    v_fma_f32 v52, v36, v122, v123
    v_mfma_f32_16x16x32_bf16 v[100:103], a[76:79], v[84:87], v[100:103]
    v_fma_f32 v53, v37, v122, v123
    v_fma_f32 v54, v38, v122, v123
    v_mfma_f32_16x16x32_bf16 v[104:107], a[140:143], v[84:87], v[104:107]
    ds_read_b128 v[80:83], v65 offset:16960
    v_fma_f32 v55, v39, v122, v123
    v_mfma_f32_16x16x32_bf16 v[108:111], a[12:15], v[88:91], v[108:111]
    v_fmac_f32 v32, v48, v40
    v_fmac_f32_e64 v33, v49, v41
    v_mfma_f32_16x16x32_bf16 v[112:115], a[76:79], v[88:91], v[112:115]
    v_fmac_f32 v34, v50, v42
    v_fmac_f32 v35, v51, v43
    v_mfma_f32_16x16x32_bf16 v[116:119], a[140:143], v[88:91], v[116:119]
    v_fmac_f32 v36, v52, v44
    s_waitcnt lgkmcnt(2)
    v_mfma_f32_16x16x32_bf16 v[96:99], a[16:19], v[56:59], v[96:99]
    ds_read_b128 v[84:87], v65 offset:128
    v_fmac_f32_e64 v37, v53, v45
    v_mfma_f32_16x16x32_bf16 v[100:103], a[80:83], v[56:59], v[100:103]
    v_fmac_f32 v38, v54, v46
    v_fmac_f32 v39, v55, v47
    v_mfma_f32_16x16x32_bf16 v[104:107], a[144:147], v[56:59], v[104:107]
    ds_read_b128 v[88:91], v65 offset:17024
    v_cvt_pk_bf16_f32 v28, v32, v33
    v_mfma_f32_16x16x32_bf16 v[108:111], a[16:19], v[60:63], v[108:111]
    v_cvt_pk_bf16_f32 v29, v34, v35
    v_cvt_pk_bf16_f32 v30, v36, v37
    v_mfma_f32_16x16x32_bf16 v[112:115], a[80:83], v[60:63], v[112:115]
    v_cvt_pk_bf16_f32 v31, v38, v39
    s_add_u32 s35, s50, 0x1000
    v_mfma_f32_16x16x32_bf16 v[116:119], a[144:147], v[60:63], v[116:119]
    buffer_store_dwordx4 v[28:31], v10, s[4:7], s35 offen
    s_waitcnt lgkmcnt(2)
    v_mfma_f32_16x16x32_bf16 v[96:99], a[20:23], v[76:79], v[96:99]
    ds_read_b128 v[56:59], v65 offset:192
    v_lshlrev_b32 v32, 16, v28
    v_mfma_f32_16x16x32_bf16 v[100:103], a[84:87], v[76:79], v[100:103]
    v_and_b32 v33, s56, v28
    v_lshlrev_b32 v34, 16, v29
    v_mfma_f32_16x16x32_bf16 v[104:107], a[148:151], v[76:79], v[104:107]
    ds_read_b128 v[60:63], v65 offset:17088
    v_and_b32_e64 v35, s56, v29
    v_mfma_f32_16x16x32_bf16 v[108:111], a[20:23], v[80:83], v[108:111]
    v_lshlrev_b32 v36, 16, v30
    v_and_b32 v37, s56, v30
    v_mfma_f32_16x16x32_bf16 v[112:115], a[84:87], v[80:83], v[112:115]
    v_lshlrev_b32 v38, 16, v31
    v_and_b32 v39, s56, v31
    v_mfma_f32_16x16x32_bf16 v[116:119], a[148:151], v[80:83], v[116:119]
    v_add_f32 v48, v32, v33
    s_waitcnt lgkmcnt(2)
    v_mfma_f32_16x16x32_bf16 v[96:99], a[24:27], v[84:87], v[96:99]
    ds_read_b128 v[76:79], v66 offset:0
    v_mul_f32_e64 v49, v32, v32
    v_mfma_f32_16x16x32_bf16 v[100:103], a[88:91], v[84:87], v[100:103]
    v_fmac_f32 v49, v33, v33
    v_add_f32 v48, v48, v34
    v_mfma_f32_16x16x32_bf16 v[104:107], a[152:155], v[84:87], v[104:107]
    ds_read_b128 v[80:83], v66 offset:16896
    v_fmac_f32_e64 v49, v34, v34
    v_mfma_f32_16x16x32_bf16 v[108:111], a[24:27], v[88:91], v[108:111]
    v_add_f32 v48, v48, v35
    v_fmac_f32 v49, v35, v35
    v_mfma_f32_16x16x32_bf16 v[112:115], a[88:91], v[88:91], v[112:115]
    v_add_f32 v48, v48, v36
    v_fmac_f32 v49, v36, v36
    v_mfma_f32_16x16x32_bf16 v[116:119], a[152:155], v[88:91], v[116:119]
    v_add_f32 v48, v48, v37
    s_waitcnt lgkmcnt(2)
    v_mfma_f32_16x16x32_bf16 v[96:99], a[28:31], v[56:59], v[96:99]
    ds_read_b128 v[84:87], v66 offset:64
    v_fmac_f32_e64 v49, v37, v37
    v_mfma_f32_16x16x32_bf16 v[100:103], a[92:95], v[56:59], v[100:103]
    v_add_f32 v48, v48, v38
    v_fmac_f32 v49, v38, v38
    v_mfma_f32_16x16x32_bf16 v[104:107], a[156:159], v[56:59], v[104:107]
    ds_read_b128 v[88:91], v66 offset:16960
    v_add_f32_e64 v48, v48, v39
    v_mfma_f32_16x16x32_bf16 v[108:111], a[28:31], v[60:63], v[108:111]
    v_fmac_f32_e64 v49, v39, v39
    v_add_f32_dpp v48, v48, v48 quad_perm:[1,0,3,2] row_mask:0xf bank_mask:0xf
    v_mfma_f32_16x16x32_bf16 v[112:115], a[92:95], v[60:63], v[112:115]
    v_add_f32_dpp v49, v49, v49 quad_perm:[1,0,3,2] row_mask:0xf bank_mask:0xf
    v_add_f32_dpp v48, v48, v48 quad_perm:[2,3,0,1] row_mask:0xf bank_mask:0xf
    v_mfma_f32_16x16x32_bf16 v[116:119], a[156:159], v[60:63], v[116:119]
    v_add_f32_dpp v49, v49, v49 quad_perm:[2,3,0,1] row_mask:0xf bank_mask:0xf
    s_waitcnt lgkmcnt(2)
    v_mfma_f32_16x16x32_bf16 v[96:99], a[32:35], v[76:79], v[96:99]
    ds_read_b128 v[56:59], v66 offset:128
    v_add_f32_dpp v48, v48, v48 row_half_mirror row_mask:0xf bank_mask:0xf
    v_mfma_f32_16x16x32_bf16 v[100:103], a[96:99], v[76:79], v[100:103]
    v_add_f32_dpp v49, v49, v49 row_half_mirror row_mask:0xf bank_mask:0xf
    s_add_u32 s35, s50, 0x2100
    s_sub_u32 s35, s35, s94
    s_mov_b32 exec_lo, 0x01010101
    s_mov_b32 exec_hi, 0x01010101
    buffer_store_dwordx2 v[48:49], v5, s[4:7], s35 offen
    s_mov_b64 exec, -1
    v_mfma_f32_16x16x32_bf16 v[104:107], a[160:163], v[76:79], v[104:107]
    ds_read_b128 v[60:63], v66 offset:17024
    s_waitcnt vmcnt(4)
    v_add_f32_e64 v72, v72, v74
    v_mfma_f32_16x16x32_bf16 v[108:111], a[32:35], v[80:83], v[108:111]
    v_add_f32 v73, v73, v75
    v_mov_b32 v74, v72
    v_mfma_f32_16x16x32_bf16 v[112:115], a[96:99], v[80:83], v[112:115]
    v_mov_b32 v75, v73
    v_permlane32_swap_b32 v74, v72
    v_mfma_f32_16x16x32_bf16 v[116:119], a[160:163], v[80:83], v[116:119]
    v_permlane32_swap_b32 v75, v73
    s_waitcnt lgkmcnt(2)
    v_mfma_f32_16x16x32_bf16 v[96:99], a[36:39], v[84:87], v[96:99]
    ds_read_b128 v[76:79], v66 offset:192
    v_add_f32_e64 v72, v72, v74
    v_mfma_f32_16x16x32_bf16 v[100:103], a[100:103], v[84:87], v[100:103]
    v_add_f32 v73, v73, v75
    v_mov_b32 v74, v72
    v_mfma_f32_16x16x32_bf16 v[104:107], a[164:167], v[84:87], v[104:107]
    ds_read_b128 v[80:83], v66 offset:17088
    v_mov_b32_e64 v75, v73
    v_mfma_f32_16x16x32_bf16 v[108:111], a[36:39], v[88:91], v[108:111]
    v_permlane16_swap_b32 v74, v72
    v_permlane16_swap_b32 v75, v73
    v_mfma_f32_16x16x32_bf16 v[112:115], a[100:103], v[88:91], v[112:115]
    v_add_f32 v72, v72, v74
    v_add_f32 v73, v73, v75
    v_mfma_f32_16x16x32_bf16 v[116:119], a[164:167], v[88:91], v[116:119]
    v_mul_f32 v72, s62, v72
    s_waitcnt lgkmcnt(2)
    v_mfma_f32_16x16x32_bf16 v[96:99], a[40:43], v[56:59], v[96:99]
    ds_read_b128 v[84:87], v67 offset:0
    v_mul_f32_e64 v73, s62, v73
    v_mfma_f32_16x16x32_bf16 v[100:103], a[104:107], v[56:59], v[100:103]
    v_fma_f32 v73, -v72, v72, v73
    v_max_f32_e64 v73, 0, v73
    v_mfma_f32_16x16x32_bf16 v[104:107], a[168:171], v[56:59], v[104:107]
    ds_read_b128 v[88:91], v67 offset:16896
    v_add_f32 v73, 0x3727c5ac, v73
    v_mfma_f32_16x16x32_bf16 v[108:111], a[40:43], v[60:63], v[108:111]
    v_rsq_f32_e64 v70, v73
    v_mfma_f32_16x16x32_bf16 v[112:115], a[104:107], v[60:63], v[112:115]
    v_mul_f32_e64 v72, -1.0, v72
    v_mfma_f32_16x16x32_bf16 v[116:119], a[168:171], v[60:63], v[116:119]
    v_mul_f32 v71, v72, v70
    s_waitcnt lgkmcnt(2)
    v_mfma_f32_16x16x32_bf16 v[96:99], a[44:47], v[76:79], v[96:99]
    ds_read_b128 v[56:59], v67 offset:64
    v_mfma_f32_16x16x32_bf16 v[100:103], a[108:111], v[76:79], v[100:103]
    s_waitcnt vmcnt(2)
    v_add_f32 v92, v92, v94
    v_mfma_f32_16x16x32_bf16 v[104:107], a[172:175], v[76:79], v[104:107]
    ds_read_b128 v[60:63], v67 offset:16960
    v_add_f32_e64 v93, v93, v95
    v_mfma_f32_16x16x32_bf16 v[108:111], a[44:47], v[80:83], v[108:111]
    v_mov_b32_e64 v94, v92
    v_mfma_f32_16x16x32_bf16 v[112:115], a[108:111], v[80:83], v[112:115]
    v_mov_b32_e64 v95, v93
    v_mfma_f32_16x16x32_bf16 v[116:119], a[172:175], v[80:83], v[116:119]
    v_permlane32_swap_b32 v94, v92
    s_waitcnt lgkmcnt(2)
    v_mfma_f32_16x16x32_bf16 v[96:99], a[48:51], v[84:87], v[96:99]
    ds_read_b128 v[76:79], v67 offset:128
    v_mfma_f32_16x16x32_bf16 v[100:103], a[112:115], v[84:87], v[100:103]
    v_permlane32_swap_b32_e64 v95, v93
    v_mfma_f32_16x16x32_bf16 v[104:107], a[176:179], v[84:87], v[104:107]
    ds_read_b128 v[80:83], v67 offset:17024
    v_add_f32_e64 v92, v92, v94
    v_mfma_f32_16x16x32_bf16 v[108:111], a[48:51], v[88:91], v[108:111]
    v_add_f32_e64 v93, v93, v95
    v_mfma_f32_16x16x32_bf16 v[112:115], a[112:115], v[88:91], v[112:115]
    v_mov_b32_e64 v94, v92
    v_mfma_f32_16x16x32_bf16 v[116:119], a[176:179], v[88:91], v[116:119]
    s_waitcnt lgkmcnt(2)
    v_mfma_f32_16x16x32_bf16 v[96:99], a[52:55], v[56:59], v[96:99]
    ds_read_b128 v[84:87], v67 offset:192
    s_waitcnt vmcnt(0)
    s_add_u32 s36, s45, 49152
    s_mov_b64 exec, 1
    buffer_store_dword v8, v8, s[4:7], s36 offen offset:0
    s_mov_b64 exec, -1
    v_mfma_f32_16x16x32_bf16 v[100:103], a[116:119], v[56:59], v[100:103]
    v_mov_b32 v95, v93
    v_permlane16_swap_b32 v94, v92
    v_mfma_f32_16x16x32_bf16 v[104:107], a[180:183], v[56:59], v[104:107]
    ds_read_b128 v[88:91], v67 offset:17088
    v_permlane16_swap_b32_e64 v95, v93
    v_mfma_f32_16x16x32_bf16 v[108:111], a[52:55], v[60:63], v[108:111]
    v_add_f32_e64 v92, v92, v94
    v_mfma_f32_16x16x32_bf16 v[112:115], a[116:119], v[60:63], v[112:115]
    v_add_f32_e64 v93, v93, v95
    v_mfma_f32_16x16x32_bf16 v[116:119], a[180:183], v[60:63], v[116:119]
    s_waitcnt lgkmcnt(2)
    v_mfma_f32_16x16x32_bf16 v[96:99], a[56:59], v[76:79], v[96:99]
    v_mul_f32 v92, s62, v92
    v_mfma_f32_16x16x32_bf16 v[100:103], a[120:123], v[76:79], v[100:103]
    ds_read_b128 v[136:139], v12 offset:0
    v_mul_f32_e64 v93, s62, v93
    v_mfma_f32_16x16x32_bf16 v[104:107], a[184:187], v[76:79], v[104:107]
    v_fma_f32 v93, -v92, v92, v93
    v_mfma_f32_16x16x32_bf16 v[108:111], a[56:59], v[80:83], v[108:111]
    ds_read_b128 v[140:143], v12 offset:16
    v_max_f32_e64 v93, 0, v93
    v_mfma_f32_16x16x32_bf16 v[112:115], a[120:123], v[80:83], v[112:115]
    v_mfma_f32_16x16x32_bf16 v[116:119], a[184:187], v[80:83], v[116:119]
    v_add_f32 v93, 0x3727c5ac, v93
    s_waitcnt lgkmcnt(2)
    v_mfma_f32_16x16x32_bf16 v[96:99], a[60:63], v[84:87], v[96:99]
    v_rsq_f32 v68, v93
    v_mfma_f32_16x16x32_bf16 v[100:103], a[124:127], v[84:87], v[100:103]
    v_mul_f32_e64 v92, -1.0, v92
    v_mfma_f32_16x16x32_bf16 v[104:107], a[188:191], v[84:87], v[104:107]
    v_mul_f32_e64 v69, v92, v68
    v_mfma_f32_16x16x32_bf16 v[108:111], a[60:63], v[88:91], v[108:111]
    v_mfma_f32_16x16x32_bf16 v[112:115], a[124:127], v[88:91], v[112:115]
    v_mfma_f32_16x16x32_bf16 v[116:119], a[188:191], v[88:91], v[116:119]
    s_add_u32 s37, s46, 49152
    buffer_load_dword v22, v20, s[4:7], s37 offen offset:0 sc1
    s_add_u32 s35, s40, 11264
    s_cmp_eq_u32 s16, 3
    s_cselect_b32 s39, s90, s35
    s_waitcnt lgkmcnt(0)
    v_pk_fma_f32 v[120:121], v[68:69], v[140:141], v[136:137] op_sel:[1,0,0] op_sel_hi:[1,1,1]
    v_pk_fma_f32 v[122:123], v[68:69], v[142:143], v[138:139] op_sel:[1,0,0] op_sel_hi:[1,1,1]
    v_pk_fma_f32 v[124:125], v[70:71], v[140:141], v[136:137] op_sel:[1,0,0] op_sel_hi:[1,1,1]
    v_pk_fma_f32 v[126:127], v[70:71], v[142:143], v[138:139] op_sel:[1,0,0] op_sel_hi:[1,1,1]
    ds_read_b128 v[136:139], v12 offset:128
    ds_read_b128 v[140:143], v12 offset:144
    v_pk_fma_f32 v[120:121], v[68:69], v[96:97], v[120:121] op_sel_hi:[0,1,1]
    v_pk_fma_f32 v[122:123], v[68:69], v[98:99], v[122:123] op_sel_hi:[0,1,1]
    v_pk_fma_f32 v[124:125], v[70:71], v[108:109], v[124:125] op_sel_hi:[0,1,1]
    v_pk_fma_f32 v[126:127], v[70:71], v[110:111], v[126:127] op_sel_hi:[0,1,1]
    v_pk_mul_f32 v[128:129], v[120:121], v[120:121]
    v_pk_mul_f32 v[130:131], v[122:123], v[122:123]
    v_pk_mul_f32 v[132:133], v[124:125], v[124:125]
    v_pk_mul_f32 v[134:135], v[126:127], v[126:127]
    v_pk_fma_f32 v[128:129], v[128:129], s[58:59], v[0:1] op_sel_hi:[1,1,0]
    v_pk_fma_f32 v[130:131], v[130:131], s[58:59], v[0:1] op_sel_hi:[1,1,0]
    v_pk_fma_f32 v[132:133], v[132:133], s[58:59], v[0:1] op_sel_hi:[1,1,0]
    v_pk_fma_f32 v[134:135], v[134:135], s[58:59], v[0:1] op_sel_hi:[1,1,0]
    v_pk_mul_f32 v[128:129], v[120:121], v[128:129]
    v_pk_mul_f32 v[130:131], v[122:123], v[130:131]
    v_pk_mul_f32 v[132:133], v[124:125], v[132:133]
    v_pk_mul_f32 v[134:135], v[126:127], v[134:135]
    v_exp_f32 v128, v128
    v_exp_f32 v129, v129
    v_exp_f32 v130, v130
    v_exp_f32 v131, v131
    v_exp_f32 v132, v132
    v_exp_f32 v133, v133
    v_exp_f32 v134, v134
    v_exp_f32_e64 v135, v135
    v_pk_add_f32 v[128:129], v[128:129], 1.0 op_sel_hi:[1,0]
    v_pk_add_f32 v[130:131], v[130:131], 1.0 op_sel_hi:[1,0]
    v_pk_add_f32 v[132:133], v[132:133], 1.0 op_sel_hi:[1,0]
    v_pk_add_f32 v[134:135], v[134:135], 1.0 op_sel_hi:[1,0]
    v_rcp_f32 v128, v128
    v_rcp_f32 v129, v129
    v_rcp_f32 v130, v130
    v_rcp_f32 v131, v131
    v_rcp_f32 v132, v132
    v_rcp_f32 v133, v133
    v_rcp_f32 v134, v134
    v_rcp_f32 v135, v135
    v_pk_mul_f32 v[120:121], v[120:121], v[128:129]
    v_pk_mul_f32 v[122:123], v[122:123], v[130:131]
    v_pk_mul_f32 v[124:125], v[124:125], v[132:133]
    v_pk_mul_f32 v[126:127], v[126:127], v[134:135]
    v_cvt_pk_bf16_f32 v128, v120, v121
    v_cvt_pk_bf16_f32 v129, v122, v123
    v_cvt_pk_bf16_f32 v130, v124, v125
    s_waitcnt vmcnt(0)
    v_cmp_eq_u32 vcc, -1, v22
    s_nop 0
    s_and_b64 vcc, exec, vcc
    s_cbranch_vccz K1_PDONE41
    s_mov_b32 s63, 524288
K1_POLL40:
    buffer_load_dword v22, v20, s[4:7], s37 offen offset:0 sc1
    s_waitcnt vmcnt(0)
    v_cmp_eq_u32 vcc, -1, v22
    s_nop 0
    s_and_b64 vcc, exec, vcc
    s_cbranch_vccz K1_PDONE41
    s_sub_u32 s63, s63, 1
    s_cmp_lg_u32 s63, 0
    s_cbranch_scc1 K1_POLL40
K1_PDONE41:
    v_cvt_pk_bf16_f32 v131, v126, v127
    v_permlane32_swap_b32 v128, v130
    s_nop 0
    v_permlane32_swap_b32 v129, v131
    buffer_store_dwordx4 v[128:131], v2, s[4:7], s35 offen offset:0
    s_add_u32 s36, s47, 0x1000
    v_lshrrev_b32_e64 v15, 3, v1
    v_mul_u32_u24 v15, 196608, v15
    v_lshl_add_u32 v15, v20, 2, v15
    s_waitcnt lgkmcnt(0)
    v_pk_fma_f32 v[120:121], v[68:69], v[140:141], v[136:137] op_sel:[1,0,0] op_sel_hi:[1,1,1]
    v_pk_fma_f32 v[122:123], v[68:69], v[142:143], v[138:139] op_sel:[1,0,0] op_sel_hi:[1,1,1]
    v_pk_fma_f32 v[124:125], v[70:71], v[140:141], v[136:137] op_sel:[1,0,0] op_sel_hi:[1,1,1]
    v_pk_fma_f32 v[126:127], v[70:71], v[142:143], v[138:139] op_sel:[1,0,0] op_sel_hi:[1,1,1]
    ds_read_b128 v[136:139], v12 offset:256
    s_add_u32 m0, s48, 33792
    s_nop 0
    buffer_load_dwordx4 v15, s[4:7], s36 offen offset:0 sc1 lds
    ds_read_b128 v[140:143], v12 offset:272
    v_pk_fma_f32 v[120:121], v[68:69], v[100:101], v[120:121] op_sel_hi:[0,1,1]
    v_pk_fma_f32 v[122:123], v[68:69], v[102:103], v[122:123] op_sel_hi:[0,1,1]
    v_pk_fma_f32 v[124:125], v[70:71], v[112:113], v[124:125] op_sel_hi:[0,1,1]
    s_add_u32 m0, s48, 34720
    s_nop 0
    buffer_load_dwordx4 v15, s[4:7], s36 offen offset:128 sc1 lds
    v_pk_fma_f32 v[126:127], v[70:71], v[114:115], v[126:127] op_sel_hi:[0,1,1]
    v_pk_mul_f32 v[128:129], v[120:121], v[120:121]
    v_pk_mul_f32 v[130:131], v[122:123], v[122:123]
    v_pk_mul_f32 v[132:133], v[124:125], v[124:125]
    v_pk_mul_f32 v[134:135], v[126:127], v[126:127]
    s_add_u32 m0, s48, 35648
    s_nop 0
    buffer_load_dwordx4 v15, s[4:7], s36 offen offset:256 sc1 lds
    v_pk_fma_f32 v[128:129], v[128:129], s[58:59], v[0:1] op_sel_hi:[1,1,0]
    v_pk_fma_f32 v[130:131], v[130:131], s[58:59], v[0:1] op_sel_hi:[1,1,0]
    v_pk_fma_f32 v[132:133], v[132:133], s[58:59], v[0:1] op_sel_hi:[1,1,0]
    v_pk_fma_f32 v[134:135], v[134:135], s[58:59], v[0:1] op_sel_hi:[1,1,0]
    s_add_u32 m0, s48, 36576
    s_nop 0
    buffer_load_dwordx4 v15, s[4:7], s36 offen offset:384 sc1 lds
    v_pk_mul_f32 v[128:129], v[120:121], v[128:129]
    v_pk_mul_f32 v[130:131], v[122:123], v[130:131]
    v_pk_mul_f32 v[132:133], v[124:125], v[132:133]
    v_pk_mul_f32 v[134:135], v[126:127], v[134:135]
    v_exp_f32 v128, v128
    s_add_u32 m0, s48, 37504
    s_nop 0
    buffer_load_dwordx4 v15, s[4:7], s36 offen offset:512 sc1 lds
    v_exp_f32 v129, v129
    v_exp_f32 v130, v130
    v_exp_f32 v131, v131
    v_exp_f32_e64 v132, v132
    s_add_u32 m0, s48, 38432
    s_nop 0
    buffer_load_dwordx4 v15, s[4:7], s36 offen offset:640 sc1 lds
    v_exp_f32 v133, v133
    v_exp_f32 v134, v134
    v_exp_f32 v135, v135
    v_pk_add_f32 v[128:129], v[128:129], 1.0 op_sel_hi:[1,0]
    v_pk_add_f32 v[130:131], v[130:131], 1.0 op_sel_hi:[1,0]
    s_add_u32 m0, s48, 39360
    s_nop 0
    buffer_load_dwordx4 v15, s[4:7], s36 offen offset:768 sc1 lds
    v_pk_add_f32 v[132:133], v[132:133], 1.0 op_sel_hi:[1,0]
    v_pk_add_f32 v[134:135], v[134:135], 1.0 op_sel_hi:[1,0]
    v_rcp_f32 v128, v128
    v_rcp_f32_e64 v129, v129
    s_add_u32 m0, s48, 40288
    s_nop 0
    buffer_load_dwordx4 v15, s[4:7], s36 offen offset:896 sc1 lds
    v_rcp_f32 v130, v130
    v_rcp_f32 v131, v131
    v_rcp_f32 v132, v132
    v_rcp_f32 v133, v133
    v_rcp_f32 v134, v134
    v_rcp_f32_e64 v135, v135
    v_pk_mul_f32 v[120:121], v[120:121], v[128:129]
    v_pk_mul_f32 v[122:123], v[122:123], v[130:131]
    v_pk_mul_f32 v[124:125], v[124:125], v[132:133]
    v_pk_mul_f32 v[126:127], v[126:127], v[134:135]
    v_cvt_pk_bf16_f32 v128, v120, v121
    v_cvt_pk_bf16_f32 v129, v122, v123
    v_cvt_pk_bf16_f32 v130, v124, v125
    v_cvt_pk_bf16_f32 v131, v126, v127
    s_nop 0
    v_permlane32_swap_b32 v128, v130
    v_permlane32_swap_b32_e64 v129, v131
    buffer_store_dwordx4 v[128:131], v2, s[4:7], s35 offen offset:1024
    s_waitcnt lgkmcnt(0)
    v_pk_fma_f32 v[120:121], v[68:69], v[140:141], v[136:137] op_sel:[1,0,0] op_sel_hi:[1,1,1]
    v_pk_fma_f32 v[122:123], v[68:69], v[142:143], v[138:139] op_sel:[1,0,0] op_sel_hi:[1,1,1]
    v_pk_fma_f32 v[124:125], v[70:71], v[140:141], v[136:137] op_sel:[1,0,0] op_sel_hi:[1,1,1]
    v_pk_fma_f32 v[126:127], v[70:71], v[142:143], v[138:139] op_sel:[1,0,0] op_sel_hi:[1,1,1]
    v_pk_fma_f32 v[120:121], v[68:69], v[104:105], v[120:121] op_sel_hi:[0,1,1]
    v_pk_fma_f32 v[122:123], v[68:69], v[106:107], v[122:123] op_sel_hi:[0,1,1]
    v_pk_fma_f32 v[124:125], v[70:71], v[116:117], v[124:125] op_sel_hi:[0,1,1]
    v_pk_fma_f32 v[126:127], v[70:71], v[118:119], v[126:127] op_sel_hi:[0,1,1]
    v_pk_mul_f32 v[128:129], v[120:121], v[120:121]
    v_pk_mul_f32 v[130:131], v[122:123], v[122:123]
    v_pk_mul_f32 v[132:133], v[124:125], v[124:125]
    v_pk_mul_f32 v[134:135], v[126:127], v[126:127]
    v_pk_fma_f32 v[128:129], v[128:129], s[58:59], v[0:1] op_sel_hi:[1,1,0]
    v_pk_fma_f32 v[130:131], v[130:131], s[58:59], v[0:1] op_sel_hi:[1,1,0]
    v_pk_fma_f32 v[132:133], v[132:133], s[58:59], v[0:1] op_sel_hi:[1,1,0]
    v_pk_fma_f32 v[134:135], v[134:135], s[58:59], v[0:1] op_sel_hi:[1,1,0]
    v_pk_mul_f32 v[128:129], v[120:121], v[128:129]
    v_pk_mul_f32 v[130:131], v[122:123], v[130:131]
    v_pk_mul_f32 v[132:133], v[124:125], v[132:133]
    v_pk_mul_f32 v[134:135], v[126:127], v[134:135]
    v_exp_f32 v128, v128
    v_exp_f32 v129, v129
    v_exp_f32 v130, v130
    v_exp_f32 v131, v131
    v_exp_f32 v132, v132
    v_exp_f32 v133, v133
    v_exp_f32 v134, v134
    v_exp_f32_e64 v135, v135
    v_pk_add_f32 v[128:129], v[128:129], 1.0 op_sel_hi:[1,0]
    v_pk_add_f32 v[130:131], v[130:131], 1.0 op_sel_hi:[1,0]
    v_pk_add_f32 v[132:133], v[132:133], 1.0 op_sel_hi:[1,0]
    v_pk_add_f32 v[134:135], v[134:135], 1.0 op_sel_hi:[1,0]
    v_rcp_f32 v128, v128
    v_rcp_f32 v129, v129
    v_rcp_f32 v130, v130
    v_rcp_f32 v131, v131
    v_rcp_f32 v132, v132
    v_rcp_f32 v133, v133
    v_rcp_f32 v134, v134
    v_rcp_f32 v135, v135
    v_pk_mul_f32 v[120:121], v[120:121], v[128:129]
    v_pk_mul_f32 v[122:123], v[122:123], v[130:131]
    v_pk_mul_f32 v[124:125], v[124:125], v[132:133]
    v_pk_mul_f32 v[126:127], v[126:127], v[134:135]
    v_cvt_pk_bf16_f32 v128, v120, v121
    v_cvt_pk_bf16_f32 v129, v122, v123
    v_cvt_pk_bf16_f32 v130, v124, v125
    v_cvt_pk_bf16_f32 v131, v126, v127
    s_nop 0
    v_permlane32_swap_b32 v128, v130
    s_waitcnt vmcnt(1)
    s_barrier
    ds_read_b128 v[84:87], v64 offset:33792
    ds_read_b128 v[88:91], v64 offset:50688
    ds_read_b128 v[56:59], v64 offset:33856
    ds_read_b128 v[60:63], v64 offset:50752
    v_permlane32_swap_b32_e64 v129, v131
    buffer_store_dwordx4 v[128:131], v2, s[4:7], s39 offen offset:2048
    s_add_u32 s38, s51, 8448
    s_add_u32 s39, s38, 196608
    s_waitcnt lgkmcnt(2)
    v_mfma_f32_16x16x32_bf16 v[32:35], a[0:3], v[84:87], 0
    ds_read_b128 v[76:79], v64 offset:33920
    v_mfma_f32_16x16x32_bf16 v[36:39], a[64:67], v[84:87], 0
    buffer_load_dwordx2 v[72:73], v9, s[4:7], s38 offen offset:128 sc1
    v_mfma_f32_16x16x32_bf16 v[40:43], a[128:131], v[84:87], 0
    ds_read_b128 v[80:83], v64 offset:50816
    v_mfma_f32_16x16x32_bf16 v[44:47], a[0:3], v[88:91], 0
    buffer_load_dwordx2 v[74:75], v9, s[4:7], s39 offen offset:128 sc1
    v_mfma_f32_16x16x32_bf16 v[48:51], a[64:67], v[88:91], 0
    v_mfma_f32_16x16x32_bf16 v[52:55], a[128:131], v[88:91], 0
    buffer_load_dwordx2 v[92:93], v9, s[4:7], s38 offen offset:0 sc1
    s_waitcnt lgkmcnt(2)
    v_mfma_f32_16x16x32_bf16 v[32:35], a[4:7], v[56:59], v[32:35]
    ds_read_b128 v[84:87], v64 offset:33984
    v_mfma_f32_16x16x32_bf16 v[36:39], a[68:71], v[56:59], v[36:39]
    buffer_load_dwordx2 v[94:95], v9, s[4:7], s39 offen offset:0 sc1
    v_mfma_f32_16x16x32_bf16 v[40:43], a[132:135], v[56:59], v[40:43]
    ds_read_b128 v[88:91], v64 offset:50880
    v_mfma_f32_16x16x32_bf16 v[44:47], a[4:7], v[60:63], v[44:47]
    v_mfma_f32_16x16x32_bf16 v[48:51], a[68:71], v[60:63], v[48:51]
    v_mfma_f32_16x16x32_bf16 v[52:55], a[132:135], v[60:63], v[52:55]
    s_waitcnt lgkmcnt(2)
    v_mfma_f32_16x16x32_bf16 v[32:35], a[8:11], v[76:79], v[32:35]
    ds_read_b128 v[56:59], v65 offset:33792
    v_mfma_f32_16x16x32_bf16 v[36:39], a[72:75], v[76:79], v[36:39]
    v_mfma_f32_16x16x32_bf16 v[40:43], a[136:139], v[76:79], v[40:43]
    ds_read_b128 v[60:63], v65 offset:50688
    v_mfma_f32_16x16x32_bf16 v[44:47], a[8:11], v[80:83], v[44:47]
    v_mfma_f32_16x16x32_bf16 v[48:51], a[72:75], v[80:83], v[48:51]
    v_mfma_f32_16x16x32_bf16 v[52:55], a[136:139], v[80:83], v[52:55]
    s_waitcnt lgkmcnt(2)
    v_mfma_f32_16x16x32_bf16 v[32:35], a[12:15], v[84:87], v[32:35]
    ds_read_b128 v[76:79], v65 offset:33856
    v_mfma_f32_16x16x32_bf16 v[36:39], a[76:79], v[84:87], v[36:39]
    v_mfma_f32_16x16x32_bf16 v[40:43], a[140:143], v[84:87], v[40:43]
    ds_read_b128 v[80:83], v65 offset:50752
    v_mfma_f32_16x16x32_bf16 v[44:47], a[12:15], v[88:91], v[44:47]
    v_mfma_f32_16x16x32_bf16 v[48:51], a[76:79], v[88:91], v[48:51]
    v_mfma_f32_16x16x32_bf16 v[52:55], a[140:143], v[88:91], v[52:55]
    s_waitcnt lgkmcnt(2)
    v_mfma_f32_16x16x32_bf16 v[32:35], a[16:19], v[56:59], v[32:35]
    ds_read_b128 v[84:87], v65 offset:33920
    v_mfma_f32_16x16x32_bf16 v[36:39], a[80:83], v[56:59], v[36:39]
    v_mfma_f32_16x16x32_bf16 v[40:43], a[144:147], v[56:59], v[40:43]
    ds_read_b128 v[88:91], v65 offset:50816
    v_mfma_f32_16x16x32_bf16 v[44:47], a[16:19], v[60:63], v[44:47]
    v_mfma_f32_16x16x32_bf16 v[48:51], a[80:83], v[60:63], v[48:51]
    v_mfma_f32_16x16x32_bf16 v[52:55], a[144:147], v[60:63], v[52:55]
    s_waitcnt lgkmcnt(2)
    v_mfma_f32_16x16x32_bf16 v[32:35], a[20:23], v[76:79], v[32:35]
    ds_read_b128 v[56:59], v65 offset:33984
    v_mfma_f32_16x16x32_bf16 v[36:39], a[84:87], v[76:79], v[36:39]
    v_mfma_f32_16x16x32_bf16 v[40:43], a[148:151], v[76:79], v[40:43]
    ds_read_b128 v[60:63], v65 offset:50880
    s_waitcnt vmcnt(4)
    s_add_u32 s36, s41, 32768
    s_mov_b64 exec, 1
    buffer_store_dword v8, v8, s[4:7], s36 offen offset:0
    s_mov_b64 exec, -1
    v_mfma_f32_16x16x32_bf16 v[44:47], a[20:23], v[80:83], v[44:47]
    v_mfma_f32_16x16x32_bf16 v[48:51], a[84:87], v[80:83], v[48:51]
    v_mfma_f32_16x16x32_bf16 v[52:55], a[148:151], v[80:83], v[52:55]
    s_waitcnt lgkmcnt(2)
    v_mfma_f32_16x16x32_bf16 v[32:35], a[24:27], v[84:87], v[32:35]
    ds_read_b128 v[76:79], v66 offset:33792
    v_mfma_f32_16x16x32_bf16 v[36:39], a[88:91], v[84:87], v[36:39]
    v_mfma_f32_16x16x32_bf16 v[40:43], a[152:155], v[84:87], v[40:43]
    ds_read_b128 v[80:83], v66 offset:50688
    v_mfma_f32_16x16x32_bf16 v[44:47], a[24:27], v[88:91], v[44:47]
    v_mfma_f32_16x16x32_bf16 v[48:51], a[88:91], v[88:91], v[48:51]
    s_waitcnt vmcnt(3)
    v_add_f32 v72, v72, v74
    v_mfma_f32_16x16x32_bf16 v[52:55], a[152:155], v[88:91], v[52:55]
    v_add_f32 v73, v73, v75
    s_waitcnt lgkmcnt(2)
    v_mfma_f32_16x16x32_bf16 v[32:35], a[28:31], v[56:59], v[32:35]
    ds_read_b128 v[84:87], v66 offset:33856
    v_mov_b32_e64 v74, v72
    v_mfma_f32_16x16x32_bf16 v[36:39], a[92:95], v[56:59], v[36:39]
    v_mov_b32_e64 v75, v73
    v_mfma_f32_16x16x32_bf16 v[40:43], a[156:159], v[56:59], v[40:43]
    ds_read_b128 v[88:91], v66 offset:50752
    v_permlane32_swap_b32_e64 v74, v72
    v_mfma_f32_16x16x32_bf16 v[44:47], a[28:31], v[60:63], v[44:47]
    v_mfma_f32_16x16x32_bf16 v[48:51], a[92:95], v[60:63], v[48:51]
    v_permlane32_swap_b32_e64 v75, v73
    v_mfma_f32_16x16x32_bf16 v[52:55], a[156:159], v[60:63], v[52:55]
    v_add_f32 v72, v72, v74
    s_waitcnt lgkmcnt(2)
    v_mfma_f32_16x16x32_bf16 v[32:35], a[32:35], v[76:79], v[32:35]
    ds_read_b128 v[56:59], v66 offset:33920
    v_add_f32_e64 v73, v73, v75
    v_mfma_f32_16x16x32_bf16 v[36:39], a[96:99], v[76:79], v[36:39]
    v_mov_b32_e64 v74, v72
    v_mfma_f32_16x16x32_bf16 v[40:43], a[160:163], v[76:79], v[40:43]
    ds_read_b128 v[60:63], v66 offset:50816
    v_mfma_f32_16x16x32_bf16 v[44:47], a[32:35], v[80:83], v[44:47]
    v_mov_b32_e64 v75, v73
    v_mfma_f32_16x16x32_bf16 v[48:51], a[96:99], v[80:83], v[48:51]
    s_add_u32 s37, s42, 32768
    buffer_load_dword v22, v20, s[4:7], s37 offen offset:0 sc1
    s_add_u32 s36, s49, 11264
    v_add_u32_e64 v21, s36, v11
    v_mfma_f32_16x16x32_bf16 v[52:55], a[160:163], v[80:83], v[52:55]
    v_permlane16_swap_b32 v74, v72
    s_waitcnt lgkmcnt(2)
    v_mfma_f32_16x16x32_bf16 v[32:35], a[36:39], v[84:87], v[32:35]
    ds_read_b128 v[76:79], v66 offset:33984
    v_permlane16_swap_b32_e64 v75, v73
    v_mfma_f32_16x16x32_bf16 v[36:39], a[100:103], v[84:87], v[36:39]
    v_add_f32 v72, v72, v74
    v_add_f32 v73, v73, v75
    v_mfma_f32_16x16x32_bf16 v[40:43], a[164:167], v[84:87], v[40:43]
    ds_read_b128 v[80:83], v66 offset:50880
    v_mfma_f32_16x16x32_bf16 v[44:47], a[36:39], v[88:91], v[44:47]
    v_mul_f32_e64 v72, s62, v72
    v_mfma_f32_16x16x32_bf16 v[48:51], a[100:103], v[88:91], v[48:51]
    v_mul_f32_e64 v73, s62, v73
    v_mfma_f32_16x16x32_bf16 v[52:55], a[164:167], v[88:91], v[52:55]
    v_fma_f32 v73, -v72, v72, v73
    s_waitcnt lgkmcnt(2)
    v_mfma_f32_16x16x32_bf16 v[32:35], a[40:43], v[56:59], v[32:35]
    ds_read_b128 v[84:87], v67 offset:33792
    v_max_f32 v73, 0, v73
    v_mfma_f32_16x16x32_bf16 v[36:39], a[104:107], v[56:59], v[36:39]
    v_mfma_f32_16x16x32_bf16 v[40:43], a[168:171], v[56:59], v[40:43]
    ds_read_b128 v[88:91], v67 offset:50688
    v_add_f32 v73, 0x3727c5ac, v73
    v_mfma_f32_16x16x32_bf16 v[44:47], a[40:43], v[60:63], v[44:47]
    v_rsq_f32_e64 v74, v73
    v_mfma_f32_16x16x32_bf16 v[48:51], a[104:107], v[60:63], v[48:51]
    v_mul_f32_e64 v72, -1.0, v72
    v_mfma_f32_16x16x32_bf16 v[52:55], a[168:171], v[60:63], v[52:55]
    v_mul_f32 v75, v72, v74
    s_waitcnt lgkmcnt(2)
    v_mfma_f32_16x16x32_bf16 v[32:35], a[44:47], v[76:79], v[32:35]
    ds_read_b128 v[56:59], v67 offset:33856
    v_mfma_f32_16x16x32_bf16 v[36:39], a[108:111], v[76:79], v[36:39]
    s_waitcnt vmcnt(2)
    v_add_f32 v92, v92, v94
    v_mfma_f32_16x16x32_bf16 v[40:43], a[172:175], v[76:79], v[40:43]
    ds_read_b128 v[60:63], v67 offset:50752
    v_add_f32_e64 v93, v93, v95
    v_mfma_f32_16x16x32_bf16 v[44:47], a[44:47], v[80:83], v[44:47]
    v_mov_b32_e64 v94, v92
    v_mfma_f32_16x16x32_bf16 v[48:51], a[108:111], v[80:83], v[48:51]
    v_mov_b32_e64 v95, v93
    v_mfma_f32_16x16x32_bf16 v[52:55], a[172:175], v[80:83], v[52:55]
    v_permlane32_swap_b32 v94, v92
    s_waitcnt lgkmcnt(2)
    v_mfma_f32_16x16x32_bf16 v[32:35], a[48:51], v[84:87], v[32:35]
    ds_read_b128 v[76:79], v67 offset:33920
    v_mfma_f32_16x16x32_bf16 v[36:39], a[112:115], v[84:87], v[36:39]
    v_permlane32_swap_b32_e64 v95, v93
    v_mfma_f32_16x16x32_bf16 v[40:43], a[176:179], v[84:87], v[40:43]
    ds_read_b128 v[80:83], v67 offset:50816
    s_waitcnt vmcnt(0)
    v_cmp_eq_u32 vcc, -1, v22
    s_nop 0
    s_and_b64 vcc, exec, vcc
    s_cbranch_vccz K1_PDONE43
    s_mov_b32 s63, 524288
K1_POLL42:
    buffer_load_dword v22, v20, s[4:7], s37 offen offset:0 sc1
    s_waitcnt vmcnt(0)
    v_cmp_eq_u32 vcc, -1, v22
    s_nop 0
    s_and_b64 vcc, exec, vcc
    s_cbranch_vccz K1_PDONE43
    s_sub_u32 s63, s63, 1
    s_cmp_lg_u32 s63, 0
    s_cbranch_scc1 K1_POLL42
K1_PDONE43:
    v_mfma_f32_16x16x32_bf16 v[44:47], a[48:51], v[88:91], v[44:47]
    buffer_load_dwordx4 v[96:99], v21, s[4:7], s64 offen sc1
    v_add_f32 v92, v92, v94
    v_mfma_f32_16x16x32_bf16 v[48:51], a[112:115], v[88:91], v[48:51]
    v_add_f32 v93, v93, v95
    v_mov_b32 v94, v92
    v_mfma_f32_16x16x32_bf16 v[52:55], a[176:179], v[88:91], v[52:55]
    s_waitcnt lgkmcnt(2)
    v_mfma_f32_16x16x32_bf16 v[32:35], a[52:55], v[56:59], v[32:35]
    ds_read_b128 v[84:87], v67 offset:33984
    v_mov_b32 v95, v93
    v_mfma_f32_16x16x32_bf16 v[36:39], a[116:119], v[56:59], v[36:39]
    buffer_load_dwordx4 v[100:103], v21, s[4:7], s65 offen sc1
    v_permlane16_swap_b32_e64 v94, v92
    v_mfma_f32_16x16x32_bf16 v[40:43], a[180:183], v[56:59], v[40:43]
    ds_read_b128 v[88:91], v67 offset:50880
    v_permlane16_swap_b32_e64 v95, v93
    v_mfma_f32_16x16x32_bf16 v[44:47], a[52:55], v[60:63], v[44:47]
    v_add_f32_e64 v92, v92, v94
    v_mfma_f32_16x16x32_bf16 v[48:51], a[116:119], v[60:63], v[48:51]
    v_add_f32_e64 v93, v93, v95
    v_mfma_f32_16x16x32_bf16 v[52:55], a[180:183], v[60:63], v[52:55]
    buffer_load_dwordx4 v[104:107], v21, s[4:7], s66 offen sc1
    s_waitcnt lgkmcnt(2)
    v_mfma_f32_16x16x32_bf16 v[32:35], a[56:59], v[76:79], v[32:35]
    v_mul_f32 v92, s62, v92
    v_mfma_f32_16x16x32_bf16 v[36:39], a[120:123], v[76:79], v[36:39]
    ds_read_b128 v[56:59], v12 offset:0
    v_mul_f32_e64 v93, s62, v93
    v_mfma_f32_16x16x32_bf16 v[40:43], a[184:187], v[76:79], v[40:43]
    v_fma_f32 v93, -v92, v92, v93
    v_mfma_f32_16x16x32_bf16 v[44:47], a[56:59], v[80:83], v[44:47]
    ds_read_b128 v[60:63], v12 offset:16
    buffer_load_dwordx4 v[108:111], v21, s[4:7], s67 offen sc1
    v_mfma_f32_16x16x32_bf16 v[48:51], a[120:123], v[80:83], v[48:51]
    v_max_f32_e64 v93, 0, v93
    v_mfma_f32_16x16x32_bf16 v[52:55], a[184:187], v[80:83], v[52:55]
    v_add_f32 v93, 0x3727c5ac, v93
    s_waitcnt lgkmcnt(2)
    v_mfma_f32_16x16x32_bf16 v[32:35], a[60:63], v[84:87], v[32:35]
    v_rsq_f32 v72, v93
    v_mfma_f32_16x16x32_bf16 v[36:39], a[124:127], v[84:87], v[36:39]
    buffer_load_dwordx4 v[112:115], v21, s[4:7], s68 offen sc1
    v_mul_f32_e64 v92, -1.0, v92
    v_mfma_f32_16x16x32_bf16 v[40:43], a[188:191], v[84:87], v[40:43]
    v_mul_f32_e64 v73, v92, v72
    v_mfma_f32_16x16x32_bf16 v[44:47], a[60:63], v[88:91], v[44:47]
    v_mfma_f32_16x16x32_bf16 v[48:51], a[124:127], v[88:91], v[48:51]
    v_mfma_f32_16x16x32_bf16 v[52:55], a[188:191], v[88:91], v[52:55]
    s_barrier
    s_add_u32 s35, s40, 0
    s_cmp_eq_u32 s16, 3
    s_cselect_b32 s39, s90, s35
    s_waitcnt lgkmcnt(0)
    v_pk_fma_f32 v[76:77], v[72:73], v[60:61], v[56:57] op_sel:[1,0,0] op_sel_hi:[1,1,1]
    buffer_load_dwordx4 v[116:119], v21, s[4:7], s69 offen sc1
    v_pk_fma_f32 v[78:79], v[72:73], v[62:63], v[58:59] op_sel:[1,0,0] op_sel_hi:[1,1,1]
    v_pk_fma_f32 v[80:81], v[74:75], v[60:61], v[56:57] op_sel:[1,0,0] op_sel_hi:[1,1,1]
    v_pk_fma_f32 v[82:83], v[74:75], v[62:63], v[58:59] op_sel:[1,0,0] op_sel_hi:[1,1,1]
    ds_read_b128 v[56:59], v12 offset:128
    ds_read_b128 v[60:63], v12 offset:144
    v_pk_fma_f32 v[76:77], v[72:73], v[32:33], v[76:77] op_sel_hi:[0,1,1]
    v_pk_fma_f32 v[78:79], v[72:73], v[34:35], v[78:79] op_sel_hi:[0,1,1]
    v_pk_fma_f32 v[80:81], v[74:75], v[44:45], v[80:81] op_sel_hi:[0,1,1]
    v_pk_fma_f32 v[82:83], v[74:75], v[46:47], v[82:83] op_sel_hi:[0,1,1]
    v_pk_mul_f32 v[84:85], v[76:77], v[76:77]
    v_pk_mul_f32 v[86:87], v[78:79], v[78:79]
    v_pk_mul_f32 v[88:89], v[80:81], v[80:81]
    v_pk_mul_f32 v[90:91], v[82:83], v[82:83]
    v_pk_fma_f32 v[84:85], v[84:85], s[58:59], v[0:1] op_sel_hi:[1,1,0]
    v_pk_fma_f32 v[86:87], v[86:87], s[58:59], v[0:1] op_sel_hi:[1,1,0]
    v_pk_fma_f32 v[88:89], v[88:89], s[58:59], v[0:1] op_sel_hi:[1,1,0]
    v_pk_fma_f32 v[90:91], v[90:91], s[58:59], v[0:1] op_sel_hi:[1,1,0]
    v_pk_mul_f32 v[84:85], v[76:77], v[84:85]
    v_pk_mul_f32 v[86:87], v[78:79], v[86:87]
    v_pk_mul_f32 v[88:89], v[80:81], v[88:89]
    v_pk_mul_f32 v[90:91], v[82:83], v[90:91]
    v_exp_f32 v84, v84
    buffer_load_dwordx4 v[120:123], v21, s[4:7], s70 offen sc1
    v_exp_f32 v85, v85
    v_exp_f32 v86, v86
    v_exp_f32 v87, v87
    v_exp_f32 v88, v88
    v_exp_f32 v89, v89
    v_exp_f32 v90, v90
    v_exp_f32_e64 v91, v91
    v_pk_add_f32 v[84:85], v[84:85], 1.0 op_sel_hi:[1,0]
    v_pk_add_f32 v[86:87], v[86:87], 1.0 op_sel_hi:[1,0]
    v_pk_add_f32 v[88:89], v[88:89], 1.0 op_sel_hi:[1,0]
    v_pk_add_f32 v[90:91], v[90:91], 1.0 op_sel_hi:[1,0]
    v_rcp_f32 v84, v84
    v_rcp_f32 v85, v85
    v_rcp_f32 v86, v86
    v_rcp_f32 v87, v87
    v_rcp_f32 v88, v88
    v_rcp_f32 v89, v89
    v_rcp_f32 v90, v90
    v_rcp_f32 v91, v91
    v_pk_mul_f32 v[76:77], v[76:77], v[84:85]
    v_pk_mul_f32 v[78:79], v[78:79], v[86:87]
    v_pk_mul_f32 v[80:81], v[80:81], v[88:89]
    buffer_load_dwordx4 v[124:127], v21, s[4:7], s71 offen sc1
    v_pk_mul_f32 v[82:83], v[82:83], v[90:91]
    v_cvt_pk_bf16_f32 v84, v76, v77
    v_cvt_pk_bf16_f32 v85, v78, v79
    v_cvt_pk_bf16_f32 v86, v80, v81
    v_cvt_pk_bf16_f32 v87, v82, v83
    s_nop 0
    v_permlane32_swap_b32 v84, v86
    v_permlane32_swap_b32_e64 v85, v87
    buffer_store_dwordx4 v[84:87], v2, s[4:7], s35 offen offset:0
    s_waitcnt lgkmcnt(0)
    v_pk_fma_f32 v[76:77], v[72:73], v[60:61], v[56:57] op_sel:[1,0,0] op_sel_hi:[1,1,1]
    v_pk_fma_f32 v[78:79], v[72:73], v[62:63], v[58:59] op_sel:[1,0,0] op_sel_hi:[1,1,1]
    v_pk_fma_f32 v[80:81], v[74:75], v[60:61], v[56:57] op_sel:[1,0,0] op_sel_hi:[1,1,1]
    v_pk_fma_f32 v[82:83], v[74:75], v[62:63], v[58:59] op_sel:[1,0,0] op_sel_hi:[1,1,1]
    ds_read_b128 v[56:59], v12 offset:256
    ds_read_b128 v[60:63], v12 offset:272
    v_pk_fma_f32 v[76:77], v[72:73], v[36:37], v[76:77] op_sel_hi:[0,1,1]
    v_pk_fma_f32 v[78:79], v[72:73], v[38:39], v[78:79] op_sel_hi:[0,1,1]
    v_pk_fma_f32 v[80:81], v[74:75], v[48:49], v[80:81] op_sel_hi:[0,1,1]
    v_pk_fma_f32 v[82:83], v[74:75], v[50:51], v[82:83] op_sel_hi:[0,1,1]
    v_pk_mul_f32 v[84:85], v[76:77], v[76:77]
    v_pk_mul_f32 v[86:87], v[78:79], v[78:79]
    v_pk_mul_f32 v[88:89], v[80:81], v[80:81]
    v_pk_mul_f32 v[90:91], v[82:83], v[82:83]
    buffer_load_dwordx4 v[128:131], v21, s[4:7], s72 offen sc1
    v_pk_fma_f32 v[84:85], v[84:85], s[58:59], v[0:1] op_sel_hi:[1,1,0]
    v_pk_fma_f32 v[86:87], v[86:87], s[58:59], v[0:1] op_sel_hi:[1,1,0]
    v_pk_fma_f32 v[88:89], v[88:89], s[58:59], v[0:1] op_sel_hi:[1,1,0]
    v_pk_fma_f32 v[90:91], v[90:91], s[58:59], v[0:1] op_sel_hi:[1,1,0]
    v_pk_mul_f32 v[84:85], v[76:77], v[84:85]
    v_pk_mul_f32 v[86:87], v[78:79], v[86:87]
    v_pk_mul_f32 v[88:89], v[80:81], v[88:89]
    v_pk_mul_f32 v[90:91], v[82:83], v[90:91]
    v_exp_f32 v84, v84
    v_exp_f32 v85, v85
    v_exp_f32 v86, v86
    v_exp_f32 v87, v87
    v_exp_f32 v88, v88
    v_exp_f32 v89, v89
    v_exp_f32 v90, v90
    v_exp_f32_e64 v91, v91
    v_pk_add_f32 v[84:85], v[84:85], 1.0 op_sel_hi:[1,0]
    v_pk_add_f32 v[86:87], v[86:87], 1.0 op_sel_hi:[1,0]
    v_pk_add_f32 v[88:89], v[88:89], 1.0 op_sel_hi:[1,0]
    v_pk_add_f32 v[90:91], v[90:91], 1.0 op_sel_hi:[1,0]
    v_rcp_f32 v84, v84
    v_rcp_f32 v85, v85
    buffer_load_dwordx4 v[132:135], v21, s[4:7], s73 offen sc1
    v_rcp_f32 v86, v86
    v_rcp_f32 v87, v87
    v_rcp_f32 v88, v88
    v_rcp_f32 v89, v89
    v_rcp_f32 v90, v90
    v_rcp_f32 v91, v91
    v_pk_mul_f32 v[76:77], v[76:77], v[84:85]
    v_pk_mul_f32 v[78:79], v[78:79], v[86:87]
    v_pk_mul_f32 v[80:81], v[80:81], v[88:89]
    v_pk_mul_f32 v[82:83], v[82:83], v[90:91]
    v_cvt_pk_bf16_f32 v84, v76, v77
    v_cvt_pk_bf16_f32 v85, v78, v79
    v_cvt_pk_bf16_f32 v86, v80, v81
    v_cvt_pk_bf16_f32 v87, v82, v83
    s_nop 0
    v_permlane32_swap_b32 v84, v86
    v_permlane32_swap_b32_e64 v85, v87
    buffer_store_dwordx4 v[84:87], v2, s[4:7], s35 offen offset:1024
    s_waitcnt lgkmcnt(0)
    v_pk_fma_f32 v[76:77], v[72:73], v[60:61], v[56:57] op_sel:[1,0,0] op_sel_hi:[1,1,1]
    v_pk_fma_f32 v[78:79], v[72:73], v[62:63], v[58:59] op_sel:[1,0,0] op_sel_hi:[1,1,1]
    v_pk_fma_f32 v[80:81], v[74:75], v[60:61], v[56:57] op_sel:[1,0,0] op_sel_hi:[1,1,1]
    v_pk_fma_f32 v[82:83], v[74:75], v[62:63], v[58:59] op_sel:[1,0,0] op_sel_hi:[1,1,1]
    v_pk_fma_f32 v[76:77], v[72:73], v[40:41], v[76:77] op_sel_hi:[0,1,1]
    buffer_load_dwordx4 v[136:139], v21, s[4:7], s74 offen sc1
    v_pk_fma_f32 v[78:79], v[72:73], v[42:43], v[78:79] op_sel_hi:[0,1,1]
    v_pk_fma_f32 v[80:81], v[74:75], v[52:53], v[80:81] op_sel_hi:[0,1,1]
    v_pk_fma_f32 v[82:83], v[74:75], v[54:55], v[82:83] op_sel_hi:[0,1,1]
    v_pk_mul_f32 v[84:85], v[76:77], v[76:77]
    v_pk_mul_f32 v[86:87], v[78:79], v[78:79]
    v_pk_mul_f32 v[88:89], v[80:81], v[80:81]
    v_pk_mul_f32 v[90:91], v[82:83], v[82:83]
    v_pk_fma_f32 v[84:85], v[84:85], s[58:59], v[0:1] op_sel_hi:[1,1,0]
    v_pk_fma_f32 v[86:87], v[86:87], s[58:59], v[0:1] op_sel_hi:[1,1,0]
    v_pk_fma_f32 v[88:89], v[88:89], s[58:59], v[0:1] op_sel_hi:[1,1,0]
    v_pk_fma_f32 v[90:91], v[90:91], s[58:59], v[0:1] op_sel_hi:[1,1,0]
    v_pk_mul_f32 v[84:85], v[76:77], v[84:85]
    v_pk_mul_f32 v[86:87], v[78:79], v[86:87]
    v_pk_mul_f32 v[88:89], v[80:81], v[88:89]
    v_pk_mul_f32 v[90:91], v[82:83], v[90:91]
    v_exp_f32 v84, v84
    v_exp_f32 v85, v85
    v_exp_f32 v86, v86
    v_exp_f32 v87, v87
    v_exp_f32 v88, v88
    v_exp_f32 v89, v89
    v_exp_f32 v90, v90
    buffer_load_dwordx4 v[140:143], v21, s[4:7], s75 offen sc1
    v_exp_f32_e64 v91, v91
    v_pk_add_f32 v[84:85], v[84:85], 1.0 op_sel_hi:[1,0]
    v_pk_add_f32 v[86:87], v[86:87], 1.0 op_sel_hi:[1,0]
    v_pk_add_f32 v[88:89], v[88:89], 1.0 op_sel_hi:[1,0]
    v_pk_add_f32 v[90:91], v[90:91], 1.0 op_sel_hi:[1,0]
    v_rcp_f32 v84, v84
    v_rcp_f32 v85, v85
    v_rcp_f32 v86, v86
    v_rcp_f32 v87, v87
    v_rcp_f32 v88, v88
    v_rcp_f32 v89, v89
    v_rcp_f32 v90, v90
    v_rcp_f32 v91, v91
    v_pk_mul_f32 v[76:77], v[76:77], v[84:85]
    v_pk_mul_f32 v[78:79], v[78:79], v[86:87]
    v_pk_mul_f32 v[80:81], v[80:81], v[88:89]
    v_pk_mul_f32 v[82:83], v[82:83], v[90:91]
    v_cvt_pk_bf16_f32 v84, v76, v77
    v_cvt_pk_bf16_f32 v85, v78, v79
    v_cvt_pk_bf16_f32 v86, v80, v81
    v_cvt_pk_bf16_f32 v87, v82, v83
    s_nop 0
    v_permlane32_swap_b32 v84, v86
    v_permlane32_swap_b32_e64 v85, v87
    buffer_store_dwordx4 v[84:87], v2, s[4:7], s39 offen offset:2048
    s_waitcnt vmcnt(14)
    v_mfma_f32_32x32x16_bf16 v[32:47], a[192:195], v[96:99], 0
    v_mfma_f32_32x32x16_bf16 v[48:63], a[196:199], v[96:99], 0
    buffer_load_dwordx4 v[96:99], v21, s[4:7], s76 offen sc1
    s_waitcnt vmcnt(14)
    v_mfma_f32_32x32x16_bf16 v[32:47], a[200:203], v[100:103], v[32:47]
    v_mfma_f32_32x32x16_bf16 v[48:63], a[204:207], v[100:103], v[48:63]
    buffer_load_dwordx4 v[100:103], v21, s[4:7], s77 offen sc1
    s_waitcnt vmcnt(14)
    v_mfma_f32_32x32x16_bf16 v[32:47], a[208:211], v[104:107], v[32:47]
    v_mfma_f32_32x32x16_bf16 v[48:63], a[212:215], v[104:107], v[48:63]
    buffer_load_dwordx4 v[104:107], v21, s[4:7], s78 offen sc1
    s_waitcnt vmcnt(14)
    v_mfma_f32_32x32x16_bf16 v[32:47], a[216:219], v[108:111], v[32:47]
    v_mfma_f32_32x32x16_bf16 v[48:63], a[220:223], v[108:111], v[48:63]
    buffer_load_dwordx4 v[108:111], v21, s[4:7], s79 offen sc1
    s_waitcnt vmcnt(14)
    v_mfma_f32_32x32x16_bf16 v[32:47], a[224:227], v[112:115], v[32:47]
    v_mfma_f32_32x32x16_bf16 v[48:63], a[228:231], v[112:115], v[48:63]
    buffer_load_dwordx4 v[112:115], v21, s[4:7], s80 offen sc1
    s_waitcnt vmcnt(14)
    v_mfma_f32_32x32x16_bf16 v[32:47], a[232:235], v[116:119], v[32:47]
    v_mfma_f32_32x32x16_bf16 v[48:63], a[236:239], v[116:119], v[48:63]
    buffer_load_dwordx4 v[116:119], v21, s[4:7], s81 offen sc1
    s_waitcnt vmcnt(14)
    v_mfma_f32_32x32x16_bf16 v[32:47], a[240:243], v[120:123], v[32:47]
    v_mfma_f32_32x32x16_bf16 v[48:63], a[244:247], v[120:123], v[48:63]
    buffer_load_dwordx4 v[120:123], v21, s[4:7], s82 offen sc1
    s_waitcnt vmcnt(14)
    v_mfma_f32_32x32x16_bf16 v[32:47], a[248:251], v[124:127], v[32:47]
    v_mfma_f32_32x32x16_bf16 v[48:63], a[252:255], v[124:127], v[48:63]
    buffer_load_dwordx4 v[124:127], v21, s[4:7], s83 offen sc1
    s_waitcnt vmcnt(13)
    v_mfma_f32_32x32x16_bf16 v[32:47], v[144:147], v[128:131], v[32:47]
    v_mfma_f32_32x32x16_bf16 v[48:63], v[148:151], v[128:131], v[48:63]
    buffer_load_dwordx4 v[128:131], v21, s[4:7], s84 offen sc1
    s_waitcnt vmcnt(13)
    v_mfma_f32_32x32x16_bf16 v[32:47], v[152:155], v[132:135], v[32:47]
    s_waitcnt vmcnt(9)
    s_add_u32 s36, s41, 49152
    s_mov_b64 exec, 1
    buffer_store_dword v8, v8, s[4:7], s36 offen offset:0
    s_mov_b64 exec, -1
    v_mfma_f32_32x32x16_bf16 v[48:63], v[156:159], v[132:135], v[48:63]
    buffer_load_dwordx4 v[132:135], v21, s[4:7], s85 offen sc1
    v_mfma_f32_32x32x16_bf16 v[32:47], v[160:163], v[136:139], v[32:47]
    v_mfma_f32_32x32x16_bf16 v[48:63], v[164:167], v[136:139], v[48:63]
    v_mfma_f32_32x32x16_bf16 v[32:47], v[168:171], v[140:143], v[32:47]
    v_mfma_f32_32x32x16_bf16 v[48:63], v[172:175], v[140:143], v[48:63]
    s_waitcnt vmcnt(10)
    v_mfma_f32_32x32x16_bf16 v[32:47], v[176:179], v[96:99], v[32:47]
    v_mfma_f32_32x32x16_bf16 v[48:63], v[180:183], v[96:99], v[48:63]
    s_waitcnt vmcnt(9)
    v_mfma_f32_32x32x16_bf16 v[32:47], v[184:187], v[100:103], v[32:47]
    v_mfma_f32_32x32x16_bf16 v[48:63], v[188:191], v[100:103], v[48:63]
    s_waitcnt vmcnt(8)
    v_mfma_f32_32x32x16_bf16 v[32:47], v[192:195], v[104:107], v[32:47]
    s_add_u32 s37, s42, 49152
    buffer_load_dword v22, v20, s[4:7], s37 offen offset:0 sc1
    s_add_u32 s36, s49, 0
    v_add_u32_e64 v21, s36, v11
    s_waitcnt vmcnt(8)
    v_mfma_f32_32x32x16_bf16 v[32:47], v[200:203], v[108:111], v[32:47]
    v_mfma_f32_32x32x16_bf16 v[48:63], v[196:199], v[104:107], v[48:63]
    s_waitcnt vmcnt(7)
    v_mfma_f32_32x32x16_bf16 v[32:47], v[208:211], v[112:115], v[32:47]
    s_waitcnt vmcnt(6)
    v_mfma_f32_32x32x16_bf16 v[32:47], v[216:219], v[116:119], v[32:47]
    v_mfma_f32_32x32x16_bf16 v[48:63], v[204:207], v[108:111], v[48:63]
    s_waitcnt vmcnt(5)
    v_mfma_f32_32x32x16_bf16 v[32:47], v[224:227], v[120:123], v[32:47]
    s_waitcnt vmcnt(4)
    v_mfma_f32_32x32x16_bf16 v[32:47], v[232:235], v[124:127], v[32:47]
    v_mfma_f32_32x32x16_bf16 v[48:63], v[212:215], v[112:115], v[48:63]
    s_waitcnt vmcnt(3)
    v_mfma_f32_32x32x16_bf16 v[32:47], v[240:243], v[128:131], v[32:47]
    s_waitcnt vmcnt(1)
    v_mfma_f32_32x32x16_bf16 v[32:47], v[248:251], v[132:135], v[32:47]
    v_mfma_f32_32x32x16_bf16 v[48:63], v[220:223], v[116:119], v[48:63]
    s_waitcnt vmcnt(0)
    v_cmp_eq_u32 vcc, -1, v22
    s_nop 0
    s_and_b64 vcc, exec, vcc
    s_cbranch_vccz K1_PDONE45
    s_mov_b32 s63, 524288
K1_POLL44:
    buffer_load_dword v22, v20, s[4:7], s37 offen offset:0 sc1
    s_waitcnt vmcnt(0)
    v_cmp_eq_u32 vcc, -1, v22
    s_nop 0
    s_and_b64 vcc, exec, vcc
    s_cbranch_vccz K1_PDONE45
    s_sub_u32 s63, s63, 1
    s_cmp_lg_u32 s63, 0
    s_cbranch_scc1 K1_POLL44
K1_PDONE45:
    v_mfma_f32_32x32x16_bf16 v[48:63], v[228:231], v[120:123], v[48:63]
    buffer_load_dwordx4 v[136:139], v21, s[4:7], s64 offen sc1
    buffer_load_dwordx4 v[140:143], v21, s[4:7], s65 offen sc1
    v_mfma_f32_32x32x16_bf16 v[48:63], v[236:239], v[124:127], v[48:63]
    s_nop 1
    ds_write_b128 v3, v[32:35] offset:0
    buffer_load_dwordx4 v[96:99], v21, s[4:7], s66 offen sc1
    v_mfma_f32_32x32x16_bf16 v[48:63], v[244:247], v[128:131], v[48:63]
    ds_write_b128 v3, v[36:39] offset:16
    ds_write_b128 v3, v[40:43] offset:32
    buffer_load_dwordx4 v[100:103], v21, s[4:7], s67 offen sc1
    v_mfma_f32_32x32x16_bf16 v[48:63], v[252:255], v[132:135], v[48:63]
    ds_write_b128 v3, v[44:47] offset:48
    buffer_load_dwordx4 v[104:107], v21, s[4:7], s68 offen sc1
    s_nop 9
    ds_write_b128 v3, v[48:51] offset:128
    buffer_load_dwordx4 v[108:111], v21, s[4:7], s69 offen sc1
    buffer_load_dwordx4 v[112:115], v21, s[4:7], s70 offen sc1
    ds_write_b128 v3, v[52:55] offset:144
    buffer_load_dwordx4 v[116:119], v21, s[4:7], s71 offen sc1
    buffer_load_dwordx4 v[120:123], v21, s[4:7], s72 offen sc1
    ds_write_b128 v3, v[56:59] offset:160
    buffer_load_dwordx4 v[124:127], v21, s[4:7], s73 offen sc1
    buffer_load_dwordx4 v[128:131], v21, s[4:7], s74 offen sc1
    ds_write_b128 v3, v[60:63] offset:176
    buffer_load_dwordx4 v[132:135], v21, s[4:7], s75 offen sc1
    s_waitcnt lgkmcnt(0)
    s_barrier
    s_waitcnt vmcnt(11)
    v_mfma_f32_32x32x16_bf16 v[32:47], a[192:195], v[136:139], 0
    ds_read_b128 v[76:79], v4 offset:0
    ds_read_b128 v[80:83], v4 offset:16
    ds_read_b128 v[84:87], v4 offset:8704
    ds_read_b128 v[88:91], v4 offset:8720
    v_lshlrev_b32_e64 v64, 16, v24
    v_mfma_f32_32x32x16_bf16 v[48:63], a[196:199], v[136:139], 0
    buffer_load_dwordx4 v[136:139], v21, s[4:7], s76 offen sc1
    v_and_b32 v65, s56, v24
    v_lshlrev_b32 v66, 16, v25
    v_and_b32 v67, s56, v25
    v_lshlrev_b32_e64 v68, 16, v26
    s_waitcnt vmcnt(11)
    v_mfma_f32_32x32x16_bf16 v[32:47], a[200:203], v[140:143], v[32:47]
    v_and_b32 v69, s56, v26
    v_lshlrev_b32 v70, 16, v27
    v_and_b32 v71, s56, v27
    s_waitcnt lgkmcnt(3)
    v_add_f32 v64, v64, v76
    v_add_f32 v65, v65, v77
    v_mfma_f32_32x32x16_bf16 v[48:63], a[204:207], v[140:143], v[48:63]
    buffer_load_dwordx4 v[140:143], v21, s[4:7], s77 offen sc1
    v_add_f32 v66, v66, v78
    v_add_f32 v67, v67, v79
    s_waitcnt lgkmcnt(2)
    v_add_f32 v68, v68, v80
    v_add_f32 v69, v69, v81
    s_waitcnt vmcnt(11)
    v_mfma_f32_32x32x16_bf16 v[32:47], a[208:211], v[96:99], v[32:47]
    v_add_f32 v70, v70, v82
    v_add_f32 v71, v71, v83
    ds_read_b128 v[76:79], v13 offset:0
    ds_read_b128 v[80:83], v13 offset:16
    s_waitcnt lgkmcnt(3)
    v_add_f32 v64, v64, v84
    v_mfma_f32_32x32x16_bf16 v[48:63], a[212:215], v[96:99], v[48:63]
    buffer_load_dwordx4 v[96:99], v21, s[4:7], s78 offen sc1
    v_add_f32 v65, v65, v85
    v_add_f32 v66, v66, v86
    v_add_f32 v67, v67, v87
    s_waitcnt lgkmcnt(2)
    v_add_f32 v68, v68, v88
    s_waitcnt vmcnt(11)
    v_mfma_f32_32x32x16_bf16 v[32:47], a[216:219], v[100:103], v[32:47]
    v_add_f32 v69, v69, v89
    v_add_f32 v70, v70, v90
    v_add_f32_e64 v71, v71, v91
    ds_read_b128 v[84:87], v4 offset:17408
    ds_read_b128 v[88:91], v4 offset:17424
    v_mfma_f32_32x32x16_bf16 v[48:63], a[220:223], v[100:103], v[48:63]
    buffer_load_dwordx4 v[100:103], v21, s[4:7], s79 offen sc1
    s_waitcnt lgkmcnt(3)
    v_add_f32 v64, v64, v76
    v_add_f32 v65, v65, v77
    v_add_f32 v66, v66, v78
    v_add_f32 v67, v67, v79
    s_waitcnt vmcnt(11)
    v_mfma_f32_32x32x16_bf16 v[32:47], a[224:227], v[104:107], v[32:47]
    s_waitcnt lgkmcnt(2)
    v_add_f32 v68, v68, v80
    v_add_f32 v69, v69, v81
    v_add_f32 v70, v70, v82
    v_add_f32_e64 v71, v71, v83
    ds_read_b128 v[76:79], v4 offset:26112
    v_mfma_f32_32x32x16_bf16 v[48:63], a[228:231], v[104:107], v[48:63]
    buffer_load_dwordx4 v[104:107], v21, s[4:7], s80 offen sc1
    ds_read_b128 v[80:83], v4 offset:26128
    s_waitcnt lgkmcnt(3)
    v_add_f32 v64, v64, v84
    v_add_f32 v65, v65, v85
    v_add_f32_e64 v66, v66, v86
    s_waitcnt vmcnt(11)
    v_mfma_f32_32x32x16_bf16 v[32:47], a[232:235], v[108:111], v[32:47]
    v_add_f32 v67, v67, v87
    s_waitcnt lgkmcnt(2)
    v_add_f32 v68, v68, v88
    v_add_f32 v69, v69, v89
    v_add_f32 v70, v70, v90
    v_add_f32 v71, v71, v91
    v_mfma_f32_32x32x16_bf16 v[48:63], a[236:239], v[108:111], v[48:63]
    buffer_load_dwordx4 v[108:111], v21, s[4:7], s81 offen sc1
    s_waitcnt lgkmcnt(1)
    v_add_f32 v64, v64, v76
    v_add_f32 v65, v65, v77
    v_add_f32 v66, v66, v78
    v_add_f32 v67, v67, v79
    s_waitcnt vmcnt(11)
    v_mfma_f32_32x32x16_bf16 v[32:47], a[240:243], v[112:115], v[32:47]
    s_waitcnt lgkmcnt(0)
    v_add_f32 v68, v68, v80
    v_add_f32 v69, v69, v81
    v_add_f32 v70, v70, v82
    v_add_f32_e64 v71, v71, v83
    v_cvt_pk_bf16_f32 v24, v64, v65
    v_mfma_f32_32x32x16_bf16 v[48:63], a[244:247], v[112:115], v[48:63]
    buffer_load_dwordx4 v[112:115], v21, s[4:7], s82 offen sc1
    v_cvt_pk_bf16_f32 v25, v66, v67
    v_cvt_pk_bf16_f32 v26, v68, v69
    v_cvt_pk_bf16_f32 v27, v70, v71
    s_add_u32 s35, s43, 0
    s_waitcnt vmcnt(11)
    v_mfma_f32_32x32x16_bf16 v[32:47], a[248:251], v[116:119], v[32:47]
    buffer_store_dwordx4 v[24:27], v7, s[12:15], s35 offen
    v_mfma_f32_32x32x16_bf16 v[48:63], a[252:255], v[116:119], v[48:63]
    buffer_load_dwordx4 v[116:119], v21, s[4:7], s83 offen sc1
    s_waitcnt vmcnt(12)
    v_mfma_f32_32x32x16_bf16 v[32:47], v[144:147], v[120:123], v[32:47]
    v_mfma_f32_32x32x16_bf16 v[48:63], v[148:151], v[120:123], v[48:63]
    buffer_load_dwordx4 v[120:123], v21, s[4:7], s84 offen sc1
    s_waitcnt vmcnt(12)
    v_mfma_f32_32x32x16_bf16 v[32:47], v[152:155], v[124:127], v[32:47]
    v_mfma_f32_32x32x16_bf16 v[48:63], v[156:159], v[124:127], v[48:63]
    buffer_load_dwordx4 v[124:127], v21, s[4:7], s85 offen sc1
    s_waitcnt vmcnt(12)
    v_mfma_f32_32x32x16_bf16 v[32:47], v[160:163], v[128:131], v[32:47]
    v_mfma_f32_32x32x16_bf16 v[48:63], v[164:167], v[128:131], v[48:63]
    s_waitcnt vmcnt(11)
    v_mfma_f32_32x32x16_bf16 v[32:47], v[168:171], v[132:135], v[32:47]
    v_mfma_f32_32x32x16_bf16 v[48:63], v[172:175], v[132:135], v[48:63]
    s_waitcnt vmcnt(10)
    v_mfma_f32_32x32x16_bf16 v[32:47], v[176:179], v[136:139], v[32:47]
    v_mfma_f32_32x32x16_bf16 v[48:63], v[180:183], v[136:139], v[48:63]
    s_waitcnt vmcnt(9)
    v_mfma_f32_32x32x16_bf16 v[32:47], v[184:187], v[140:143], v[32:47]
    v_mfma_f32_32x32x16_bf16 v[48:63], v[188:191], v[140:143], v[48:63]
    s_waitcnt vmcnt(8)
    v_mfma_f32_32x32x16_bf16 v[32:47], v[192:195], v[96:99], v[32:47]
    s_waitcnt vmcnt(7)
    v_mfma_f32_32x32x16_bf16 v[32:47], v[200:203], v[100:103], v[32:47]
    v_mfma_f32_32x32x16_bf16 v[48:63], v[196:199], v[96:99], v[48:63]
    s_waitcnt vmcnt(6)
    v_mfma_f32_32x32x16_bf16 v[32:47], v[208:211], v[104:107], v[32:47]
    s_waitcnt vmcnt(5)
    v_mfma_f32_32x32x16_bf16 v[32:47], v[216:219], v[108:111], v[32:47]
    v_mfma_f32_32x32x16_bf16 v[48:63], v[204:207], v[100:103], v[48:63]
    s_waitcnt vmcnt(4)
    v_mfma_f32_32x32x16_bf16 v[32:47], v[224:227], v[112:115], v[32:47]
    s_waitcnt vmcnt(2)
    v_mfma_f32_32x32x16_bf16 v[32:47], v[232:235], v[116:119], v[32:47]
    v_mfma_f32_32x32x16_bf16 v[48:63], v[212:215], v[104:107], v[48:63]
    s_waitcnt vmcnt(1)
    v_mfma_f32_32x32x16_bf16 v[32:47], v[240:243], v[120:123], v[32:47]
    s_waitcnt vmcnt(0)
    v_mfma_f32_32x32x16_bf16 v[32:47], v[248:251], v[124:127], v[32:47]
    v_mfma_f32_32x32x16_bf16 v[48:63], v[220:223], v[108:111], v[48:63]
    v_mfma_f32_32x32x16_bf16 v[48:63], v[228:231], v[112:115], v[48:63]
    v_mfma_f32_32x32x16_bf16 v[48:63], v[236:239], v[116:119], v[48:63]
    s_nop 8
    ds_write_b128 v3, v[32:35] offset:34816
    v_mfma_f32_32x32x16_bf16 v[48:63], v[244:247], v[120:123], v[48:63]
    ds_write_b128 v3, v[36:39] offset:34832
    ds_write_b128 v3, v[40:43] offset:34848
    v_mfma_f32_32x32x16_bf16 v[48:63], v[252:255], v[124:127], v[48:63]
    ds_write_b128 v3, v[44:47] offset:34864
    s_nop 10
    ds_write_b128 v3, v[48:51] offset:34944
    ds_write_b128 v3, v[52:55] offset:34960
    ds_write_b128 v3, v[56:59] offset:34976
    ds_write_b128 v3, v[60:63] offset:34992
    s_waitcnt lgkmcnt(0)
    s_barrier
    ds_read_b128 v[32:35], v4 offset:34816
    ds_read_b128 v[36:39], v4 offset:34832
    ds_read_b128 v[40:43], v4 offset:43520
    ds_read_b128 v[44:47], v4 offset:43536
    ds_read_b128 v[48:51], v4 offset:52224
    ds_read_b128 v[52:55], v4 offset:52240
    ds_read_b128 v[56:59], v4 offset:60928
    ds_read_b128 v[60:63], v4 offset:60944
    ds_read_b128 v[76:79], v13 offset:0
    ds_read_b128 v[80:83], v13 offset:16
    v_lshlrev_b32 v64, 16, v28
    v_and_b32 v65, s56, v28
    v_lshlrev_b32 v66, 16, v29
    v_and_b32 v67, s56, v29
    v_lshlrev_b32 v68, 16, v30
    v_and_b32 v69, s56, v30
    v_lshlrev_b32 v70, 16, v31
    v_and_b32_e64 v71, s56, v31
    s_waitcnt lgkmcnt(7)
    v_pk_add_f32 v[32:33], v[32:33], v[40:41]
    v_pk_add_f32 v[34:35], v[34:35], v[42:43]
    s_waitcnt lgkmcnt(6)
    v_pk_add_f32 v[36:37], v[36:37], v[44:45]
    v_pk_add_f32 v[38:39], v[38:39], v[46:47]
    s_waitcnt lgkmcnt(3)
    v_pk_add_f32 v[48:49], v[48:49], v[56:57]
    v_pk_add_f32 v[50:51], v[50:51], v[58:59]
    s_waitcnt lgkmcnt(2)
    v_pk_add_f32 v[52:53], v[52:53], v[60:61]
    v_pk_add_f32 v[54:55], v[54:55], v[62:63]
    v_pk_add_f32 v[64:65], v[64:65], v[32:33]
    v_pk_add_f32 v[66:67], v[66:67], v[34:35]
    v_pk_add_f32 v[68:69], v[68:69], v[36:37]
    v_pk_add_f32 v[70:71], v[70:71], v[38:39]
    v_pk_add_f32 v[64:65], v[64:65], v[48:49]
    v_pk_add_f32 v[66:67], v[66:67], v[50:51]
    v_pk_add_f32 v[68:69], v[68:69], v[52:53]
    v_pk_add_f32 v[70:71], v[70:71], v[54:55]
    s_waitcnt lgkmcnt(1)
    v_pk_add_f32 v[64:65], v[64:65], v[76:77]
    v_pk_add_f32 v[66:67], v[66:67], v[78:79]
    s_waitcnt lgkmcnt(0)
    v_pk_add_f32 v[68:69], v[68:69], v[80:81]
    v_pk_add_f32 v[70:71], v[70:71], v[82:83]
    v_cvt_pk_bf16_f32 v28, v64, v65
    v_cvt_pk_bf16_f32 v29, v66, v67
    v_cvt_pk_bf16_f32 v30, v68, v69
    v_cvt_pk_bf16_f32 v31, v70, v71
    s_add_u32 s35, s43, 32768
    buffer_store_dwordx4 v[28:31], v7, s[12:15], s35 offen
    s_branch K1_FIN
K1_SLOW:
    s_waitcnt lgkmcnt(15)
    v_lshlrev_b32 v76, 16, v76
    s_waitcnt lgkmcnt(14)
    v_lshlrev_b32 v77, 16, v77
    s_waitcnt lgkmcnt(13)
    v_lshlrev_b32 v78, 16, v78
    s_waitcnt lgkmcnt(12)
    v_lshlrev_b32 v79, 16, v79
    s_waitcnt lgkmcnt(11)
    v_lshlrev_b32 v80, 16, v80
    s_waitcnt lgkmcnt(10)
    v_lshlrev_b32 v81, 16, v81
    s_waitcnt lgkmcnt(9)
    v_lshlrev_b32 v82, 16, v82
    s_waitcnt lgkmcnt(8)
    v_lshlrev_b32 v83, 16, v83
    v_pk_fma_f32 v[84:85], v[64:65], v[74:75], v[74:75] op_sel:[0,0,1] op_sel_hi:[1,0,1]
    v_pk_fma_f32 v[86:87], v[66:67], v[74:75], v[74:75] op_sel:[0,0,1] op_sel_hi:[1,0,1]
    v_pk_fma_f32 v[88:89], v[68:69], v[74:75], v[74:75] op_sel:[0,0,1] op_sel_hi:[1,0,1]
    v_pk_fma_f32 v[90:91], v[70:71], v[74:75], v[74:75] op_sel:[0,0,1] op_sel_hi:[1,0,1]
    v_pk_fma_f32 v[64:65], v[84:85], v[76:77], v[64:65]
    v_pk_fma_f32 v[66:67], v[86:87], v[78:79], v[66:67]
    v_pk_fma_f32 v[68:69], v[88:89], v[80:81], v[68:69]
    v_pk_fma_f32 v[70:71], v[90:91], v[82:83], v[70:71]
    v_cvt_pk_bf16_f32 v24, v64, v65
    v_cvt_pk_bf16_f32 v25, v66, v67
    v_cvt_pk_bf16_f32 v26, v68, v69
    v_cvt_pk_bf16_f32 v27, v70, v71
    s_add_u32 s35, s50, 0x1800000
    buffer_store_dwordx4 v[24:27], v10, s[4:7], s35 offen sc1
    v_dot2_f32_bf16 v84, v24, s57, 0
    v_dot2_f32_bf16 v85, v24, v24, 0
    v_dot2_f32_bf16 v84, v25, s57, v84
    v_dot2_f32_bf16 v85, v25, v25, v85
    v_dot2_f32_bf16 v84, v26, s57, v84
    v_dot2_f32_bf16 v85, v26, v26, v85
    v_dot2_f32_bf16 v84, v27, s57, v84
    v_dot2_f32_bf16 v85, v27, v27, v85
    s_nop 1
    v_add_f32_dpp v84, v84, v84 quad_perm:[1,0,3,2] row_mask:0xf bank_mask:0xf
    v_add_f32_dpp v85, v85, v85 quad_perm:[1,0,3,2] row_mask:0xf bank_mask:0xf
    s_nop 0
    v_add_f32_dpp v84, v84, v84 quad_perm:[2,3,0,1] row_mask:0xf bank_mask:0xf
    v_add_f32_dpp v85, v85, v85 quad_perm:[2,3,0,1] row_mask:0xf bank_mask:0xf
    s_nop 0
    v_add_f32_dpp v84, v84, v84 row_half_mirror row_mask:0xf bank_mask:0xf
    v_add_f32_dpp v85, v85, v85 row_half_mirror row_mask:0xf bank_mask:0xf
    s_add_u32 s35, s50, 0x1802000
    s_sub_u32 s35, s35, s94
    s_mov_b32 exec_lo, 0x01010101
    s_mov_b32 exec_hi, 0x01010101
    buffer_store_dwordx2 v[84:85], v5, s[4:7], s35 offen sc1
    s_mov_b64 exec, -1
    s_waitcnt lgkmcnt(7)
    v_lshlrev_b32 v76, 16, v104
    s_waitcnt lgkmcnt(6)
    v_lshlrev_b32 v77, 16, v105
    s_waitcnt lgkmcnt(5)
    v_lshlrev_b32 v78, 16, v106
    s_waitcnt lgkmcnt(4)
    v_lshlrev_b32 v79, 16, v107
    s_waitcnt lgkmcnt(3)
    v_lshlrev_b32 v80, 16, v108
    s_waitcnt lgkmcnt(2)
    v_lshlrev_b32 v81, 16, v109
    s_waitcnt lgkmcnt(1)
    v_lshlrev_b32 v82, 16, v110
    s_waitcnt lgkmcnt(0)
    v_lshlrev_b32 v83, 16, v111
    v_lshlrev_b32 v64, 16, v28
    v_and_b32 v65, s56, v28
    v_lshlrev_b32 v66, 16, v29
    v_and_b32 v67, s56, v29
    v_lshlrev_b32 v68, 16, v30
    v_and_b32 v69, s56, v30
    v_lshlrev_b32 v70, 16, v31
    v_and_b32_e64 v71, s56, v31
    v_pk_fma_f32 v[84:85], v[64:65], v[94:95], v[94:95] op_sel:[0,0,1] op_sel_hi:[1,0,1]
    v_pk_fma_f32 v[86:87], v[66:67], v[94:95], v[94:95] op_sel:[0,0,1] op_sel_hi:[1,0,1]
    v_pk_fma_f32 v[88:89], v[68:69], v[94:95], v[94:95] op_sel:[0,0,1] op_sel_hi:[1,0,1]
    v_pk_fma_f32 v[90:91], v[70:71], v[94:95], v[94:95] op_sel:[0,0,1] op_sel_hi:[1,0,1]
    v_pk_fma_f32 v[64:65], v[84:85], v[76:77], v[64:65]
    v_pk_fma_f32 v[66:67], v[86:87], v[78:79], v[66:67]
    v_pk_fma_f32 v[68:69], v[88:89], v[80:81], v[68:69]
    v_pk_fma_f32 v[70:71], v[90:91], v[82:83], v[70:71]
    v_cvt_pk_bf16_f32 v28, v64, v65
    v_cvt_pk_bf16_f32 v29, v66, v67
    v_cvt_pk_bf16_f32 v30, v68, v69
    v_cvt_pk_bf16_f32 v31, v70, v71
    s_add_u32 s35, s50, 0x1801000
    buffer_store_dwordx4 v[28:31], v10, s[4:7], s35 offen sc1
    v_dot2_f32_bf16 v84, v28, s57, 0
    v_dot2_f32_bf16 v85, v28, v28, 0
    v_dot2_f32_bf16 v84, v29, s57, v84
    v_dot2_f32_bf16 v85, v29, v29, v85
    v_dot2_f32_bf16 v84, v30, s57, v84
    v_dot2_f32_bf16 v85, v30, v30, v85
    v_dot2_f32_bf16 v84, v31, s57, v84
    v_dot2_f32_bf16 v85, v31, v31, v85
    s_nop 1
    v_add_f32_dpp v84, v84, v84 quad_perm:[1,0,3,2] row_mask:0xf bank_mask:0xf
    v_add_f32_dpp v85, v85, v85 quad_perm:[1,0,3,2] row_mask:0xf bank_mask:0xf
    s_nop 0
    v_add_f32_dpp v84, v84, v84 quad_perm:[2,3,0,1] row_mask:0xf bank_mask:0xf
    v_add_f32_dpp v85, v85, v85 quad_perm:[2,3,0,1] row_mask:0xf bank_mask:0xf
    s_nop 0
    v_add_f32_dpp v84, v84, v84 row_half_mirror row_mask:0xf bank_mask:0xf
    v_add_f32_dpp v85, v85, v85 row_half_mirror row_mask:0xf bank_mask:0xf
    s_add_u32 s35, s50, 0x1802100
    s_sub_u32 s35, s35, s94
    s_mov_b32 exec_lo, 0x01010101
    s_mov_b32 exec_hi, 0x01010101
    buffer_store_dwordx2 v[84:85], v5, s[4:7], s35 offen sc1
    s_mov_b64 exec, -1
    s_waitcnt vmcnt(2)
    s_mov_b64 exec, 1
    buffer_store_dword v8, v8, s[4:7], s45 offen offset:0 sc1
    s_mov_b64 exec, -1
    s_add_u32 s35, s29, 0
    s_and_b32 s35, s35, 3
    s_lshl_b32 s52, s35, 8
    s_add_u32 s35, s29, 1
    s_and_b32 s35, s35, 3
    s_lshl_b32 s53, s35, 8
    s_add_u32 s35, s29, 2
    s_and_b32 s35, s35, 3
    s_lshl_b32 s54, s35, 8
    s_add_u32 s35, s29, 3
    s_and_b32 s35, s35, 3
    s_lshl_b32 s55, s35, 8
    v_and_b32_e64 v14, 15, v1
    v_mul_u32_u24 v14, 1056, v14
    v_lshrrev_b32_e64 v15, 4, v1
    v_lshl_add_u32 v14, v15, 4, v14
    v_add_u32 v64, s52, v14
    v_add_u32 v65, s53, v14
    v_add_u32 v66, s54, v14
    v_add_u32 v67, s55, v14
    ds_read_b64_tr_b16 v[184:185], v17 offset:0
    ds_read_b64_tr_b16 v[186:187], v17 offset:1024
    ds_read_b64_tr_b16 v[188:189], v17 offset:64
    ds_read_b64_tr_b16 v[190:191], v17 offset:1088
    s_waitcnt vmcnt(1)
    s_add_u32 s36, s45, 16384
    s_mov_b64 exec, 1
    buffer_store_dword v8, v8, s[4:7], s36 offen offset:0 sc1
    s_mov_b64 exec, -1
    buffer_load_dword v22, v20, s[4:7], s46 offen offset:0 sc1
    ds_read_b64_tr_b16 v[192:193], v17 offset:3072
    ds_read_b64_tr_b16 v[194:195], v17 offset:4096
    ds_read_b64_tr_b16 v[196:197], v17 offset:3136
    ds_read_b64_tr_b16 v[198:199], v17 offset:4160
    s_waitcnt vmcnt(0)
    v_cmp_eq_u32 vcc, -1, v22
    s_nop 0
    s_and_b64 vcc, exec, vcc
    s_cbranch_vccz K1_PDONE47
    s_mov_b32 s63, 524288
K1_POLL46:
    buffer_load_dword v22, v20, s[4:7], s46 offen offset:0 sc1
    s_waitcnt vmcnt(0)
    v_cmp_eq_u32 vcc, -1, v22
    s_nop 0
    s_and_b64 vcc, exec, vcc
    s_cbranch_vccz K1_PDONE47
    s_sub_u32 s63, s63, 1
    s_cmp_lg_u32 s63, 0
    s_cbranch_scc1 K1_POLL46
K1_PDONE47:
    s_add_u32 s36, s47, 0x1800000
    v_lshrrev_b32_e64 v15, 3, v1
    v_mul_u32_u24 v15, 196608, v15
    v_lshl_add_u32 v15, v20, 2, v15
    s_add_u32 m0, s48, 0
    s_nop 0
    buffer_load_dwordx4 v15, s[4:7], s36 offen offset:0 sc1 lds
    s_add_u32 m0, s48, 928
    s_nop 0
    buffer_load_dwordx4 v15, s[4:7], s36 offen offset:128 sc1 lds
    s_add_u32 m0, s48, 1856
    s_nop 0
    buffer_load_dwordx4 v15, s[4:7], s36 offen offset:256 sc1 lds
    s_add_u32 m0, s48, 2784
    s_nop 0
    buffer_load_dwordx4 v15, s[4:7], s36 offen offset:384 sc1 lds
    s_add_u32 m0, s48, 3712
    s_nop 0
    buffer_load_dwordx4 v15, s[4:7], s36 offen offset:512 sc1 lds
    s_add_u32 m0, s48, 4640
    s_nop 0
    buffer_load_dwordx4 v15, s[4:7], s36 offen offset:640 sc1 lds
    s_add_u32 m0, s48, 5568
    s_nop 0
    buffer_load_dwordx4 v15, s[4:7], s36 offen offset:768 sc1 lds
    s_add_u32 m0, s48, 6496
    s_nop 0
    buffer_load_dwordx4 v15, s[4:7], s36 offen offset:896 sc1 lds
    s_waitcnt lgkmcnt(0)
    s_add_u32 s37, s46, 16384
    buffer_load_dword v22, v20, s[4:7], s37 offen offset:0 sc1
    ds_read_b64_tr_b16 v[200:201], v17 offset:5120
    ds_read_b64_tr_b16 v[202:203], v17 offset:6144
    ds_read_b64_tr_b16 v[204:205], v17 offset:5184
    ds_read_b64_tr_b16 v[206:207], v17 offset:6208
    ds_read_b64_tr_b16 v[208:209], v17 offset:7168
    ds_read_b64_tr_b16 v[210:211], v17 offset:8192
    ds_read_b64_tr_b16 v[212:213], v17 offset:7232
    ds_read_b64_tr_b16 v[214:215], v17 offset:8256
    ds_read_b64_tr_b16 v[216:217], v17 offset:9216
    ds_read_b64_tr_b16 v[218:219], v17 offset:10240
    ds_read_b64_tr_b16 v[220:221], v17 offset:9280
    ds_read_b64_tr_b16 v[222:223], v17 offset:10304
    s_waitcnt vmcnt(1)
    s_barrier
    s_add_u32 s38, s51, 25174016
    s_add_u32 s39, s38, 196608
    ds_read_b128 v[84:87], v64 offset:0
    ds_read_b128 v[88:91], v64 offset:16896
    ds_read_b128 v[56:59], v64 offset:64
    ds_read_b128 v[60:63], v64 offset:16960
    s_waitcnt lgkmcnt(2)
    v_mfma_f32_16x16x32_bf16 v[96:99], a[0:3], v[84:87], 0
    ds_read_b128 v[76:79], v64 offset:128
    v_mfma_f32_16x16x32_bf16 v[100:103], a[64:67], v[84:87], 0
    buffer_load_dwordx2 v[72:73], v9, s[4:7], s38 offen offset:128 sc1
    v_mfma_f32_16x16x32_bf16 v[104:107], a[128:131], v[84:87], 0
    ds_read_b128 v[80:83], v64 offset:17024
    s_waitcnt vmcnt(1)
    v_cmp_eq_u32 vcc, -1, v22
    s_nop 0
    s_and_b64 vcc, exec, vcc
    s_cbranch_vccz K1_PDONE49
    s_mov_b32 s63, 524288
K1_POLL48:
    buffer_load_dword v22, v20, s[4:7], s37 offen offset:0 sc1
    s_waitcnt vmcnt(0)
    v_cmp_eq_u32 vcc, -1, v22
    s_nop 0
    s_and_b64 vcc, exec, vcc
    s_cbranch_vccz K1_PDONE49
    s_sub_u32 s63, s63, 1
    s_cmp_lg_u32 s63, 0
    s_cbranch_scc1 K1_POLL48
K1_PDONE49:
    v_mfma_f32_16x16x32_bf16 v[108:111], a[0:3], v[88:91], 0
    buffer_load_dwordx2 v[74:75], v9, s[4:7], s39 offen offset:128 sc1
    s_add_u32 s36, s47, 0x1801000
    v_lshrrev_b32_e64 v15, 3, v1
    v_mul_u32_u24 v15, 196608, v15
    v_lshl_add_u32 v15, v20, 2, v15
    v_mfma_f32_16x16x32_bf16 v[112:115], a[64:67], v[88:91], 0
    v_mfma_f32_16x16x32_bf16 v[116:119], a[128:131], v[88:91], 0
    buffer_load_dwordx2 v[92:93], v9, s[4:7], s38 offen offset:0 sc1
    s_waitcnt lgkmcnt(2)
    v_mfma_f32_16x16x32_bf16 v[96:99], a[4:7], v[56:59], v[96:99]
    ds_read_b128 v[84:87], v64 offset:192
    v_mfma_f32_16x16x32_bf16 v[100:103], a[68:71], v[56:59], v[100:103]
    buffer_load_dwordx2 v[94:95], v9, s[4:7], s39 offen offset:0 sc1
    v_mfma_f32_16x16x32_bf16 v[104:107], a[132:135], v[56:59], v[104:107]
    ds_read_b128 v[88:91], v64 offset:17088
    v_mfma_f32_16x16x32_bf16 v[108:111], a[4:7], v[60:63], v[108:111]
    s_add_u32 m0, s48, 33792
    s_nop 0
    buffer_load_dwordx4 v15, s[4:7], s36 offen offset:0 sc1 lds
    v_mfma_f32_16x16x32_bf16 v[112:115], a[68:71], v[60:63], v[112:115]
    s_add_u32 m0, s48, 34720
    s_nop 0
    buffer_load_dwordx4 v15, s[4:7], s36 offen offset:128 sc1 lds
    v_mfma_f32_16x16x32_bf16 v[116:119], a[132:135], v[60:63], v[116:119]
    s_waitcnt lgkmcnt(2)
    v_mfma_f32_16x16x32_bf16 v[96:99], a[8:11], v[76:79], v[96:99]
    ds_read_b128 v[56:59], v65 offset:0
    v_mfma_f32_16x16x32_bf16 v[100:103], a[72:75], v[76:79], v[100:103]
    s_add_u32 m0, s48, 35648
    s_nop 0
    buffer_load_dwordx4 v15, s[4:7], s36 offen offset:256 sc1 lds
    v_mfma_f32_16x16x32_bf16 v[104:107], a[136:139], v[76:79], v[104:107]
    ds_read_b128 v[60:63], v65 offset:16896
    v_mfma_f32_16x16x32_bf16 v[108:111], a[8:11], v[80:83], v[108:111]
    s_add_u32 m0, s48, 36576
    s_nop 0
    buffer_load_dwordx4 v15, s[4:7], s36 offen offset:384 sc1 lds
    v_mfma_f32_16x16x32_bf16 v[112:115], a[72:75], v[80:83], v[112:115]
    s_add_u32 m0, s48, 37504
    s_nop 0
    buffer_load_dwordx4 v15, s[4:7], s36 offen offset:512 sc1 lds
    v_mfma_f32_16x16x32_bf16 v[116:119], a[136:139], v[80:83], v[116:119]
    s_waitcnt lgkmcnt(2)
    v_mfma_f32_16x16x32_bf16 v[96:99], a[12:15], v[84:87], v[96:99]
    ds_read_b128 v[76:79], v65 offset:64
    v_mfma_f32_16x16x32_bf16 v[100:103], a[76:79], v[84:87], v[100:103]
    s_add_u32 m0, s48, 38432
    s_nop 0
    buffer_load_dwordx4 v15, s[4:7], s36 offen offset:640 sc1 lds
    v_mfma_f32_16x16x32_bf16 v[104:107], a[140:143], v[84:87], v[104:107]
    ds_read_b128 v[80:83], v65 offset:16960
    v_mfma_f32_16x16x32_bf16 v[108:111], a[12:15], v[88:91], v[108:111]
    s_add_u32 m0, s48, 39360
    s_nop 0
    buffer_load_dwordx4 v15, s[4:7], s36 offen offset:768 sc1 lds
    v_mfma_f32_16x16x32_bf16 v[112:115], a[76:79], v[88:91], v[112:115]
    s_add_u32 m0, s48, 40288
    s_nop 0
    buffer_load_dwordx4 v15, s[4:7], s36 offen offset:896 sc1 lds
    v_mfma_f32_16x16x32_bf16 v[116:119], a[140:143], v[88:91], v[116:119]
    s_waitcnt lgkmcnt(2)
    v_mfma_f32_16x16x32_bf16 v[96:99], a[16:19], v[56:59], v[96:99]
    ds_read_b128 v[84:87], v65 offset:128
    v_mfma_f32_16x16x32_bf16 v[100:103], a[80:83], v[56:59], v[100:103]
    v_mfma_f32_16x16x32_bf16 v[104:107], a[144:147], v[56:59], v[104:107]
    ds_read_b128 v[88:91], v65 offset:17024
    v_mfma_f32_16x16x32_bf16 v[108:111], a[16:19], v[60:63], v[108:111]
    v_mfma_f32_16x16x32_bf16 v[112:115], a[80:83], v[60:63], v[112:115]
    v_mfma_f32_16x16x32_bf16 v[116:119], a[144:147], v[60:63], v[116:119]
    s_waitcnt lgkmcnt(2)
    v_mfma_f32_16x16x32_bf16 v[96:99], a[20:23], v[76:79], v[96:99]
    ds_read_b128 v[56:59], v65 offset:192
    v_mfma_f32_16x16x32_bf16 v[100:103], a[84:87], v[76:79], v[100:103]
    v_mfma_f32_16x16x32_bf16 v[104:107], a[148:151], v[76:79], v[104:107]
    ds_read_b128 v[60:63], v65 offset:17088
    v_mfma_f32_16x16x32_bf16 v[108:111], a[20:23], v[80:83], v[108:111]
    v_mfma_f32_16x16x32_bf16 v[112:115], a[84:87], v[80:83], v[112:115]
    v_mfma_f32_16x16x32_bf16 v[116:119], a[148:151], v[80:83], v[116:119]
    s_waitcnt lgkmcnt(2)
    v_mfma_f32_16x16x32_bf16 v[96:99], a[24:27], v[84:87], v[96:99]
    ds_read_b128 v[76:79], v66 offset:0
    v_mfma_f32_16x16x32_bf16 v[100:103], a[88:91], v[84:87], v[100:103]
    v_mfma_f32_16x16x32_bf16 v[104:107], a[152:155], v[84:87], v[104:107]
    ds_read_b128 v[80:83], v66 offset:16896
    v_mfma_f32_16x16x32_bf16 v[108:111], a[24:27], v[88:91], v[108:111]
    v_mfma_f32_16x16x32_bf16 v[112:115], a[88:91], v[88:91], v[112:115]
    s_waitcnt vmcnt(10)
    v_add_f32 v72, v72, v74
    v_mfma_f32_16x16x32_bf16 v[116:119], a[152:155], v[88:91], v[116:119]
    v_add_f32 v73, v73, v75
    s_waitcnt lgkmcnt(2)
    v_mfma_f32_16x16x32_bf16 v[96:99], a[28:31], v[56:59], v[96:99]
    ds_read_b128 v[84:87], v66 offset:64
    v_mov_b32_e64 v74, v72
    v_mfma_f32_16x16x32_bf16 v[100:103], a[92:95], v[56:59], v[100:103]
    s_add_u32 s3, s3, 16384
    s_cmp_eq_u32 s3, s95
    s_cselect_b32 s39, 360448, 0
    s_sub_u32 s3, s3, s39
    v_add_u32_e64 v18, s3, v253
    s_add_u32 m0, s91, 11264
    v_add_u32 v19, 7168, v18
    buffer_load_dwordx4 v18, s[96:99], 0 offen lds
    buffer_load_dwordx4 v19, s[96:99], 0 offen offset:1024 lds
    v_mfma_f32_16x16x32_bf16 v[104:107], a[156:159], v[56:59], v[104:107]
    ds_read_b128 v[88:91], v66 offset:16960
    v_mov_b32_e64 v75, v73
    v_mfma_f32_16x16x32_bf16 v[108:111], a[28:31], v[60:63], v[108:111]
    v_permlane32_swap_b32_e64 v74, v72
    v_mfma_f32_16x16x32_bf16 v[112:115], a[92:95], v[60:63], v[112:115]
    v_permlane32_swap_b32_e64 v75, v73
    v_mfma_f32_16x16x32_bf16 v[116:119], a[156:159], v[60:63], v[116:119]
    v_add_f32 v72, v72, v74
    s_waitcnt lgkmcnt(2)
    v_mfma_f32_16x16x32_bf16 v[96:99], a[32:35], v[76:79], v[96:99]
    ds_read_b128 v[56:59], v66 offset:128
    v_add_f32_e64 v73, v73, v75
    v_mfma_f32_16x16x32_bf16 v[100:103], a[96:99], v[76:79], v[100:103]
    v_mov_b32_e64 v74, v72
    v_mfma_f32_16x16x32_bf16 v[104:107], a[160:163], v[76:79], v[104:107]
    ds_read_b128 v[60:63], v66 offset:17024
    v_mfma_f32_16x16x32_bf16 v[108:111], a[32:35], v[80:83], v[108:111]
    v_mov_b32_e64 v75, v73
    v_mfma_f32_16x16x32_bf16 v[112:115], a[96:99], v[80:83], v[112:115]
    v_permlane16_swap_b32_e64 v74, v72
    v_mfma_f32_16x16x32_bf16 v[116:119], a[160:163], v[80:83], v[116:119]
    v_permlane16_swap_b32 v75, v73
    s_waitcnt lgkmcnt(2)
    v_mfma_f32_16x16x32_bf16 v[96:99], a[36:39], v[84:87], v[96:99]
    ds_read_b128 v[76:79], v66 offset:192
    s_add_u32 s3, s3, 16384
    s_cmp_eq_u32 s3, s95
    s_cselect_b32 s39, 360448, 0
    s_sub_u32 s3, s3, s39
    v_add_u32_e64 v18, s3, v253
    s_add_u32 m0, s91, 13312
    v_add_u32 v19, 7168, v18
    buffer_load_dwordx4 v18, s[96:99], 0 offen lds
    buffer_load_dwordx4 v19, s[96:99], 0 offen offset:1024 lds
    v_mfma_f32_16x16x32_bf16 v[100:103], a[100:103], v[84:87], v[100:103]
    v_add_f32 v72, v72, v74
    v_add_f32 v73, v73, v75
    v_mfma_f32_16x16x32_bf16 v[104:107], a[164:167], v[84:87], v[104:107]
    ds_read_b128 v[80:83], v66 offset:17088
    v_mfma_f32_16x16x32_bf16 v[108:111], a[36:39], v[88:91], v[108:111]
    v_mul_f32_e64 v72, s62, v72
    v_mfma_f32_16x16x32_bf16 v[112:115], a[100:103], v[88:91], v[112:115]
    v_mul_f32_e64 v73, s62, v73
    v_mfma_f32_16x16x32_bf16 v[116:119], a[164:167], v[88:91], v[116:119]
    v_fma_f32 v73, -v72, v72, v73
    s_waitcnt lgkmcnt(2)
    v_mfma_f32_16x16x32_bf16 v[96:99], a[40:43], v[56:59], v[96:99]
    ds_read_b128 v[84:87], v67 offset:0
    v_max_f32 v73, 0, v73
    v_mfma_f32_16x16x32_bf16 v[100:103], a[104:107], v[56:59], v[100:103]
    v_mfma_f32_16x16x32_bf16 v[104:107], a[168:171], v[56:59], v[104:107]
    ds_read_b128 v[88:91], v67 offset:16896
    v_add_f32 v73, 0x3727c5ac, v73
    v_mfma_f32_16x16x32_bf16 v[108:111], a[40:43], v[60:63], v[108:111]
    v_rsq_f32_e64 v70, v73
    v_mfma_f32_16x16x32_bf16 v[112:115], a[104:107], v[60:63], v[112:115]
    v_mul_f32_e64 v72, -1.0, v72
    v_mfma_f32_16x16x32_bf16 v[116:119], a[168:171], v[60:63], v[116:119]
    s_add_u32 s3, s3, 16384
    s_cmp_eq_u32 s3, s95
    s_cselect_b32 s39, 360448, 0
    s_sub_u32 s3, s3, s39
    v_add_u32 v18, s3, v253
    s_add_u32 m0, s91, 0
    v_add_u32 v19, 7168, v18
    buffer_load_dwordx4 v18, s[96:99], 0 offen lds
    buffer_load_dwordx4 v19, s[96:99], 0 offen offset:1024 lds
    s_waitcnt lgkmcnt(2)
    v_mfma_f32_16x16x32_bf16 v[96:99], a[44:47], v[76:79], v[96:99]
    ds_read_b128 v[56:59], v67 offset:64
    v_mul_f32 v71, v72, v70
    v_mfma_f32_16x16x32_bf16 v[100:103], a[108:111], v[76:79], v[100:103]
    s_waitcnt vmcnt(14)
    v_add_f32 v92, v92, v94
    v_mfma_f32_16x16x32_bf16 v[104:107], a[172:175], v[76:79], v[104:107]
    ds_read_b128 v[60:63], v67 offset:16960
    v_add_f32_e64 v93, v93, v95
    v_mfma_f32_16x16x32_bf16 v[108:111], a[44:47], v[80:83], v[108:111]
    v_mov_b32_e64 v94, v92
    v_mfma_f32_16x16x32_bf16 v[112:115], a[108:111], v[80:83], v[112:115]
    v_mov_b32_e64 v95, v93
    v_mfma_f32_16x16x32_bf16 v[116:119], a[172:175], v[80:83], v[116:119]
    v_permlane32_swap_b32 v94, v92
    s_waitcnt lgkmcnt(2)
    v_mfma_f32_16x16x32_bf16 v[96:99], a[48:51], v[84:87], v[96:99]
    ds_read_b128 v[76:79], v67 offset:128
    v_mfma_f32_16x16x32_bf16 v[100:103], a[112:115], v[84:87], v[100:103]
    v_permlane32_swap_b32_e64 v95, v93
    v_mfma_f32_16x16x32_bf16 v[104:107], a[176:179], v[84:87], v[104:107]
    ds_read_b128 v[80:83], v67 offset:17024
    v_add_f32_e64 v92, v92, v94
    v_mfma_f32_16x16x32_bf16 v[108:111], a[48:51], v[88:91], v[108:111]
    v_add_f32_e64 v93, v93, v95
    v_mfma_f32_16x16x32_bf16 v[112:115], a[112:115], v[88:91], v[112:115]
    s_add_u32 s3, s3, 16384
    s_cmp_eq_u32 s3, s95
    s_cselect_b32 s39, 360448, 0
    s_sub_u32 s3, s3, s39
    v_add_u32_e64 v18, s3, v253
    s_add_u32 m0, s91, 3072
    v_add_u32 v19, 7168, v18
    buffer_load_dwordx4 v18, s[96:99], 0 offen lds
    buffer_load_dwordx4 v19, s[96:99], 0 offen offset:1024 lds
    v_mfma_f32_16x16x32_bf16 v[116:119], a[176:179], v[88:91], v[116:119]
    v_mov_b32 v94, v92
    s_waitcnt lgkmcnt(2)
    v_mfma_f32_16x16x32_bf16 v[96:99], a[52:55], v[56:59], v[96:99]
    ds_read_b128 v[84:87], v67 offset:192
    v_mov_b32_e64 v95, v93
    v_mfma_f32_16x16x32_bf16 v[100:103], a[116:119], v[56:59], v[100:103]
    v_permlane16_swap_b32_e64 v94, v92
    v_mfma_f32_16x16x32_bf16 v[104:107], a[180:183], v[56:59], v[104:107]
    ds_read_b128 v[88:91], v67 offset:17088
    v_permlane16_swap_b32_e64 v95, v93
    v_mfma_f32_16x16x32_bf16 v[108:111], a[52:55], v[60:63], v[108:111]
    v_add_f32_e64 v92, v92, v94
    v_mfma_f32_16x16x32_bf16 v[112:115], a[116:119], v[60:63], v[112:115]
    v_add_f32_e64 v93, v93, v95
    v_mfma_f32_16x16x32_bf16 v[116:119], a[180:183], v[60:63], v[116:119]
    s_waitcnt lgkmcnt(2)
    v_mfma_f32_16x16x32_bf16 v[96:99], a[56:59], v[76:79], v[96:99]
    v_mul_f32 v92, s62, v92
    v_mfma_f32_16x16x32_bf16 v[100:103], a[120:123], v[76:79], v[100:103]
    ds_read_b128 v[136:139], v12 offset:0
    v_mul_f32_e64 v93, s62, v93
    v_mfma_f32_16x16x32_bf16 v[104:107], a[184:187], v[76:79], v[104:107]
    v_fma_f32 v93, -v92, v92, v93
    v_mfma_f32_16x16x32_bf16 v[108:111], a[56:59], v[80:83], v[108:111]
    ds_read_b128 v[140:143], v12 offset:16
    v_max_f32_e64 v93, 0, v93
    v_mfma_f32_16x16x32_bf16 v[112:115], a[120:123], v[80:83], v[112:115]
    v_mfma_f32_16x16x32_bf16 v[116:119], a[184:187], v[80:83], v[116:119]
    v_add_f32 v93, 0x3727c5ac, v93
    s_waitcnt lgkmcnt(2)
    v_mfma_f32_16x16x32_bf16 v[96:99], a[60:63], v[84:87], v[96:99]
    v_rsq_f32 v68, v93
    v_mfma_f32_16x16x32_bf16 v[100:103], a[124:127], v[84:87], v[100:103]
    v_mul_f32_e64 v92, -1.0, v92
    v_mfma_f32_16x16x32_bf16 v[104:107], a[188:191], v[84:87], v[104:107]
    v_mul_f32_e64 v69, v92, v68
    v_mfma_f32_16x16x32_bf16 v[108:111], a[60:63], v[88:91], v[108:111]
    v_mfma_f32_16x16x32_bf16 v[112:115], a[124:127], v[88:91], v[112:115]
    v_mfma_f32_16x16x32_bf16 v[116:119], a[188:191], v[88:91], v[116:119]
    s_add_u32 s35, s40, 0
    s_cmp_eq_u32 s16, 3
    s_cselect_b32 s39, s90, s35
    s_waitcnt lgkmcnt(0)
    v_pk_fma_f32 v[120:121], v[68:69], v[140:141], v[136:137] op_sel:[1,0,0] op_sel_hi:[1,1,1]
    v_pk_fma_f32 v[122:123], v[68:69], v[142:143], v[138:139] op_sel:[1,0,0] op_sel_hi:[1,1,1]
    v_pk_fma_f32 v[124:125], v[70:71], v[140:141], v[136:137] op_sel:[1,0,0] op_sel_hi:[1,1,1]
    v_pk_fma_f32 v[126:127], v[70:71], v[142:143], v[138:139] op_sel:[1,0,0] op_sel_hi:[1,1,1]
    ds_read_b128 v[136:139], v12 offset:128
    ds_read_b128 v[140:143], v12 offset:144
    v_pk_fma_f32 v[120:121], v[68:69], v[96:97], v[120:121] op_sel_hi:[0,1,1]
    v_pk_fma_f32 v[122:123], v[68:69], v[98:99], v[122:123] op_sel_hi:[0,1,1]
    v_pk_fma_f32 v[124:125], v[70:71], v[108:109], v[124:125] op_sel_hi:[0,1,1]
    v_pk_fma_f32 v[126:127], v[70:71], v[110:111], v[126:127] op_sel_hi:[0,1,1]
    v_pk_mul_f32 v[128:129], v[120:121], v[120:121]
    v_pk_mul_f32 v[130:131], v[122:123], v[122:123]
    v_pk_mul_f32 v[132:133], v[124:125], v[124:125]
    v_pk_mul_f32 v[134:135], v[126:127], v[126:127]
    v_pk_fma_f32 v[128:129], v[128:129], s[58:59], v[0:1] op_sel_hi:[1,1,0]
    v_pk_fma_f32 v[130:131], v[130:131], s[58:59], v[0:1] op_sel_hi:[1,1,0]
    v_pk_fma_f32 v[132:133], v[132:133], s[58:59], v[0:1] op_sel_hi:[1,1,0]
    v_pk_fma_f32 v[134:135], v[134:135], s[58:59], v[0:1] op_sel_hi:[1,1,0]
    v_pk_mul_f32 v[128:129], v[120:121], v[128:129]
    v_pk_mul_f32 v[130:131], v[122:123], v[130:131]
    v_pk_mul_f32 v[132:133], v[124:125], v[132:133]
    v_pk_mul_f32 v[134:135], v[126:127], v[134:135]
    v_exp_f32 v128, v128
    v_exp_f32 v129, v129
    v_exp_f32 v130, v130
    v_exp_f32 v131, v131
    v_exp_f32 v132, v132
    v_exp_f32 v133, v133
    v_exp_f32 v134, v134
    v_exp_f32 v135, v135
    v_pk_add_f32 v[128:129], v[128:129], 1.0 op_sel_hi:[1,0]
    v_pk_add_f32 v[130:131], v[130:131], 1.0 op_sel_hi:[1,0]
    v_pk_add_f32 v[132:133], v[132:133], 1.0 op_sel_hi:[1,0]
    v_pk_add_f32 v[134:135], v[134:135], 1.0 op_sel_hi:[1,0]
    v_rcp_f32 v128, v128
    v_rcp_f32 v129, v129
    v_rcp_f32 v130, v130
    v_rcp_f32 v131, v131
    v_rcp_f32 v132, v132
    v_rcp_f32 v133, v133
    v_rcp_f32 v134, v134
    v_rcp_f32 v135, v135
    v_pk_mul_f32 v[120:121], v[120:121], v[128:129]
    v_pk_mul_f32 v[122:123], v[122:123], v[130:131]
    v_pk_mul_f32 v[124:125], v[124:125], v[132:133]
    v_pk_mul_f32 v[126:127], v[126:127], v[134:135]
    v_cvt_pk_bf16_f32 v128, v120, v121
    v_cvt_pk_bf16_f32 v129, v122, v123
    v_cvt_pk_bf16_f32 v130, v124, v125
    v_cvt_pk_bf16_f32 v131, v126, v127
    s_nop 0
    v_permlane32_swap_b32 v128, v130
    v_permlane32_swap_b32_e64 v129, v131
    buffer_store_dwordx4 v[128:131], v2, s[4:7], s35 offen offset:0 sc1
    s_waitcnt lgkmcnt(0)
    v_pk_fma_f32 v[120:121], v[68:69], v[140:141], v[136:137] op_sel:[1,0,0] op_sel_hi:[1,1,1]
    v_pk_fma_f32 v[122:123], v[68:69], v[142:143], v[138:139] op_sel:[1,0,0] op_sel_hi:[1,1,1]
    v_pk_fma_f32 v[124:125], v[70:71], v[140:141], v[136:137] op_sel:[1,0,0] op_sel_hi:[1,1,1]
    v_pk_fma_f32 v[126:127], v[70:71], v[142:143], v[138:139] op_sel:[1,0,0] op_sel_hi:[1,1,1]
    ds_read_b128 v[136:139], v12 offset:256
    ds_read_b128 v[140:143], v12 offset:272
    v_pk_fma_f32 v[120:121], v[68:69], v[100:101], v[120:121] op_sel_hi:[0,1,1]
    v_pk_fma_f32 v[122:123], v[68:69], v[102:103], v[122:123] op_sel_hi:[0,1,1]
    v_pk_fma_f32 v[124:125], v[70:71], v[112:113], v[124:125] op_sel_hi:[0,1,1]
    v_pk_fma_f32 v[126:127], v[70:71], v[114:115], v[126:127] op_sel_hi:[0,1,1]
    v_pk_mul_f32 v[128:129], v[120:121], v[120:121]
    v_pk_mul_f32 v[130:131], v[122:123], v[122:123]
    v_pk_mul_f32 v[132:133], v[124:125], v[124:125]
    v_pk_mul_f32 v[134:135], v[126:127], v[126:127]
    v_pk_fma_f32 v[128:129], v[128:129], s[58:59], v[0:1] op_sel_hi:[1,1,0]
    v_pk_fma_f32 v[130:131], v[130:131], s[58:59], v[0:1] op_sel_hi:[1,1,0]
    v_pk_fma_f32 v[132:133], v[132:133], s[58:59], v[0:1] op_sel_hi:[1,1,0]
    v_pk_fma_f32 v[134:135], v[134:135], s[58:59], v[0:1] op_sel_hi:[1,1,0]
    v_pk_mul_f32 v[128:129], v[120:121], v[128:129]
    v_pk_mul_f32 v[130:131], v[122:123], v[130:131]
    v_pk_mul_f32 v[132:133], v[124:125], v[132:133]
    v_pk_mul_f32 v[134:135], v[126:127], v[134:135]
    v_exp_f32 v128, v128
    v_exp_f32 v129, v129
    v_exp_f32 v130, v130
    v_exp_f32 v131, v131
    v_exp_f32 v132, v132
    v_exp_f32 v133, v133
    v_exp_f32 v134, v134
    v_exp_f32_e64 v135, v135
    v_pk_add_f32 v[128:129], v[128:129], 1.0 op_sel_hi:[1,0]
    v_pk_add_f32 v[130:131], v[130:131], 1.0 op_sel_hi:[1,0]
    v_pk_add_f32 v[132:133], v[132:133], 1.0 op_sel_hi:[1,0]
    v_pk_add_f32 v[134:135], v[134:135], 1.0 op_sel_hi:[1,0]
    v_rcp_f32 v128, v128
    v_rcp_f32 v129, v129
    v_rcp_f32 v130, v130
    v_rcp_f32 v131, v131
    v_rcp_f32 v132, v132
    v_rcp_f32 v133, v133
    v_rcp_f32 v134, v134
    v_rcp_f32 v135, v135
    v_pk_mul_f32 v[120:121], v[120:121], v[128:129]
    v_pk_mul_f32 v[122:123], v[122:123], v[130:131]
    v_pk_mul_f32 v[124:125], v[124:125], v[132:133]
    v_pk_mul_f32 v[126:127], v[126:127], v[134:135]
    v_cvt_pk_bf16_f32 v128, v120, v121
    v_cvt_pk_bf16_f32 v129, v122, v123
    v_cvt_pk_bf16_f32 v130, v124, v125
    v_cvt_pk_bf16_f32 v131, v126, v127
    s_nop 0
    v_permlane32_swap_b32 v128, v130
    v_permlane32_swap_b32_e64 v129, v131
    buffer_store_dwordx4 v[128:131], v2, s[4:7], s35 offen offset:1024 sc1
    s_waitcnt lgkmcnt(0)
    v_pk_fma_f32 v[120:121], v[68:69], v[140:141], v[136:137] op_sel:[1,0,0] op_sel_hi:[1,1,1]
    v_pk_fma_f32 v[122:123], v[68:69], v[142:143], v[138:139] op_sel:[1,0,0] op_sel_hi:[1,1,1]
    v_pk_fma_f32 v[124:125], v[70:71], v[140:141], v[136:137] op_sel:[1,0,0] op_sel_hi:[1,1,1]
    v_pk_fma_f32 v[126:127], v[70:71], v[142:143], v[138:139] op_sel:[1,0,0] op_sel_hi:[1,1,1]
    v_pk_fma_f32 v[120:121], v[68:69], v[104:105], v[120:121] op_sel_hi:[0,1,1]
    v_pk_fma_f32 v[122:123], v[68:69], v[106:107], v[122:123] op_sel_hi:[0,1,1]
    v_pk_fma_f32 v[124:125], v[70:71], v[116:117], v[124:125] op_sel_hi:[0,1,1]
    v_pk_fma_f32 v[126:127], v[70:71], v[118:119], v[126:127] op_sel_hi:[0,1,1]
    v_pk_mul_f32 v[128:129], v[120:121], v[120:121]
    v_pk_mul_f32 v[130:131], v[122:123], v[122:123]
    v_pk_mul_f32 v[132:133], v[124:125], v[124:125]
    v_pk_mul_f32 v[134:135], v[126:127], v[126:127]
    v_pk_fma_f32 v[128:129], v[128:129], s[58:59], v[0:1] op_sel_hi:[1,1,0]
    s_waitcnt vmcnt(10)
    s_barrier
    ds_read_b128 v[84:87], v64 offset:33792
    ds_read_b128 v[88:91], v64 offset:50688
    ds_read_b128 v[56:59], v64 offset:33856
    ds_read_b128 v[60:63], v64 offset:50752
    v_pk_fma_f32 v[130:131], v[130:131], s[58:59], v[0:1] op_sel_hi:[1,1,0]
    v_pk_fma_f32 v[132:133], v[132:133], s[58:59], v[0:1] op_sel_hi:[1,1,0]
    v_pk_fma_f32 v[134:135], v[134:135], s[58:59], v[0:1] op_sel_hi:[1,1,0]
    v_pk_mul_f32 v[128:129], v[120:121], v[128:129]
    v_pk_mul_f32 v[130:131], v[122:123], v[130:131]
    v_pk_mul_f32 v[132:133], v[124:125], v[132:133]
    v_pk_mul_f32 v[134:135], v[126:127], v[134:135]
    v_exp_f32 v128, v128
    v_exp_f32 v129, v129
    v_exp_f32 v130, v130
    v_exp_f32 v131, v131
    v_exp_f32 v132, v132
    v_exp_f32 v133, v133
    v_exp_f32 v134, v134
    v_exp_f32_e64 v135, v135
    v_pk_add_f32 v[128:129], v[128:129], 1.0 op_sel_hi:[1,0]
    v_pk_add_f32 v[130:131], v[130:131], 1.0 op_sel_hi:[1,0]
    v_pk_add_f32 v[132:133], v[132:133], 1.0 op_sel_hi:[1,0]
    v_pk_add_f32 v[134:135], v[134:135], 1.0 op_sel_hi:[1,0]
    v_rcp_f32 v128, v128
    v_rcp_f32 v129, v129
    v_rcp_f32 v130, v130
    v_rcp_f32 v131, v131
    v_rcp_f32 v132, v132
    v_rcp_f32 v133, v133
    v_rcp_f32 v134, v134
    v_rcp_f32 v135, v135
    v_pk_mul_f32 v[120:121], v[120:121], v[128:129]
    v_pk_mul_f32 v[122:123], v[122:123], v[130:131]
    v_pk_mul_f32 v[124:125], v[124:125], v[132:133]
    v_pk_mul_f32 v[126:127], v[126:127], v[134:135]
    v_cvt_pk_bf16_f32 v128, v120, v121
    v_cvt_pk_bf16_f32 v129, v122, v123
    v_cvt_pk_bf16_f32 v130, v124, v125
    v_cvt_pk_bf16_f32 v131, v126, v127
    s_nop 0
    v_permlane32_swap_b32 v128, v130
    v_permlane32_swap_b32_e64 v129, v131
    buffer_store_dwordx4 v[128:131], v2, s[4:7], s39 offen offset:2048 sc1
    s_add_u32 s38, s51, 25174272
    s_add_u32 s39, s38, 196608
    s_waitcnt lgkmcnt(2)
    v_mfma_f32_16x16x32_bf16 v[32:35], a[0:3], v[84:87], 0
    ds_read_b128 v[76:79], v64 offset:33920
    v_mfma_f32_16x16x32_bf16 v[36:39], a[64:67], v[84:87], 0
    buffer_load_dwordx2 v[72:73], v9, s[4:7], s38 offen offset:128 sc1
    v_mfma_f32_16x16x32_bf16 v[40:43], a[128:131], v[84:87], 0
    ds_read_b128 v[80:83], v64 offset:50816
    v_mfma_f32_16x16x32_bf16 v[44:47], a[0:3], v[88:91], 0
    buffer_load_dwordx2 v[74:75], v9, s[4:7], s39 offen offset:128 sc1
    v_mfma_f32_16x16x32_bf16 v[48:51], a[64:67], v[88:91], 0
    v_mfma_f32_16x16x32_bf16 v[52:55], a[128:131], v[88:91], 0
    buffer_load_dwordx2 v[92:93], v9, s[4:7], s38 offen offset:0 sc1
    s_waitcnt lgkmcnt(2)
    v_mfma_f32_16x16x32_bf16 v[32:35], a[4:7], v[56:59], v[32:35]
    ds_read_b128 v[84:87], v64 offset:33984
    v_mfma_f32_16x16x32_bf16 v[36:39], a[68:71], v[56:59], v[36:39]
    buffer_load_dwordx2 v[94:95], v9, s[4:7], s39 offen offset:0 sc1
    v_mfma_f32_16x16x32_bf16 v[40:43], a[132:135], v[56:59], v[40:43]
    ds_read_b128 v[88:91], v64 offset:50880
    v_mfma_f32_16x16x32_bf16 v[44:47], a[4:7], v[60:63], v[44:47]
    v_mfma_f32_16x16x32_bf16 v[48:51], a[68:71], v[60:63], v[48:51]
    v_mfma_f32_16x16x32_bf16 v[52:55], a[132:135], v[60:63], v[52:55]
    s_waitcnt lgkmcnt(2)
    v_mfma_f32_16x16x32_bf16 v[32:35], a[8:11], v[76:79], v[32:35]
    ds_read_b128 v[56:59], v65 offset:33792
    v_mfma_f32_16x16x32_bf16 v[36:39], a[72:75], v[76:79], v[36:39]
    v_mfma_f32_16x16x32_bf16 v[40:43], a[136:139], v[76:79], v[40:43]
    ds_read_b128 v[60:63], v65 offset:50688
    v_mfma_f32_16x16x32_bf16 v[44:47], a[8:11], v[80:83], v[44:47]
    v_mfma_f32_16x16x32_bf16 v[48:51], a[72:75], v[80:83], v[48:51]
    v_mfma_f32_16x16x32_bf16 v[52:55], a[136:139], v[80:83], v[52:55]
    s_waitcnt lgkmcnt(2)
    v_mfma_f32_16x16x32_bf16 v[32:35], a[12:15], v[84:87], v[32:35]
    ds_read_b128 v[76:79], v65 offset:33856
    v_mfma_f32_16x16x32_bf16 v[36:39], a[76:79], v[84:87], v[36:39]
    v_mfma_f32_16x16x32_bf16 v[40:43], a[140:143], v[84:87], v[40:43]
    ds_read_b128 v[80:83], v65 offset:50752
    v_mfma_f32_16x16x32_bf16 v[44:47], a[12:15], v[88:91], v[44:47]
    v_mfma_f32_16x16x32_bf16 v[48:51], a[76:79], v[88:91], v[48:51]
    v_mfma_f32_16x16x32_bf16 v[52:55], a[140:143], v[88:91], v[52:55]
    s_waitcnt lgkmcnt(2)
    v_mfma_f32_16x16x32_bf16 v[32:35], a[16:19], v[56:59], v[32:35]
    ds_read_b128 v[84:87], v65 offset:33920
    v_mfma_f32_16x16x32_bf16 v[36:39], a[80:83], v[56:59], v[36:39]
    v_mfma_f32_16x16x32_bf16 v[40:43], a[144:147], v[56:59], v[40:43]
    ds_read_b128 v[88:91], v65 offset:50816
    v_mfma_f32_16x16x32_bf16 v[44:47], a[16:19], v[60:63], v[44:47]
    v_mfma_f32_16x16x32_bf16 v[48:51], a[80:83], v[60:63], v[48:51]
    v_mfma_f32_16x16x32_bf16 v[52:55], a[144:147], v[60:63], v[52:55]
    s_waitcnt lgkmcnt(2)
    v_mfma_f32_16x16x32_bf16 v[32:35], a[20:23], v[76:79], v[32:35]
    ds_read_b128 v[56:59], v65 offset:33984
    v_mfma_f32_16x16x32_bf16 v[36:39], a[84:87], v[76:79], v[36:39]
    v_mfma_f32_16x16x32_bf16 v[40:43], a[148:151], v[76:79], v[40:43]
    ds_read_b128 v[60:63], v65 offset:50880
    s_waitcnt vmcnt(4)
    s_add_u32 s36, s41, 0
    s_mov_b64 exec, 1
    buffer_store_dword v8, v8, s[4:7], s36 offen offset:0 sc1
    s_mov_b64 exec, -1
    v_mfma_f32_16x16x32_bf16 v[44:47], a[20:23], v[80:83], v[44:47]
    v_mfma_f32_16x16x32_bf16 v[48:51], a[84:87], v[80:83], v[48:51]
    v_mfma_f32_16x16x32_bf16 v[52:55], a[148:151], v[80:83], v[52:55]
    s_waitcnt lgkmcnt(2)
    v_mfma_f32_16x16x32_bf16 v[32:35], a[24:27], v[84:87], v[32:35]
    ds_read_b128 v[76:79], v66 offset:33792
    v_mfma_f32_16x16x32_bf16 v[36:39], a[88:91], v[84:87], v[36:39]
    v_mfma_f32_16x16x32_bf16 v[40:43], a[152:155], v[84:87], v[40:43]
    ds_read_b128 v[80:83], v66 offset:50688
    v_mfma_f32_16x16x32_bf16 v[44:47], a[24:27], v[88:91], v[44:47]
    v_mfma_f32_16x16x32_bf16 v[48:51], a[88:91], v[88:91], v[48:51]
    s_waitcnt vmcnt(3)
    v_add_f32_e64 v72, v72, v74
    v_mfma_f32_16x16x32_bf16 v[52:55], a[152:155], v[88:91], v[52:55]
    v_add_f32 v73, v73, v75
    s_waitcnt lgkmcnt(2)
    v_mfma_f32_16x16x32_bf16 v[32:35], a[28:31], v[56:59], v[32:35]
    ds_read_b128 v[84:87], v66 offset:33856
    v_mov_b32_e64 v74, v72
    v_mfma_f32_16x16x32_bf16 v[36:39], a[92:95], v[56:59], v[36:39]
    v_mov_b32_e64 v75, v73
    v_mfma_f32_16x16x32_bf16 v[40:43], a[156:159], v[56:59], v[40:43]
    ds_read_b128 v[88:91], v66 offset:50752
    v_permlane32_swap_b32_e64 v74, v72
    v_mfma_f32_16x16x32_bf16 v[44:47], a[28:31], v[60:63], v[44:47]
    v_mfma_f32_16x16x32_bf16 v[48:51], a[92:95], v[60:63], v[48:51]
    v_permlane32_swap_b32_e64 v75, v73
    v_mfma_f32_16x16x32_bf16 v[52:55], a[156:159], v[60:63], v[52:55]
    v_add_f32 v72, v72, v74
    s_waitcnt lgkmcnt(2)
    v_mfma_f32_16x16x32_bf16 v[32:35], a[32:35], v[76:79], v[32:35]
    ds_read_b128 v[56:59], v66 offset:33920
    v_add_f32_e64 v73, v73, v75
    v_mfma_f32_16x16x32_bf16 v[36:39], a[96:99], v[76:79], v[36:39]
    v_mov_b32_e64 v74, v72
    v_mfma_f32_16x16x32_bf16 v[40:43], a[160:163], v[76:79], v[40:43]
    ds_read_b128 v[60:63], v66 offset:50816
    v_mfma_f32_16x16x32_bf16 v[44:47], a[32:35], v[80:83], v[44:47]
    v_mov_b32_e64 v75, v73
    v_mfma_f32_16x16x32_bf16 v[48:51], a[96:99], v[80:83], v[48:51]
    s_add_u32 s37, s42, 0
    buffer_load_dword v22, v20, s[4:7], s37 offen offset:0 sc1
    s_add_u32 s36, s49, 0
    v_add_u32_e64 v21, s36, v11
    v_mfma_f32_16x16x32_bf16 v[52:55], a[160:163], v[80:83], v[52:55]
    v_permlane16_swap_b32 v74, v72
    s_waitcnt lgkmcnt(2)
    v_mfma_f32_16x16x32_bf16 v[32:35], a[36:39], v[84:87], v[32:35]
    ds_read_b128 v[76:79], v66 offset:33984
    v_permlane16_swap_b32_e64 v75, v73
    v_mfma_f32_16x16x32_bf16 v[36:39], a[100:103], v[84:87], v[36:39]
    v_add_f32 v72, v72, v74
    v_add_f32 v73, v73, v75
    v_mfma_f32_16x16x32_bf16 v[40:43], a[164:167], v[84:87], v[40:43]
    ds_read_b128 v[80:83], v66 offset:50880
    v_mfma_f32_16x16x32_bf16 v[44:47], a[36:39], v[88:91], v[44:47]
    v_mul_f32_e64 v72, s62, v72
    v_mfma_f32_16x16x32_bf16 v[48:51], a[100:103], v[88:91], v[48:51]
    v_mul_f32_e64 v73, s62, v73
    v_mfma_f32_16x16x32_bf16 v[52:55], a[164:167], v[88:91], v[52:55]
    v_fma_f32 v73, -v72, v72, v73
    s_waitcnt lgkmcnt(2)
    v_mfma_f32_16x16x32_bf16 v[32:35], a[40:43], v[56:59], v[32:35]
    ds_read_b128 v[84:87], v67 offset:33792
    v_max_f32 v73, 0, v73
    v_mfma_f32_16x16x32_bf16 v[36:39], a[104:107], v[56:59], v[36:39]
    v_mfma_f32_16x16x32_bf16 v[40:43], a[168:171], v[56:59], v[40:43]
    ds_read_b128 v[88:91], v67 offset:50688
    v_add_f32 v73, 0x3727c5ac, v73
    v_mfma_f32_16x16x32_bf16 v[44:47], a[40:43], v[60:63], v[44:47]
    v_rsq_f32_e64 v74, v73
    v_mfma_f32_16x16x32_bf16 v[48:51], a[104:107], v[60:63], v[48:51]
    v_mul_f32_e64 v72, -1.0, v72
    v_mfma_f32_16x16x32_bf16 v[52:55], a[168:171], v[60:63], v[52:55]
    v_mul_f32 v75, v72, v74
    s_waitcnt lgkmcnt(2)
    v_mfma_f32_16x16x32_bf16 v[32:35], a[44:47], v[76:79], v[32:35]
    ds_read_b128 v[56:59], v67 offset:33856
    v_mfma_f32_16x16x32_bf16 v[36:39], a[108:111], v[76:79], v[36:39]
    s_waitcnt vmcnt(2)
    v_add_f32 v92, v92, v94
    v_mfma_f32_16x16x32_bf16 v[40:43], a[172:175], v[76:79], v[40:43]
    ds_read_b128 v[60:63], v67 offset:50752
    v_add_f32_e64 v93, v93, v95
    v_mfma_f32_16x16x32_bf16 v[44:47], a[44:47], v[80:83], v[44:47]
    v_mov_b32_e64 v94, v92
    v_mfma_f32_16x16x32_bf16 v[48:51], a[108:111], v[80:83], v[48:51]
    v_mov_b32_e64 v95, v93
    v_mfma_f32_16x16x32_bf16 v[52:55], a[172:175], v[80:83], v[52:55]
    v_permlane32_swap_b32 v94, v92
    s_waitcnt lgkmcnt(2)
    v_mfma_f32_16x16x32_bf16 v[32:35], a[48:51], v[84:87], v[32:35]
    ds_read_b128 v[76:79], v67 offset:33920
    v_mfma_f32_16x16x32_bf16 v[36:39], a[112:115], v[84:87], v[36:39]
    v_permlane32_swap_b32_e64 v95, v93
    v_mfma_f32_16x16x32_bf16 v[40:43], a[176:179], v[84:87], v[40:43]
    ds_read_b128 v[80:83], v67 offset:50816
    s_waitcnt vmcnt(0)
    v_cmp_eq_u32 vcc, -1, v22
    s_nop 0
    s_and_b64 vcc, exec, vcc
    s_cbranch_vccz K1_PDONE51
    s_mov_b32 s63, 524288
K1_POLL50:
    buffer_load_dword v22, v20, s[4:7], s37 offen offset:0 sc1
    s_waitcnt vmcnt(0)
    v_cmp_eq_u32 vcc, -1, v22
    s_nop 0
    s_and_b64 vcc, exec, vcc
    s_cbranch_vccz K1_PDONE51
    s_sub_u32 s63, s63, 1
    s_cmp_lg_u32 s63, 0
    s_cbranch_scc1 K1_POLL50
K1_PDONE51:
    v_mfma_f32_16x16x32_bf16 v[44:47], a[48:51], v[88:91], v[44:47]
    buffer_load_dwordx4 v[96:99], v21, s[4:7], s64 offen sc1
    v_add_f32 v92, v92, v94
    v_mfma_f32_16x16x32_bf16 v[48:51], a[112:115], v[88:91], v[48:51]
    v_add_f32 v93, v93, v95
    v_mov_b32 v94, v92
    v_mfma_f32_16x16x32_bf16 v[52:55], a[176:179], v[88:91], v[52:55]
    s_waitcnt lgkmcnt(2)
    v_mfma_f32_16x16x32_bf16 v[32:35], a[52:55], v[56:59], v[32:35]
    ds_read_b128 v[84:87], v67 offset:33984
    v_mov_b32 v95, v93
    v_mfma_f32_16x16x32_bf16 v[36:39], a[116:119], v[56:59], v[36:39]
    buffer_load_dwordx4 v[100:103], v21, s[4:7], s65 offen sc1
    v_permlane16_swap_b32_e64 v94, v92
    v_mfma_f32_16x16x32_bf16 v[40:43], a[180:183], v[56:59], v[40:43]
    ds_read_b128 v[88:91], v67 offset:50880
    v_permlane16_swap_b32_e64 v95, v93
    v_mfma_f32_16x16x32_bf16 v[44:47], a[52:55], v[60:63], v[44:47]
    v_add_f32_e64 v92, v92, v94
    v_mfma_f32_16x16x32_bf16 v[48:51], a[116:119], v[60:63], v[48:51]
    v_add_f32_e64 v93, v93, v95
    v_mfma_f32_16x16x32_bf16 v[52:55], a[180:183], v[60:63], v[52:55]
    buffer_load_dwordx4 v[104:107], v21, s[4:7], s66 offen sc1
    s_waitcnt lgkmcnt(2)
    v_mfma_f32_16x16x32_bf16 v[32:35], a[56:59], v[76:79], v[32:35]
    v_mul_f32 v92, s62, v92
    v_mfma_f32_16x16x32_bf16 v[36:39], a[120:123], v[76:79], v[36:39]
    ds_read_b128 v[56:59], v12 offset:0
    v_mul_f32_e64 v93, s62, v93
    v_mfma_f32_16x16x32_bf16 v[40:43], a[184:187], v[76:79], v[40:43]
    v_fma_f32 v93, -v92, v92, v93
    v_mfma_f32_16x16x32_bf16 v[44:47], a[56:59], v[80:83], v[44:47]
    ds_read_b128 v[60:63], v12 offset:16
    buffer_load_dwordx4 v[108:111], v21, s[4:7], s67 offen sc1
    v_mfma_f32_16x16x32_bf16 v[48:51], a[120:123], v[80:83], v[48:51]
    v_max_f32_e64 v93, 0, v93
    v_mfma_f32_16x16x32_bf16 v[52:55], a[184:187], v[80:83], v[52:55]
    v_add_f32 v93, 0x3727c5ac, v93
    s_waitcnt lgkmcnt(2)
    v_mfma_f32_16x16x32_bf16 v[32:35], a[60:63], v[84:87], v[32:35]
    v_rsq_f32 v72, v93
    v_mfma_f32_16x16x32_bf16 v[36:39], a[124:127], v[84:87], v[36:39]
    buffer_load_dwordx4 v[112:115], v21, s[4:7], s68 offen sc1
    v_mul_f32_e64 v92, -1.0, v92
    v_mfma_f32_16x16x32_bf16 v[40:43], a[188:191], v[84:87], v[40:43]
    v_mul_f32_e64 v73, v92, v72
    v_mfma_f32_16x16x32_bf16 v[44:47], a[60:63], v[88:91], v[44:47]
    v_mfma_f32_16x16x32_bf16 v[48:51], a[124:127], v[88:91], v[48:51]
    v_mfma_f32_16x16x32_bf16 v[52:55], a[188:191], v[88:91], v[52:55]
    s_add_u32 s35, s40, 11264
    s_cmp_eq_u32 s16, 3
    s_cselect_b32 s39, s90, s35
    s_waitcnt lgkmcnt(0)
    v_pk_fma_f32 v[76:77], v[72:73], v[60:61], v[56:57] op_sel:[1,0,0] op_sel_hi:[1,1,1]
    buffer_load_dwordx4 v[116:119], v21, s[4:7], s69 offen sc1
    v_pk_fma_f32 v[78:79], v[72:73], v[62:63], v[58:59] op_sel:[1,0,0] op_sel_hi:[1,1,1]
    v_pk_fma_f32 v[80:81], v[74:75], v[60:61], v[56:57] op_sel:[1,0,0] op_sel_hi:[1,1,1]
    v_pk_fma_f32 v[82:83], v[74:75], v[62:63], v[58:59] op_sel:[1,0,0] op_sel_hi:[1,1,1]
    ds_read_b128 v[56:59], v12 offset:128
    ds_read_b128 v[60:63], v12 offset:144
    v_pk_fma_f32 v[76:77], v[72:73], v[32:33], v[76:77] op_sel_hi:[0,1,1]
    v_pk_fma_f32 v[78:79], v[72:73], v[34:35], v[78:79] op_sel_hi:[0,1,1]
    v_pk_fma_f32 v[80:81], v[74:75], v[44:45], v[80:81] op_sel_hi:[0,1,1]
    v_pk_fma_f32 v[82:83], v[74:75], v[46:47], v[82:83] op_sel_hi:[0,1,1]
    v_pk_mul_f32 v[84:85], v[76:77], v[76:77]
    v_pk_mul_f32 v[86:87], v[78:79], v[78:79]
    v_pk_mul_f32 v[88:89], v[80:81], v[80:81]
    v_pk_mul_f32 v[90:91], v[82:83], v[82:83]
    v_pk_fma_f32 v[84:85], v[84:85], s[58:59], v[0:1] op_sel_hi:[1,1,0]
    v_pk_fma_f32 v[86:87], v[86:87], s[58:59], v[0:1] op_sel_hi:[1,1,0]
    v_pk_fma_f32 v[88:89], v[88:89], s[58:59], v[0:1] op_sel_hi:[1,1,0]
    v_pk_fma_f32 v[90:91], v[90:91], s[58:59], v[0:1] op_sel_hi:[1,1,0]
    v_pk_mul_f32 v[84:85], v[76:77], v[84:85]
    v_pk_mul_f32 v[86:87], v[78:79], v[86:87]
    v_pk_mul_f32 v[88:89], v[80:81], v[88:89]
    v_pk_mul_f32 v[90:91], v[82:83], v[90:91]
    v_exp_f32 v84, v84
    buffer_load_dwordx4 v[120:123], v21, s[4:7], s70 offen sc1
    v_exp_f32 v85, v85
    v_exp_f32 v86, v86
    v_exp_f32 v87, v87
    v_exp_f32 v88, v88
    v_exp_f32 v89, v89
    v_exp_f32 v90, v90
    v_exp_f32_e64 v91, v91
    v_pk_add_f32 v[84:85], v[84:85], 1.0 op_sel_hi:[1,0]
    v_pk_add_f32 v[86:87], v[86:87], 1.0 op_sel_hi:[1,0]
    v_pk_add_f32 v[88:89], v[88:89], 1.0 op_sel_hi:[1,0]
    v_pk_add_f32 v[90:91], v[90:91], 1.0 op_sel_hi:[1,0]
    v_rcp_f32 v84, v84
    v_rcp_f32 v85, v85
    v_rcp_f32 v86, v86
    v_rcp_f32 v87, v87
    v_rcp_f32 v88, v88
    v_rcp_f32 v89, v89
    v_rcp_f32 v90, v90
    v_rcp_f32 v91, v91
    v_pk_mul_f32 v[76:77], v[76:77], v[84:85]
    v_pk_mul_f32 v[78:79], v[78:79], v[86:87]
    v_pk_mul_f32 v[80:81], v[80:81], v[88:89]
    buffer_load_dwordx4 v[124:127], v21, s[4:7], s71 offen sc1
    v_pk_mul_f32 v[82:83], v[82:83], v[90:91]
    v_cvt_pk_bf16_f32 v84, v76, v77
    v_cvt_pk_bf16_f32 v85, v78, v79
    v_cvt_pk_bf16_f32 v86, v80, v81
    v_cvt_pk_bf16_f32 v87, v82, v83
    s_nop 0
    v_permlane32_swap_b32 v84, v86
    v_permlane32_swap_b32_e64 v85, v87
    buffer_store_dwordx4 v[84:87], v2, s[4:7], s35 offen offset:0 sc1
    s_waitcnt lgkmcnt(0)
    v_pk_fma_f32 v[76:77], v[72:73], v[60:61], v[56:57] op_sel:[1,0,0] op_sel_hi:[1,1,1]
    v_pk_fma_f32 v[78:79], v[72:73], v[62:63], v[58:59] op_sel:[1,0,0] op_sel_hi:[1,1,1]
    v_pk_fma_f32 v[80:81], v[74:75], v[60:61], v[56:57] op_sel:[1,0,0] op_sel_hi:[1,1,1]
    v_pk_fma_f32 v[82:83], v[74:75], v[62:63], v[58:59] op_sel:[1,0,0] op_sel_hi:[1,1,1]
    ds_read_b128 v[56:59], v12 offset:256
    ds_read_b128 v[60:63], v12 offset:272
    v_pk_fma_f32 v[76:77], v[72:73], v[36:37], v[76:77] op_sel_hi:[0,1,1]
    v_pk_fma_f32 v[78:79], v[72:73], v[38:39], v[78:79] op_sel_hi:[0,1,1]
    v_pk_fma_f32 v[80:81], v[74:75], v[48:49], v[80:81] op_sel_hi:[0,1,1]
    v_pk_fma_f32 v[82:83], v[74:75], v[50:51], v[82:83] op_sel_hi:[0,1,1]
    v_pk_mul_f32 v[84:85], v[76:77], v[76:77]
    v_pk_mul_f32 v[86:87], v[78:79], v[78:79]
    v_pk_mul_f32 v[88:89], v[80:81], v[80:81]
    v_pk_mul_f32 v[90:91], v[82:83], v[82:83]
    buffer_load_dwordx4 v[128:131], v21, s[4:7], s72 offen sc1
    v_pk_fma_f32 v[84:85], v[84:85], s[58:59], v[0:1] op_sel_hi:[1,1,0]
    v_pk_fma_f32 v[86:87], v[86:87], s[58:59], v[0:1] op_sel_hi:[1,1,0]
    v_pk_fma_f32 v[88:89], v[88:89], s[58:59], v[0:1] op_sel_hi:[1,1,0]
    v_pk_fma_f32 v[90:91], v[90:91], s[58:59], v[0:1] op_sel_hi:[1,1,0]
    v_pk_mul_f32 v[84:85], v[76:77], v[84:85]
    v_pk_mul_f32 v[86:87], v[78:79], v[86:87]
    v_pk_mul_f32 v[88:89], v[80:81], v[88:89]
    v_pk_mul_f32 v[90:91], v[82:83], v[90:91]
    v_exp_f32 v84, v84
    v_exp_f32 v85, v85
    v_exp_f32 v86, v86
    v_exp_f32 v87, v87
    v_exp_f32 v88, v88
    v_exp_f32 v89, v89
    v_exp_f32 v90, v90
    v_exp_f32_e64 v91, v91
    v_pk_add_f32 v[84:85], v[84:85], 1.0 op_sel_hi:[1,0]
    v_pk_add_f32 v[86:87], v[86:87], 1.0 op_sel_hi:[1,0]
    v_pk_add_f32 v[88:89], v[88:89], 1.0 op_sel_hi:[1,0]
    v_pk_add_f32 v[90:91], v[90:91], 1.0 op_sel_hi:[1,0]
    v_rcp_f32 v84, v84
    v_rcp_f32 v85, v85
    buffer_load_dwordx4 v[132:135], v21, s[4:7], s73 offen sc1
    v_rcp_f32 v86, v86
    v_rcp_f32 v87, v87
    v_rcp_f32 v88, v88
    v_rcp_f32 v89, v89
    v_rcp_f32 v90, v90
    v_rcp_f32 v91, v91
    v_pk_mul_f32 v[76:77], v[76:77], v[84:85]
    v_pk_mul_f32 v[78:79], v[78:79], v[86:87]
    v_pk_mul_f32 v[80:81], v[80:81], v[88:89]
    v_pk_mul_f32 v[82:83], v[82:83], v[90:91]
    v_cvt_pk_bf16_f32 v84, v76, v77
    v_cvt_pk_bf16_f32 v85, v78, v79
    v_cvt_pk_bf16_f32 v86, v80, v81
    v_cvt_pk_bf16_f32 v87, v82, v83
    s_nop 0
    v_permlane32_swap_b32 v84, v86
    v_permlane32_swap_b32_e64 v85, v87
    buffer_store_dwordx4 v[84:87], v2, s[4:7], s35 offen offset:1024 sc1
    s_waitcnt lgkmcnt(0)
    v_pk_fma_f32 v[76:77], v[72:73], v[60:61], v[56:57] op_sel:[1,0,0] op_sel_hi:[1,1,1]
    v_pk_fma_f32 v[78:79], v[72:73], v[62:63], v[58:59] op_sel:[1,0,0] op_sel_hi:[1,1,1]
    v_pk_fma_f32 v[80:81], v[74:75], v[60:61], v[56:57] op_sel:[1,0,0] op_sel_hi:[1,1,1]
    v_pk_fma_f32 v[82:83], v[74:75], v[62:63], v[58:59] op_sel:[1,0,0] op_sel_hi:[1,1,1]
    v_pk_fma_f32 v[76:77], v[72:73], v[40:41], v[76:77] op_sel_hi:[0,1,1]
    buffer_load_dwordx4 v[136:139], v21, s[4:7], s74 offen sc1
    v_pk_fma_f32 v[78:79], v[72:73], v[42:43], v[78:79] op_sel_hi:[0,1,1]
    v_pk_fma_f32 v[80:81], v[74:75], v[52:53], v[80:81] op_sel_hi:[0,1,1]
    v_pk_fma_f32 v[82:83], v[74:75], v[54:55], v[82:83] op_sel_hi:[0,1,1]
    v_pk_mul_f32 v[84:85], v[76:77], v[76:77]
    v_pk_mul_f32 v[86:87], v[78:79], v[78:79]
    v_pk_mul_f32 v[88:89], v[80:81], v[80:81]
    v_pk_mul_f32 v[90:91], v[82:83], v[82:83]
    v_pk_fma_f32 v[84:85], v[84:85], s[58:59], v[0:1] op_sel_hi:[1,1,0]
    v_pk_fma_f32 v[86:87], v[86:87], s[58:59], v[0:1] op_sel_hi:[1,1,0]
    v_pk_fma_f32 v[88:89], v[88:89], s[58:59], v[0:1] op_sel_hi:[1,1,0]
    v_pk_fma_f32 v[90:91], v[90:91], s[58:59], v[0:1] op_sel_hi:[1,1,0]
    v_pk_mul_f32 v[84:85], v[76:77], v[84:85]
    v_pk_mul_f32 v[86:87], v[78:79], v[86:87]
    v_pk_mul_f32 v[88:89], v[80:81], v[88:89]
    v_pk_mul_f32 v[90:91], v[82:83], v[90:91]
    v_exp_f32 v84, v84
    v_exp_f32 v85, v85
    v_exp_f32 v86, v86
    v_exp_f32 v87, v87
    v_exp_f32 v88, v88
    v_exp_f32 v89, v89
    v_exp_f32 v90, v90
    buffer_load_dwordx4 v[140:143], v21, s[4:7], s75 offen sc1
    v_exp_f32_e64 v91, v91
    v_pk_add_f32 v[84:85], v[84:85], 1.0 op_sel_hi:[1,0]
    v_pk_add_f32 v[86:87], v[86:87], 1.0 op_sel_hi:[1,0]
    v_pk_add_f32 v[88:89], v[88:89], 1.0 op_sel_hi:[1,0]
    v_pk_add_f32 v[90:91], v[90:91], 1.0 op_sel_hi:[1,0]
    v_rcp_f32 v84, v84
    v_rcp_f32 v85, v85
    v_rcp_f32 v86, v86
    v_rcp_f32 v87, v87
    v_rcp_f32 v88, v88
    v_rcp_f32 v89, v89
    v_rcp_f32 v90, v90
    v_rcp_f32 v91, v91
    v_pk_mul_f32 v[76:77], v[76:77], v[84:85]
    v_pk_mul_f32 v[78:79], v[78:79], v[86:87]
    v_pk_mul_f32 v[80:81], v[80:81], v[88:89]
    v_pk_mul_f32 v[82:83], v[82:83], v[90:91]
    v_cvt_pk_bf16_f32 v84, v76, v77
    v_cvt_pk_bf16_f32 v85, v78, v79
    v_cvt_pk_bf16_f32 v86, v80, v81
    v_cvt_pk_bf16_f32 v87, v82, v83
    s_nop 0
    v_permlane32_swap_b32 v84, v86
    v_permlane32_swap_b32_e64 v85, v87
    buffer_store_dwordx4 v[84:87], v2, s[4:7], s39 offen offset:2048 sc1
    s_waitcnt vmcnt(14)
    v_mfma_f32_32x32x16_bf16 v[32:47], a[192:195], v[96:99], 0
    v_mfma_f32_32x32x16_bf16 v[48:63], a[196:199], v[96:99], 0
    buffer_load_dwordx4 v[96:99], v21, s[4:7], s76 offen sc1
    s_waitcnt vmcnt(14)
    v_mfma_f32_32x32x16_bf16 v[32:47], a[200:203], v[100:103], v[32:47]
    ds_read_b64_tr_b16 v[224:225], v17 offset:11264
    v_mfma_f32_32x32x16_bf16 v[48:63], a[204:207], v[100:103], v[48:63]
    buffer_load_dwordx4 v[100:103], v21, s[4:7], s77 offen sc1
    ds_read_b64_tr_b16 v[226:227], v17 offset:12288
    s_waitcnt vmcnt(14)
    v_mfma_f32_32x32x16_bf16 v[32:47], a[208:211], v[104:107], v[32:47]
    ds_read_b64_tr_b16 v[228:229], v17 offset:11328
    v_mfma_f32_32x32x16_bf16 v[48:63], a[212:215], v[104:107], v[48:63]
    buffer_load_dwordx4 v[104:107], v21, s[4:7], s78 offen sc1
    ds_read_b64_tr_b16 v[230:231], v17 offset:12352
    s_waitcnt vmcnt(14)
    v_mfma_f32_32x32x16_bf16 v[32:47], a[216:219], v[108:111], v[32:47]
    v_mfma_f32_32x32x16_bf16 v[48:63], a[220:223], v[108:111], v[48:63]
    buffer_load_dwordx4 v[108:111], v21, s[4:7], s79 offen sc1
    s_waitcnt vmcnt(14)
    v_mfma_f32_32x32x16_bf16 v[32:47], a[224:227], v[112:115], v[32:47]
    ds_read_b64_tr_b16 v[232:233], v17 offset:13312
    v_mfma_f32_32x32x16_bf16 v[48:63], a[228:231], v[112:115], v[48:63]
    buffer_load_dwordx4 v[112:115], v21, s[4:7], s80 offen sc1
    ds_read_b64_tr_b16 v[234:235], v17 offset:14336
    s_waitcnt vmcnt(14)
    v_mfma_f32_32x32x16_bf16 v[32:47], a[232:235], v[116:119], v[32:47]
    ds_read_b64_tr_b16 v[236:237], v17 offset:13376
    v_mfma_f32_32x32x16_bf16 v[48:63], a[236:239], v[116:119], v[48:63]
    buffer_load_dwordx4 v[116:119], v21, s[4:7], s81 offen sc1
    s_waitcnt vmcnt(14)
    v_mfma_f32_32x32x16_bf16 v[32:47], a[240:243], v[120:123], v[32:47]
    ds_read_b64_tr_b16 v[238:239], v17 offset:14400
    v_mfma_f32_32x32x16_bf16 v[48:63], a[244:247], v[120:123], v[48:63]
    buffer_load_dwordx4 v[120:123], v21, s[4:7], s82 offen sc1
    s_waitcnt vmcnt(14)
    v_mfma_f32_32x32x16_bf16 v[32:47], a[248:251], v[124:127], v[32:47]
    ds_read_b64_tr_b16 v[240:241], v17 offset:0
    v_mfma_f32_32x32x16_bf16 v[48:63], a[252:255], v[124:127], v[48:63]
    buffer_load_dwordx4 v[124:127], v21, s[4:7], s83 offen sc1
    ds_read_b64_tr_b16 v[242:243], v17 offset:1024
    s_waitcnt vmcnt(13)
    v_mfma_f32_32x32x16_bf16 v[32:47], v[144:147], v[128:131], v[32:47]
    v_mfma_f32_32x32x16_bf16 v[48:63], v[148:151], v[128:131], v[48:63]
    buffer_load_dwordx4 v[128:131], v21, s[4:7], s84 offen sc1
    ds_read_b64_tr_b16 v[244:245], v17 offset:64
    s_waitcnt vmcnt(13)
    v_mfma_f32_32x32x16_bf16 v[32:47], v[152:155], v[132:135], v[32:47]
    s_waitcnt vmcnt(9)
    s_add_u32 s36, s41, 16384
    s_mov_b64 exec, 1
    buffer_store_dword v8, v8, s[4:7], s36 offen offset:0 sc1
    s_mov_b64 exec, -1
    v_mfma_f32_32x32x16_bf16 v[48:63], v[156:159], v[132:135], v[48:63]
    buffer_load_dwordx4 v[132:135], v21, s[4:7], s85 offen sc1
    ds_read_b64_tr_b16 v[246:247], v17 offset:1088
    v_mfma_f32_32x32x16_bf16 v[32:47], v[160:163], v[136:139], v[32:47]
    ds_read_b64_tr_b16 v[248:249], v17 offset:3072
    v_mfma_f32_32x32x16_bf16 v[48:63], v[164:167], v[136:139], v[48:63]
    v_mfma_f32_32x32x16_bf16 v[32:47], v[168:171], v[140:143], v[32:47]
    ds_read_b64_tr_b16 v[250:251], v17 offset:4096
    v_mfma_f32_32x32x16_bf16 v[48:63], v[172:175], v[140:143], v[48:63]
    ds_read_b64_tr_b16 v[252:253], v17 offset:3136
    s_waitcnt vmcnt(10)
    v_mfma_f32_32x32x16_bf16 v[32:47], v[176:179], v[96:99], v[32:47]
    ds_read_b64_tr_b16 v[254:255], v17 offset:4160
    v_mfma_f32_32x32x16_bf16 v[48:63], v[180:183], v[96:99], v[48:63]
    s_waitcnt lgkmcnt(0)
    s_barrier
    s_waitcnt vmcnt(9)
    v_mfma_f32_32x32x16_bf16 v[32:47], v[184:187], v[100:103], v[32:47]
    v_mfma_f32_32x32x16_bf16 v[48:63], v[188:191], v[100:103], v[48:63]
    s_waitcnt vmcnt(8)
    v_mfma_f32_32x32x16_bf16 v[32:47], v[192:195], v[104:107], v[32:47]
    s_add_u32 s37, s42, 16384
    buffer_load_dword v22, v20, s[4:7], s37 offen offset:0 sc1
    s_add_u32 s36, s49, 11264
    v_add_u32 v21, s36, v11
    s_waitcnt vmcnt(8)
    v_mfma_f32_32x32x16_bf16 v[32:47], v[200:203], v[108:111], v[32:47]
    v_mfma_f32_32x32x16_bf16 v[48:63], v[196:199], v[104:107], v[48:63]
    s_waitcnt vmcnt(7)
    v_mfma_f32_32x32x16_bf16 v[32:47], v[208:211], v[112:115], v[32:47]
    s_waitcnt vmcnt(6)
    v_mfma_f32_32x32x16_bf16 v[32:47], v[216:219], v[116:119], v[32:47]
    v_mfma_f32_32x32x16_bf16 v[48:63], v[204:207], v[108:111], v[48:63]
    s_waitcnt vmcnt(5)
    v_mfma_f32_32x32x16_bf16 v[32:47], v[224:227], v[120:123], v[32:47]
    s_waitcnt vmcnt(4)
    v_mfma_f32_32x32x16_bf16 v[32:47], v[232:235], v[124:127], v[32:47]
    v_mfma_f32_32x32x16_bf16 v[48:63], v[212:215], v[112:115], v[48:63]
    s_waitcnt vmcnt(3)
    v_mfma_f32_32x32x16_bf16 v[32:47], v[240:243], v[128:131], v[32:47]
    s_waitcnt vmcnt(1)
    v_mfma_f32_32x32x16_bf16 v[32:47], v[248:251], v[132:135], v[32:47]
    v_mfma_f32_32x32x16_bf16 v[48:63], v[220:223], v[116:119], v[48:63]
    s_waitcnt vmcnt(0)
    v_cmp_eq_u32 vcc, -1, v22
    s_nop 0
    s_and_b64 vcc, exec, vcc
    s_cbranch_vccz K1_PDONE53
    s_mov_b32 s63, 524288
K1_POLL52:
    buffer_load_dword v22, v20, s[4:7], s37 offen offset:0 sc1
    s_waitcnt vmcnt(0)
    v_cmp_eq_u32 vcc, -1, v22
    s_nop 0
    s_and_b64 vcc, exec, vcc
    s_cbranch_vccz K1_PDONE53
    s_sub_u32 s63, s63, 1
    s_cmp_lg_u32 s63, 0
    s_cbranch_scc1 K1_POLL52
K1_PDONE53:
    v_mfma_f32_32x32x16_bf16 v[48:63], v[228:231], v[120:123], v[48:63]
    buffer_load_dwordx4 v[136:139], v21, s[4:7], s64 offen sc1
    buffer_load_dwordx4 v[140:143], v21, s[4:7], s65 offen sc1
    v_mfma_f32_32x32x16_bf16 v[48:63], v[236:239], v[124:127], v[48:63]
    s_nop 1
    ds_write_b128 v3, v[32:35] offset:0
    buffer_load_dwordx4 v[96:99], v21, s[4:7], s66 offen sc1
    v_mfma_f32_32x32x16_bf16 v[48:63], v[244:247], v[128:131], v[48:63]
    ds_write_b128 v3, v[36:39] offset:16
    ds_write_b128 v3, v[40:43] offset:32
    buffer_load_dwordx4 v[100:103], v21, s[4:7], s67 offen sc1
    v_mfma_f32_32x32x16_bf16 v[48:63], v[252:255], v[132:135], v[48:63]
    ds_write_b128 v3, v[44:47] offset:48
    buffer_load_dwordx4 v[104:107], v21, s[4:7], s68 offen sc1
    s_nop 9
    ds_write_b128 v3, v[48:51] offset:128
    buffer_load_dwordx4 v[108:111], v21, s[4:7], s69 offen sc1
    ds_write_b128 v3, v[52:55] offset:144
    buffer_load_dwordx4 v[112:115], v21, s[4:7], s70 offen sc1
    ds_write_b128 v3, v[56:59] offset:160
    buffer_load_dwordx4 v[116:119], v21, s[4:7], s71 offen sc1
    ds_write_b128 v3, v[60:63] offset:176
    buffer_load_dwordx4 v[120:123], v21, s[4:7], s72 offen sc1
    s_waitcnt lgkmcnt(0)
    s_barrier
    s_add_u32 s44, s44, 131072
    ds_read_b128 v[32:35], v4 offset:0
    ds_read_b128 v[36:39], v4 offset:16
    ds_read_b128 v[40:43], v4 offset:8704
    ds_read_b128 v[44:47], v4 offset:8720
    ds_read_b128 v[48:51], v4 offset:17408
    ds_read_b128 v[52:55], v4 offset:17424
    ds_read_b128 v[56:59], v4 offset:26112
    ds_read_b128 v[60:63], v4 offset:26128
    ds_read_b128 v[76:79], v13 offset:0
    ds_read_b128 v[80:83], v13 offset:16
    v_lshlrev_b32 v64, 16, v24
    buffer_load_dwordx4 v[124:127], v21, s[4:7], s73 offen sc1
    v_and_b32 v65, s56, v24
    v_lshlrev_b32 v66, 16, v25
    v_and_b32 v67, s56, v25
    v_lshlrev_b32 v68, 16, v26
    v_and_b32 v69, s56, v26
    v_lshlrev_b32 v70, 16, v27
    v_and_b32 v71, s56, v27
    s_waitcnt lgkmcnt(7)
    v_pk_add_f32 v[32:33], v[32:33], v[40:41]
    v_pk_add_f32 v[34:35], v[34:35], v[42:43]
    s_waitcnt lgkmcnt(6)
    v_pk_add_f32 v[36:37], v[36:37], v[44:45]
    buffer_load_dwordx4 v[128:131], v21, s[4:7], s74 offen sc1
    v_pk_add_f32 v[38:39], v[38:39], v[46:47]
    s_waitcnt lgkmcnt(3)
    v_pk_add_f32 v[48:49], v[48:49], v[56:57]
    v_pk_add_f32 v[50:51], v[50:51], v[58:59]
    s_waitcnt lgkmcnt(2)
    v_pk_add_f32 v[52:53], v[52:53], v[60:61]
    v_pk_add_f32 v[54:55], v[54:55], v[62:63]
    v_pk_add_f32 v[64:65], v[64:65], v[32:33]
    v_pk_add_f32 v[66:67], v[66:67], v[34:35]
    v_pk_add_f32 v[68:69], v[68:69], v[36:37]
    v_pk_add_f32 v[70:71], v[70:71], v[38:39]
    v_pk_add_f32 v[64:65], v[64:65], v[48:49]
    buffer_load_dwordx4 v[132:135], v21, s[4:7], s75 offen sc1
    v_pk_add_f32 v[66:67], v[66:67], v[50:51]
    v_pk_add_f32 v[68:69], v[68:69], v[52:53]
    v_pk_add_f32 v[70:71], v[70:71], v[54:55]
    s_waitcnt lgkmcnt(1)
    v_pk_add_f32 v[64:65], v[64:65], v[76:77]
    v_pk_add_f32 v[66:67], v[66:67], v[78:79]
    s_waitcnt lgkmcnt(0)
    v_pk_add_f32 v[68:69], v[68:69], v[80:81]
    v_pk_add_f32 v[70:71], v[70:71], v[82:83]
    v_cvt_pk_bf16_f32 v24, v64, v65
    v_cvt_pk_bf16_f32 v25, v66, v67
    v_cvt_pk_bf16_f32 v26, v68, v69
    v_cvt_pk_bf16_f32 v27, v70, v71
    v_dot2_f32_bf16 v72, v24, s57, 0
    v_dot2_f32_bf16 v73, v24, v24, 0
    v_dot2_f32_bf16 v72, v25, s57, v72
    v_dot2_f32_bf16 v73, v25, v25, v73
    v_dot2_f32_bf16 v72, v26, s57, v72
    v_dot2_f32_bf16 v73, v26, v26, v73
    v_dot2_f32_bf16 v72, v27, s57, v72
    v_dot2_f32_bf16 v73, v27, v27, v73
    s_nop 1
    v_add_f32_dpp v72, v72, v72 quad_perm:[1,0,3,2] row_mask:0xf bank_mask:0xf
    v_add_f32_dpp v73, v73, v73 quad_perm:[1,0,3,2] row_mask:0xf bank_mask:0xf
    s_nop 0
    v_add_f32_dpp v72, v72, v72 quad_perm:[2,3,0,1] row_mask:0xf bank_mask:0xf
    v_add_f32_dpp v73, v73, v73 quad_perm:[2,3,0,1] row_mask:0xf bank_mask:0xf
    s_nop 0
    v_add_f32_dpp v72, v72, v72 row_half_mirror row_mask:0xf bank_mask:0xf
    v_add_f32_dpp v73, v73, v73 row_half_mirror row_mask:0xf bank_mask:0xf
    s_mov_b32 exec_lo, 0x01010101
    s_mov_b32 exec_hi, 0x01010101
    buffer_store_dwordx2 v[72:73], v5, s[4:7], s44 offen offset:0 sc1
    s_mov_b64 exec, -1
    v_lshlrev_b32 v64, 16, v24
    v_and_b32 v65, s56, v24
    v_lshlrev_b32 v66, 16, v25
    v_and_b32 v67, s56, v25
    v_lshlrev_b32 v68, 16, v26
    v_and_b32 v69, s56, v26
    v_lshlrev_b32 v70, 16, v27
    v_and_b32 v71, s56, v27
    s_waitcnt vmcnt(12)
    v_mfma_f32_32x32x16_bf16 v[32:47], a[192:195], v[136:139], 0
    ds_read_u16 v76, v23 offset:0
    ds_read_u16 v77, v23 offset:128
    ds_read_u16 v78, v23 offset:256
    ds_read_u16 v79, v23 offset:384
    ds_read_u16 v80, v23 offset:512
    v_mfma_f32_32x32x16_bf16 v[48:63], a[196:199], v[136:139], 0
    buffer_load_dwordx4 v[136:139], v21, s[4:7], s76 offen sc1
    ds_read_u16 v81, v23 offset:640
    ds_read_u16 v82, v23 offset:768
    ds_read_u16 v83, v23 offset:896
    s_waitcnt lgkmcnt(7)
    v_lshlrev_b32_e64 v76, 16, v76
    s_waitcnt vmcnt(12)
    v_mfma_f32_32x32x16_bf16 v[32:47], a[200:203], v[140:143], v[32:47]
    s_waitcnt lgkmcnt(6)
    v_lshlrev_b32 v77, 16, v77
    s_waitcnt lgkmcnt(5)
    v_lshlrev_b32 v78, 16, v78
    s_waitcnt lgkmcnt(4)
    v_lshlrev_b32 v79, 16, v79
    s_waitcnt lgkmcnt(3)
    v_lshlrev_b32 v80, 16, v80
    s_waitcnt lgkmcnt(2)
    v_lshlrev_b32 v81, 16, v81
    v_mfma_f32_32x32x16_bf16 v[48:63], a[204:207], v[140:143], v[48:63]
    buffer_load_dwordx4 v[140:143], v21, s[4:7], s77 offen sc1
    s_waitcnt lgkmcnt(1)
    v_lshlrev_b32 v82, 16, v82
    s_waitcnt lgkmcnt(0)
    v_lshlrev_b32_e64 v83, 16, v83
    s_waitcnt vmcnt(12)
    v_mfma_f32_32x32x16_bf16 v[32:47], a[208:211], v[96:99], v[32:47]
    v_mfma_f32_32x32x16_bf16 v[48:63], a[212:215], v[96:99], v[48:63]
    buffer_load_dwordx4 v[96:99], v21, s[4:7], s78 offen sc1
    s_waitcnt vmcnt(12)
    v_mfma_f32_32x32x16_bf16 v[32:47], a[216:219], v[100:103], v[32:47]
    v_mfma_f32_32x32x16_bf16 v[48:63], a[220:223], v[100:103], v[48:63]
    buffer_load_dwordx4 v[100:103], v21, s[4:7], s79 offen sc1
    s_waitcnt vmcnt(12)
    v_mfma_f32_32x32x16_bf16 v[32:47], a[224:227], v[104:107], v[32:47]
    v_mfma_f32_32x32x16_bf16 v[48:63], a[228:231], v[104:107], v[48:63]
    buffer_load_dwordx4 v[104:107], v21, s[4:7], s80 offen sc1
    s_waitcnt vmcnt(12)
    v_mfma_f32_32x32x16_bf16 v[32:47], a[232:235], v[108:111], v[32:47]
    buffer_load_dwordx2 v[72:73], v6, s[4:7], s44 offen offset:0 sc1
    v_mfma_f32_32x32x16_bf16 v[48:63], a[236:239], v[108:111], v[48:63]
    buffer_load_dwordx4 v[108:111], v21, s[4:7], s81 offen sc1
    s_waitcnt vmcnt(13)
    v_mfma_f32_32x32x16_bf16 v[32:47], a[240:243], v[112:115], v[32:47]
    v_mfma_f32_32x32x16_bf16 v[48:63], a[244:247], v[112:115], v[48:63]
    buffer_load_dwordx4 v[112:115], v21, s[4:7], s82 offen sc1
    s_waitcnt vmcnt(13)
    v_mfma_f32_32x32x16_bf16 v[32:47], a[248:251], v[116:119], v[32:47]
    v_mfma_f32_32x32x16_bf16 v[48:63], a[252:255], v[116:119], v[48:63]
    buffer_load_dwordx4 v[116:119], v21, s[4:7], s83 offen sc1
    s_waitcnt vmcnt(13)
    v_mfma_f32_32x32x16_bf16 v[32:47], v[144:147], v[120:123], v[32:47]
    v_mfma_f32_32x32x16_bf16 v[48:63], v[148:151], v[120:123], v[48:63]
    buffer_load_dwordx4 v[120:123], v21, s[4:7], s84 offen sc1
    s_waitcnt vmcnt(13)
    v_mfma_f32_32x32x16_bf16 v[32:47], v[152:155], v[124:127], v[32:47]
    v_mfma_f32_32x32x16_bf16 v[48:63], v[156:159], v[124:127], v[48:63]
    buffer_load_dwordx4 v[124:127], v21, s[4:7], s85 offen sc1
    s_waitcnt vmcnt(13)
    v_mfma_f32_32x32x16_bf16 v[32:47], v[160:163], v[128:131], v[32:47]
    v_mfma_f32_32x32x16_bf16 v[48:63], v[164:167], v[128:131], v[48:63]
    s_waitcnt vmcnt(12)
    v_mfma_f32_32x32x16_bf16 v[32:47], v[168:171], v[132:135], v[32:47]
    s_waitcnt vmcnt(5)
    v_max_u32_e64 v74, v72, v73
    v_cmp_eq_u32 vcc, -1, v74
    s_nop 0
    s_and_b64 vcc, exec, vcc
    s_cbranch_vccz K1_PDONE55
    s_mov_b32 s63, 524288
K1_POLL54:
    buffer_load_dwordx2 v[72:73], v6, s[4:7], s44 offen offset:0 sc1
    s_waitcnt vmcnt(0)
    v_max_u32_e64 v74, v72, v73
    v_cmp_eq_u32 vcc, -1, v74
    s_nop 0
    s_and_b64 vcc, exec, vcc
    s_cbranch_vccz K1_PDONE55
    s_sub_u32 s63, s63, 1
    s_cmp_lg_u32 s63, 0
    s_cbranch_scc1 K1_POLL54
K1_PDONE55:
    v_mfma_f32_32x32x16_bf16 v[48:63], v[172:175], v[132:135], v[48:63]
    v_add_f32_dpp v72, v72, v72 quad_perm:[1,0,3,2] row_mask:0xf bank_mask:0xf
    v_add_f32_dpp v73, v73, v73 quad_perm:[1,0,3,2] row_mask:0xf bank_mask:0xf
    s_nop 0
    v_add_f32_dpp v72, v72, v72 quad_perm:[2,3,0,1] row_mask:0xf bank_mask:0xf
    v_add_f32_dpp v73, v73, v73 quad_perm:[2,3,0,1] row_mask:0xf bank_mask:0xf
    s_nop 0
    v_add_f32_dpp v72, v72, v72 row_half_mirror row_mask:0xf bank_mask:0xf
    v_mfma_f32_32x32x16_bf16 v[32:47], v[176:179], v[136:139], v[32:47]
    v_add_f32_dpp v73, v73, v73 row_half_mirror row_mask:0xf bank_mask:0xf
    v_mul_f32 v72, s62, v72
    v_mul_f32 v73, s62, v73
    v_fma_f32 v73, -v72, v72, v73
    v_max_f32_e64 v73, 0, v73
    v_mfma_f32_32x32x16_bf16 v[48:63], v[180:183], v[136:139], v[48:63]
    v_add_f32 v73, 0x3727c5ac, v73
    v_rsq_f32 v74, v73
    v_mul_f32 v72, -1.0, v72
    v_mul_f32_e64 v75, v72, v74
    v_mfma_f32_32x32x16_bf16 v[32:47], v[184:187], v[140:143], v[32:47]
    v_fma_f32 v84, v64, v74, v75
    v_fma_f32 v85, v65, v74, v75
    v_fma_f32 v86, v66, v74, v75
    v_fma_f32 v87, v67, v74, v75
    v_fma_f32 v88, v68, v74, v75
    v_mfma_f32_32x32x16_bf16 v[48:63], v[188:191], v[140:143], v[48:63]
    v_fma_f32 v89, v69, v74, v75
    v_fma_f32 v90, v70, v74, v75
    v_fma_f32 v91, v71, v74, v75
    v_fmac_f32 v64, v84, v76
    v_fmac_f32 v65, v85, v77
    v_mfma_f32_32x32x16_bf16 v[32:47], v[192:195], v[96:99], v[32:47]
    v_fmac_f32 v66, v86, v78
    v_fmac_f32 v67, v87, v79
    v_fmac_f32 v68, v88, v80
    v_fmac_f32 v69, v89, v81
    v_fmac_f32_e64 v70, v90, v82
    v_mfma_f32_32x32x16_bf16 v[32:47], v[200:203], v[100:103], v[32:47]
    v_fmac_f32_e64 v71, v91, v83
    v_cvt_pk_bf16_f32 v24, v64, v65
    v_cvt_pk_bf16_f32 v25, v66, v67
    v_cvt_pk_bf16_f32 v26, v68, v69
    v_cvt_pk_bf16_f32 v27, v70, v71
    v_mfma_f32_32x32x16_bf16 v[48:63], v[196:199], v[96:99], v[48:63]
    s_add_u32 s35, s50, 0x1e00000
    buffer_store_dwordx4 v[24:27], v10, s[4:7], s35 offen sc1
    v_lshlrev_b32 v64, 16, v24
    v_and_b32 v65, s56, v24
    v_lshlrev_b32_e64 v66, 16, v25
    v_mfma_f32_32x32x16_bf16 v[32:47], v[208:211], v[104:107], v[32:47]
    v_and_b32 v67, s56, v25
    v_lshlrev_b32 v68, 16, v26
    v_and_b32 v69, s56, v26
    v_lshlrev_b32 v70, 16, v27
    v_and_b32 v71, s56, v27
    s_waitcnt vmcnt(5)
    v_mfma_f32_32x32x16_bf16 v[32:47], v[216:219], v[108:111], v[32:47]
    v_add_f32 v84, v64, v65
    v_mul_f32 v85, v64, v64
    v_fmac_f32 v85, v65, v65
    v_add_f32 v84, v84, v66
    v_fmac_f32_e64 v85, v66, v66
    v_mfma_f32_32x32x16_bf16 v[48:63], v[204:207], v[100:103], v[48:63]
    v_add_f32 v84, v84, v67
    v_fmac_f32 v85, v67, v67
    v_add_f32 v84, v84, v68
    v_fmac_f32 v85, v68, v68
    v_add_f32 v84, v84, v69
    s_waitcnt vmcnt(4)
    v_mfma_f32_32x32x16_bf16 v[32:47], v[224:227], v[112:115], v[32:47]
    v_fmac_f32 v85, v69, v69
    v_add_f32 v84, v84, v70
    v_fmac_f32 v85, v70, v70
    v_add_f32 v84, v84, v71
    v_fmac_f32 v85, v71, v71
    s_waitcnt vmcnt(3)
    v_mfma_f32_32x32x16_bf16 v[32:47], v[232:235], v[116:119], v[32:47]
    v_add_f32_dpp v84, v84, v84 quad_perm:[1,0,3,2] row_mask:0xf bank_mask:0xf
    v_add_f32_dpp v85, v85, v85 quad_perm:[1,0,3,2] row_mask:0xf bank_mask:0xf
    s_nop 0
    v_add_f32_dpp v84, v84, v84 quad_perm:[2,3,0,1] row_mask:0xf bank_mask:0xf
    v_add_f32_dpp v85, v85, v85 quad_perm:[2,3,0,1] row_mask:0xf bank_mask:0xf
    s_nop 0
    v_add_f32_dpp v84, v84, v84 row_half_mirror row_mask:0xf bank_mask:0xf
    v_mfma_f32_32x32x16_bf16 v[48:63], v[212:215], v[104:107], v[48:63]
    v_add_f32_dpp v85, v85, v85 row_half_mirror row_mask:0xf bank_mask:0xf
    s_add_u32 s35, s50, 0x1e02000
    s_sub_u32 s35, s35, s94
    s_mov_b32 exec_lo, 0x01010101
    s_mov_b32 exec_hi, 0x01010101
    buffer_store_dwordx2 v[84:85], v5, s[4:7], s35 offen sc1
    s_mov_b64 exec, -1
    s_waitcnt vmcnt(3)
    v_mfma_f32_32x32x16_bf16 v[32:47], v[240:243], v[120:123], v[32:47]
    s_waitcnt vmcnt(2)
    v_mfma_f32_32x32x16_bf16 v[32:47], v[248:251], v[124:127], v[32:47]
    v_mfma_f32_32x32x16_bf16 v[48:63], v[220:223], v[108:111], v[48:63]
    v_mfma_f32_32x32x16_bf16 v[48:63], v[228:231], v[112:115], v[48:63]
    v_mfma_f32_32x32x16_bf16 v[48:63], v[236:239], v[116:119], v[48:63]
    s_nop 8
    ds_write_b128 v3, v[32:35] offset:34816
    v_mfma_f32_32x32x16_bf16 v[48:63], v[244:247], v[120:123], v[48:63]
    ds_write_b128 v3, v[36:39] offset:34832
    ds_write_b128 v3, v[40:43] offset:34848
    v_mfma_f32_32x32x16_bf16 v[48:63], v[252:255], v[124:127], v[48:63]
    ds_write_b128 v3, v[44:47] offset:34864
    s_nop 10
    ds_write_b128 v3, v[48:51] offset:34944
    ds_write_b128 v3, v[52:55] offset:34960
    ds_write_b128 v3, v[56:59] offset:34976
    ds_write_b128 v3, v[60:63] offset:34992
    s_waitcnt lgkmcnt(0)
    s_barrier
    ds_read_b128 v[32:35], v4 offset:34816
    ds_read_b128 v[36:39], v4 offset:34832
    ds_read_b128 v[40:43], v4 offset:43520
    ds_read_b128 v[44:47], v4 offset:43536
    ds_read_b128 v[48:51], v4 offset:52224
    ds_read_b128 v[52:55], v4 offset:52240
    ds_read_b128 v[56:59], v4 offset:60928
    ds_read_b128 v[60:63], v4 offset:60944
    ds_read_b128 v[76:79], v13 offset:0
    ds_read_b128 v[80:83], v13 offset:16
    v_lshlrev_b32 v64, 16, v28
    v_and_b32 v65, s56, v28
    v_lshlrev_b32 v66, 16, v29
    v_and_b32 v67, s56, v29
    v_lshlrev_b32 v68, 16, v30
    s_waitcnt vmcnt(0)
    s_add_u32 s36, s45, 32768
    s_mov_b64 exec, 1
    buffer_store_dword v8, v8, s[4:7], s36 offen offset:0 sc1
    s_mov_b64 exec, -1
    v_and_b32 v69, s56, v30
    v_lshlrev_b32 v70, 16, v31
    v_and_b32 v71, s56, v31
    s_waitcnt lgkmcnt(7)
    v_pk_add_f32 v[32:33], v[32:33], v[40:41]
    v_pk_add_f32 v[34:35], v[34:35], v[42:43]
    s_waitcnt lgkmcnt(6)
    v_pk_add_f32 v[36:37], v[36:37], v[44:45]
    v_pk_add_f32 v[38:39], v[38:39], v[46:47]
    s_waitcnt lgkmcnt(3)
    v_pk_add_f32 v[48:49], v[48:49], v[56:57]
    v_pk_add_f32 v[50:51], v[50:51], v[58:59]
    s_waitcnt lgkmcnt(2)
    v_pk_add_f32 v[52:53], v[52:53], v[60:61]
    v_pk_add_f32 v[54:55], v[54:55], v[62:63]
    v_pk_add_f32 v[64:65], v[64:65], v[32:33]
    v_pk_add_f32 v[66:67], v[66:67], v[34:35]
    v_pk_add_f32 v[68:69], v[68:69], v[36:37]
    v_pk_add_f32 v[70:71], v[70:71], v[38:39]
    v_pk_add_f32 v[64:65], v[64:65], v[48:49]
    v_pk_add_f32 v[66:67], v[66:67], v[50:51]
    v_pk_add_f32 v[68:69], v[68:69], v[52:53]
    v_pk_add_f32 v[70:71], v[70:71], v[54:55]
    s_waitcnt lgkmcnt(1)
    v_pk_add_f32 v[64:65], v[64:65], v[76:77]
    v_pk_add_f32 v[66:67], v[66:67], v[78:79]
    s_waitcnt lgkmcnt(0)
    v_pk_add_f32 v[68:69], v[68:69], v[80:81]
    v_pk_add_f32 v[70:71], v[70:71], v[82:83]
    v_cvt_pk_bf16_f32 v28, v64, v65
    v_cvt_pk_bf16_f32 v29, v66, v67
    v_cvt_pk_bf16_f32 v30, v68, v69
    v_cvt_pk_bf16_f32 v31, v70, v71
    v_dot2_f32_bf16 v72, v28, s57, 0
    v_dot2_f32_bf16 v73, v28, v28, 0
    v_dot2_f32_bf16 v72, v29, s57, v72
    v_dot2_f32_bf16 v73, v29, v29, v73
    v_dot2_f32_bf16 v72, v30, s57, v72
    v_dot2_f32_bf16 v73, v30, v30, v73
    v_dot2_f32_bf16 v72, v31, s57, v72
    v_dot2_f32_bf16 v73, v31, v31, v73
    s_nop 1
    v_add_f32_dpp v72, v72, v72 quad_perm:[1,0,3,2] row_mask:0xf bank_mask:0xf
    v_add_f32_dpp v73, v73, v73 quad_perm:[1,0,3,2] row_mask:0xf bank_mask:0xf
    s_nop 0
    v_add_f32_dpp v72, v72, v72 quad_perm:[2,3,0,1] row_mask:0xf bank_mask:0xf
    v_add_f32_dpp v73, v73, v73 quad_perm:[2,3,0,1] row_mask:0xf bank_mask:0xf
    s_nop 0
    v_add_f32_dpp v72, v72, v72 row_half_mirror row_mask:0xf bank_mask:0xf
    v_add_f32_dpp v73, v73, v73 row_half_mirror row_mask:0xf bank_mask:0xf
    s_mov_b32 exec_lo, 0x01010101
    s_mov_b32 exec_hi, 0x01010101
    buffer_store_dwordx2 v[72:73], v5, s[4:7], s44 offen offset:2048 sc1
    s_mov_b64 exec, -1
    v_and_b32 v14, 15, v1
    v_mul_u32_u24 v14, 1056, v14
    v_lshrrev_b32_e64 v15, 4, v1
    v_lshl_add_u32 v14, v15, 4, v14
    v_add_u32 v64, s52, v14
    v_add_u32 v65, s53, v14
    v_add_u32 v66, s54, v14
    v_add_u32 v67, s55, v14
    s_add_u32 s37, s46, 32768
    buffer_load_dword v22, v20, s[4:7], s37 offen offset:0 sc1
    ds_read_u16 v40, v23 offset:64
    ds_read_u16 v41, v23 offset:192
    ds_read_u16 v42, v23 offset:320
    ds_read_u16 v43, v23 offset:448
    ds_read_u16 v44, v23 offset:576
    ds_read_u16 v45, v23 offset:704
    ds_read_u16 v46, v23 offset:832
    ds_read_u16 v47, v23 offset:960
    v_lshlrev_b32 v32, 16, v28
    v_and_b32 v33, s56, v28
    v_lshlrev_b32 v34, 16, v29
    v_and_b32 v35, s56, v29
    v_lshlrev_b32 v36, 16, v30
    v_and_b32 v37, s56, v30
    v_lshlrev_b32 v38, 16, v31
    v_and_b32 v39, s56, v31
    s_waitcnt lgkmcnt(7)
    v_lshlrev_b32 v40, 16, v40
    s_waitcnt lgkmcnt(6)
    v_lshlrev_b32 v41, 16, v41
    s_waitcnt lgkmcnt(5)
    v_lshlrev_b32 v42, 16, v42
    s_waitcnt lgkmcnt(4)
    v_lshlrev_b32 v43, 16, v43
    s_waitcnt lgkmcnt(3)
    v_lshlrev_b32 v44, 16, v44
    s_waitcnt lgkmcnt(2)
    v_lshlrev_b32 v45, 16, v45
    s_waitcnt lgkmcnt(1)
    v_lshlrev_b32 v46, 16, v46
    s_waitcnt lgkmcnt(0)
    v_lshlrev_b32_e64 v47, 16, v47
    s_waitcnt vmcnt(0)
    v_cmp_eq_u32 vcc, -1, v22
    s_nop 0
    s_and_b64 vcc, exec, vcc
    s_cbranch_vccz K1_PDONE57
    s_mov_b32 s63, 524288
K1_POLL56:
    buffer_load_dword v22, v20, s[4:7], s37 offen offset:0 sc1
    s_waitcnt vmcnt(0)
    v_cmp_eq_u32 vcc, -1, v22
    s_nop 0
    s_and_b64 vcc, exec, vcc
    s_cbranch_vccz K1_PDONE57
    s_sub_u32 s63, s63, 1
    s_cmp_lg_u32 s63, 0
    s_cbranch_scc1 K1_POLL56
K1_PDONE57:
    s_add_u32 s36, s47, 0x1e00000
    v_lshrrev_b32_e64 v15, 3, v1
    v_mul_u32_u24 v15, 196608, v15
    v_lshl_add_u32 v15, v20, 2, v15
    s_add_u32 m0, s48, 0
    s_nop 0
    buffer_load_dwordx4 v15, s[4:7], s36 offen offset:0 sc1 lds
    s_add_u32 m0, s48, 928
    s_nop 0
    buffer_load_dwordx4 v15, s[4:7], s36 offen offset:128 sc1 lds
    s_add_u32 m0, s48, 1856
    s_nop 0
    buffer_load_dwordx4 v15, s[4:7], s36 offen offset:256 sc1 lds
    s_add_u32 m0, s48, 2784
    s_nop 0
    buffer_load_dwordx4 v15, s[4:7], s36 offen offset:384 sc1 lds
    s_add_u32 m0, s48, 3712
    s_nop 0
    buffer_load_dwordx4 v15, s[4:7], s36 offen offset:512 sc1 lds
    s_add_u32 m0, s48, 4640
    s_nop 0
    buffer_load_dwordx4 v15, s[4:7], s36 offen offset:640 sc1 lds
    s_add_u32 m0, s48, 5568
    s_nop 0
    buffer_load_dwordx4 v15, s[4:7], s36 offen offset:768 sc1 lds
    s_add_u32 m0, s48, 6496
    s_nop 0
    buffer_load_dwordx4 v15, s[4:7], s36 offen offset:896 sc1 lds
    buffer_load_dwordx2 v[120:121], v6, s[4:7], s44 offen offset:2048 sc1
    s_waitcnt vmcnt(1)
    s_barrier
    s_add_u32 s38, s51, 31465472
    s_add_u32 s39, s38, 196608
    ds_read_b128 v[84:87], v64 offset:0
    ds_read_b128 v[88:91], v64 offset:16896
    ds_read_b128 v[56:59], v64 offset:64
    ds_read_b128 v[60:63], v64 offset:16960
    s_waitcnt lgkmcnt(2)
    v_mfma_f32_16x16x32_bf16 v[96:99], a[0:3], v[84:87], 0
    ds_read_b128 v[76:79], v64 offset:128
    v_mfma_f32_16x16x32_bf16 v[100:103], a[64:67], v[84:87], 0
    buffer_load_dwordx2 v[72:73], v9, s[4:7], s38 offen offset:128 sc1
    v_mfma_f32_16x16x32_bf16 v[104:107], a[128:131], v[84:87], 0
    ds_read_b128 v[80:83], v64 offset:17024
    s_waitcnt vmcnt(1)
    v_max_u32 v122, v120, v121
    v_cmp_eq_u32 vcc, -1, v122
    s_nop 0
    s_and_b64 vcc, exec, vcc
    s_cbranch_vccz K1_PDONE59
    s_mov_b32 s63, 524288
K1_POLL58:
    buffer_load_dwordx2 v[120:121], v6, s[4:7], s44 offen offset:2048 sc1
    s_waitcnt vmcnt(0)
    v_max_u32_e64 v122, v120, v121
    v_cmp_eq_u32 vcc, -1, v122
    s_nop 0
    s_and_b64 vcc, exec, vcc
    s_cbranch_vccz K1_PDONE59
    s_sub_u32 s63, s63, 1
    s_cmp_lg_u32 s63, 0
    s_cbranch_scc1 K1_POLL58
K1_PDONE59:
    v_mfma_f32_16x16x32_bf16 v[108:111], a[0:3], v[88:91], 0
    buffer_load_dwordx2 v[74:75], v9, s[4:7], s39 offen offset:128 sc1
    v_add_f32_dpp v120, v120, v120 quad_perm:[1,0,3,2] row_mask:0xf bank_mask:0xf
    v_mfma_f32_16x16x32_bf16 v[112:115], a[64:67], v[88:91], 0
    v_add_f32_dpp v121, v121, v121 quad_perm:[1,0,3,2] row_mask:0xf bank_mask:0xf
    v_add_f32_dpp v120, v120, v120 quad_perm:[2,3,0,1] row_mask:0xf bank_mask:0xf
    v_mfma_f32_16x16x32_bf16 v[116:119], a[128:131], v[88:91], 0
    buffer_load_dwordx2 v[92:93], v9, s[4:7], s38 offen offset:0 sc1
    s_waitcnt lgkmcnt(2)
    v_mfma_f32_16x16x32_bf16 v[96:99], a[4:7], v[56:59], v[96:99]
    ds_read_b128 v[84:87], v64 offset:192
    v_add_f32_dpp v121, v121, v121 quad_perm:[2,3,0,1] row_mask:0xf bank_mask:0xf
    v_mfma_f32_16x16x32_bf16 v[100:103], a[68:71], v[56:59], v[100:103]
    buffer_load_dwordx2 v[94:95], v9, s[4:7], s39 offen offset:0 sc1
    v_add_f32_dpp v120, v120, v120 row_half_mirror row_mask:0xf bank_mask:0xf
    v_mfma_f32_16x16x32_bf16 v[104:107], a[132:135], v[56:59], v[104:107]
    ds_read_b128 v[88:91], v64 offset:17088
    v_add_f32_dpp v121, v121, v121 row_half_mirror row_mask:0xf bank_mask:0xf
    v_mfma_f32_16x16x32_bf16 v[108:111], a[4:7], v[60:63], v[108:111]
    v_mul_f32 v120, s62, v120
    v_mul_f32_e64 v121, s62, v121
    v_mfma_f32_16x16x32_bf16 v[112:115], a[68:71], v[60:63], v[112:115]
    v_fma_f32 v121, -v120, v120, v121
    v_max_f32_e64 v121, 0, v121
    v_mfma_f32_16x16x32_bf16 v[116:119], a[132:135], v[60:63], v[116:119]
    v_add_f32 v121, 0x3727c5ac, v121
    s_waitcnt lgkmcnt(2)
    v_mfma_f32_16x16x32_bf16 v[96:99], a[8:11], v[76:79], v[96:99]
    ds_read_b128 v[56:59], v65 offset:0
    v_mfma_f32_16x16x32_bf16 v[100:103], a[72:75], v[76:79], v[100:103]
    v_rsq_f32 v122, v121
    v_mfma_f32_16x16x32_bf16 v[104:107], a[136:139], v[76:79], v[104:107]
    ds_read_b128 v[60:63], v65 offset:16896
    v_mul_f32_e64 v120, -1.0, v120
    v_mfma_f32_16x16x32_bf16 v[108:111], a[8:11], v[80:83], v[108:111]
    v_mul_f32_e64 v123, v120, v122
    v_fma_f32 v48, v32, v122, v123
    v_mfma_f32_16x16x32_bf16 v[112:115], a[72:75], v[80:83], v[112:115]
    v_fma_f32 v49, v33, v122, v123
    v_fma_f32 v50, v34, v122, v123
    v_mfma_f32_16x16x32_bf16 v[116:119], a[136:139], v[80:83], v[116:119]
    v_fma_f32 v51, v35, v122, v123
    s_waitcnt lgkmcnt(2)
    v_mfma_f32_16x16x32_bf16 v[96:99], a[12:15], v[84:87], v[96:99]
    ds_read_b128 v[76:79], v65 offset:64
    v_fma_f32 v52, v36, v122, v123
    v_mfma_f32_16x16x32_bf16 v[100:103], a[76:79], v[84:87], v[100:103]
    v_fma_f32 v53, v37, v122, v123
    v_fma_f32 v54, v38, v122, v123
    v_mfma_f32_16x16x32_bf16 v[104:107], a[140:143], v[84:87], v[104:107]
    ds_read_b128 v[80:83], v65 offset:16960
    v_fma_f32 v55, v39, v122, v123
    v_mfma_f32_16x16x32_bf16 v[108:111], a[12:15], v[88:91], v[108:111]
    v_fmac_f32 v32, v48, v40
    v_fmac_f32_e64 v33, v49, v41
    v_mfma_f32_16x16x32_bf16 v[112:115], a[76:79], v[88:91], v[112:115]
    v_fmac_f32 v34, v50, v42
    v_fmac_f32 v35, v51, v43
    v_mfma_f32_16x16x32_bf16 v[116:119], a[140:143], v[88:91], v[116:119]
    v_fmac_f32 v36, v52, v44
    s_waitcnt lgkmcnt(2)
    v_mfma_f32_16x16x32_bf16 v[96:99], a[16:19], v[56:59], v[96:99]
    ds_read_b128 v[84:87], v65 offset:128
    v_fmac_f32_e64 v37, v53, v45
    v_mfma_f32_16x16x32_bf16 v[100:103], a[80:83], v[56:59], v[100:103]
    v_fmac_f32 v38, v54, v46
    v_fmac_f32 v39, v55, v47
    v_mfma_f32_16x16x32_bf16 v[104:107], a[144:147], v[56:59], v[104:107]
    ds_read_b128 v[88:91], v65 offset:17024
    v_cvt_pk_bf16_f32 v28, v32, v33
    v_mfma_f32_16x16x32_bf16 v[108:111], a[16:19], v[60:63], v[108:111]
    v_cvt_pk_bf16_f32 v29, v34, v35
    v_cvt_pk_bf16_f32 v30, v36, v37
    v_mfma_f32_16x16x32_bf16 v[112:115], a[80:83], v[60:63], v[112:115]
    v_cvt_pk_bf16_f32 v31, v38, v39
    s_add_u32 s35, s50, 0x1e01000
    v_mfma_f32_16x16x32_bf16 v[116:119], a[144:147], v[60:63], v[116:119]
    buffer_store_dwordx4 v[28:31], v10, s[4:7], s35 offen sc1
    s_waitcnt lgkmcnt(2)
    v_mfma_f32_16x16x32_bf16 v[96:99], a[20:23], v[76:79], v[96:99]
    ds_read_b128 v[56:59], v65 offset:192
    v_lshlrev_b32 v32, 16, v28
    v_mfma_f32_16x16x32_bf16 v[100:103], a[84:87], v[76:79], v[100:103]
    v_and_b32 v33, s56, v28
    v_lshlrev_b32 v34, 16, v29
    v_mfma_f32_16x16x32_bf16 v[104:107], a[148:151], v[76:79], v[104:107]
    ds_read_b128 v[60:63], v65 offset:17088
    v_and_b32_e64 v35, s56, v29
    v_mfma_f32_16x16x32_bf16 v[108:111], a[20:23], v[80:83], v[108:111]
    v_lshlrev_b32 v36, 16, v30
    v_and_b32 v37, s56, v30
    v_mfma_f32_16x16x32_bf16 v[112:115], a[84:87], v[80:83], v[112:115]
    v_lshlrev_b32 v38, 16, v31
    v_and_b32 v39, s56, v31
    v_mfma_f32_16x16x32_bf16 v[116:119], a[148:151], v[80:83], v[116:119]
    v_add_f32 v48, v32, v33
    s_waitcnt lgkmcnt(2)
    v_mfma_f32_16x16x32_bf16 v[96:99], a[24:27], v[84:87], v[96:99]
    ds_read_b128 v[76:79], v66 offset:0
    v_mul_f32_e64 v49, v32, v32
    v_mfma_f32_16x16x32_bf16 v[100:103], a[88:91], v[84:87], v[100:103]
    v_fmac_f32 v49, v33, v33
    v_add_f32 v48, v48, v34
    v_mfma_f32_16x16x32_bf16 v[104:107], a[152:155], v[84:87], v[104:107]
    ds_read_b128 v[80:83], v66 offset:16896
    v_fmac_f32_e64 v49, v34, v34
    v_mfma_f32_16x16x32_bf16 v[108:111], a[24:27], v[88:91], v[108:111]
    v_add_f32 v48, v48, v35
    v_fmac_f32 v49, v35, v35
    v_mfma_f32_16x16x32_bf16 v[112:115], a[88:91], v[88:91], v[112:115]
    v_add_f32 v48, v48, v36
    v_fmac_f32 v49, v36, v36
    v_mfma_f32_16x16x32_bf16 v[116:119], a[152:155], v[88:91], v[116:119]
    v_add_f32 v48, v48, v37
    s_waitcnt lgkmcnt(2)
    v_mfma_f32_16x16x32_bf16 v[96:99], a[28:31], v[56:59], v[96:99]
    ds_read_b128 v[84:87], v66 offset:64
    v_fmac_f32_e64 v49, v37, v37
    v_mfma_f32_16x16x32_bf16 v[100:103], a[92:95], v[56:59], v[100:103]
    v_add_f32 v48, v48, v38
    v_fmac_f32 v49, v38, v38
    v_mfma_f32_16x16x32_bf16 v[104:107], a[156:159], v[56:59], v[104:107]
    ds_read_b128 v[88:91], v66 offset:16960
    v_add_f32_e64 v48, v48, v39
    v_mfma_f32_16x16x32_bf16 v[108:111], a[28:31], v[60:63], v[108:111]
    v_fmac_f32_e64 v49, v39, v39
    v_add_f32_dpp v48, v48, v48 quad_perm:[1,0,3,2] row_mask:0xf bank_mask:0xf
    v_mfma_f32_16x16x32_bf16 v[112:115], a[92:95], v[60:63], v[112:115]
    v_add_f32_dpp v49, v49, v49 quad_perm:[1,0,3,2] row_mask:0xf bank_mask:0xf
    v_add_f32_dpp v48, v48, v48 quad_perm:[2,3,0,1] row_mask:0xf bank_mask:0xf
    v_mfma_f32_16x16x32_bf16 v[116:119], a[156:159], v[60:63], v[116:119]
    v_add_f32_dpp v49, v49, v49 quad_perm:[2,3,0,1] row_mask:0xf bank_mask:0xf
    s_waitcnt lgkmcnt(2)
    v_mfma_f32_16x16x32_bf16 v[96:99], a[32:35], v[76:79], v[96:99]
    ds_read_b128 v[56:59], v66 offset:128
    v_add_f32_dpp v48, v48, v48 row_half_mirror row_mask:0xf bank_mask:0xf
    v_mfma_f32_16x16x32_bf16 v[100:103], a[96:99], v[76:79], v[100:103]
    v_add_f32_dpp v49, v49, v49 row_half_mirror row_mask:0xf bank_mask:0xf
    s_add_u32 s35, s50, 0x1e02100
    s_sub_u32 s35, s35, s94
    s_mov_b32 exec_lo, 0x01010101
    s_mov_b32 exec_hi, 0x01010101
    buffer_store_dwordx2 v[48:49], v5, s[4:7], s35 offen sc1
    s_mov_b64 exec, -1
    v_mfma_f32_16x16x32_bf16 v[104:107], a[160:163], v[76:79], v[104:107]
    ds_read_b128 v[60:63], v66 offset:17024
    s_waitcnt vmcnt(4)
    v_add_f32_e64 v72, v72, v74
    v_mfma_f32_16x16x32_bf16 v[108:111], a[32:35], v[80:83], v[108:111]
    v_add_f32 v73, v73, v75
    v_mov_b32 v74, v72
    v_mfma_f32_16x16x32_bf16 v[112:115], a[96:99], v[80:83], v[112:115]
    v_mov_b32 v75, v73
    v_permlane32_swap_b32 v74, v72
    v_mfma_f32_16x16x32_bf16 v[116:119], a[160:163], v[80:83], v[116:119]
    v_permlane32_swap_b32 v75, v73
    s_waitcnt lgkmcnt(2)
    v_mfma_f32_16x16x32_bf16 v[96:99], a[36:39], v[84:87], v[96:99]
    ds_read_b128 v[76:79], v66 offset:192
    v_add_f32_e64 v72, v72, v74
    v_mfma_f32_16x16x32_bf16 v[100:103], a[100:103], v[84:87], v[100:103]
    v_add_f32 v73, v73, v75
    v_mov_b32 v74, v72
    v_mfma_f32_16x16x32_bf16 v[104:107], a[164:167], v[84:87], v[104:107]
    ds_read_b128 v[80:83], v66 offset:17088
    v_mov_b32_e64 v75, v73
    v_mfma_f32_16x16x32_bf16 v[108:111], a[36:39], v[88:91], v[108:111]
    v_permlane16_swap_b32 v74, v72
    v_permlane16_swap_b32 v75, v73
    v_mfma_f32_16x16x32_bf16 v[112:115], a[100:103], v[88:91], v[112:115]
    v_add_f32 v72, v72, v74
    v_add_f32 v73, v73, v75
    v_mfma_f32_16x16x32_bf16 v[116:119], a[164:167], v[88:91], v[116:119]
    v_mul_f32 v72, s62, v72
    s_waitcnt lgkmcnt(2)
    v_mfma_f32_16x16x32_bf16 v[96:99], a[40:43], v[56:59], v[96:99]
    ds_read_b128 v[84:87], v67 offset:0
    v_mul_f32_e64 v73, s62, v73
    v_mfma_f32_16x16x32_bf16 v[100:103], a[104:107], v[56:59], v[100:103]
    v_fma_f32 v73, -v72, v72, v73
    v_max_f32_e64 v73, 0, v73
    v_mfma_f32_16x16x32_bf16 v[104:107], a[168:171], v[56:59], v[104:107]
    ds_read_b128 v[88:91], v67 offset:16896
    v_add_f32 v73, 0x3727c5ac, v73
    v_mfma_f32_16x16x32_bf16 v[108:111], a[40:43], v[60:63], v[108:111]
    v_rsq_f32_e64 v70, v73
    v_mfma_f32_16x16x32_bf16 v[112:115], a[104:107], v[60:63], v[112:115]
    v_mul_f32_e64 v72, -1.0, v72
    v_mfma_f32_16x16x32_bf16 v[116:119], a[168:171], v[60:63], v[116:119]
    v_mul_f32 v71, v72, v70
    s_waitcnt lgkmcnt(2)
    v_mfma_f32_16x16x32_bf16 v[96:99], a[44:47], v[76:79], v[96:99]
    ds_read_b128 v[56:59], v67 offset:64
    v_mfma_f32_16x16x32_bf16 v[100:103], a[108:111], v[76:79], v[100:103]
    s_waitcnt vmcnt(2)
    v_add_f32 v92, v92, v94
    v_mfma_f32_16x16x32_bf16 v[104:107], a[172:175], v[76:79], v[104:107]
    ds_read_b128 v[60:63], v67 offset:16960
    v_add_f32_e64 v93, v93, v95
    v_mfma_f32_16x16x32_bf16 v[108:111], a[44:47], v[80:83], v[108:111]
    v_mov_b32_e64 v94, v92
    v_mfma_f32_16x16x32_bf16 v[112:115], a[108:111], v[80:83], v[112:115]
    v_mov_b32_e64 v95, v93
    v_mfma_f32_16x16x32_bf16 v[116:119], a[172:175], v[80:83], v[116:119]
    v_permlane32_swap_b32 v94, v92
    s_waitcnt lgkmcnt(2)
    v_mfma_f32_16x16x32_bf16 v[96:99], a[48:51], v[84:87], v[96:99]
    ds_read_b128 v[76:79], v67 offset:128
    v_mfma_f32_16x16x32_bf16 v[100:103], a[112:115], v[84:87], v[100:103]
    v_permlane32_swap_b32_e64 v95, v93
    v_mfma_f32_16x16x32_bf16 v[104:107], a[176:179], v[84:87], v[104:107]
    ds_read_b128 v[80:83], v67 offset:17024
    v_add_f32_e64 v92, v92, v94
    v_mfma_f32_16x16x32_bf16 v[108:111], a[48:51], v[88:91], v[108:111]
    v_add_f32_e64 v93, v93, v95
    v_mfma_f32_16x16x32_bf16 v[112:115], a[112:115], v[88:91], v[112:115]
    v_mov_b32_e64 v94, v92
    v_mfma_f32_16x16x32_bf16 v[116:119], a[176:179], v[88:91], v[116:119]
    s_waitcnt lgkmcnt(2)
    v_mfma_f32_16x16x32_bf16 v[96:99], a[52:55], v[56:59], v[96:99]
    ds_read_b128 v[84:87], v67 offset:192
    s_waitcnt vmcnt(0)
    s_add_u32 s36, s45, 49152
    s_mov_b64 exec, 1
    buffer_store_dword v8, v8, s[4:7], s36 offen offset:0 sc1
    s_mov_b64 exec, -1
    v_mfma_f32_16x16x32_bf16 v[100:103], a[116:119], v[56:59], v[100:103]
    v_mov_b32 v95, v93
    v_permlane16_swap_b32 v94, v92
    v_mfma_f32_16x16x32_bf16 v[104:107], a[180:183], v[56:59], v[104:107]
    ds_read_b128 v[88:91], v67 offset:17088
    v_permlane16_swap_b32_e64 v95, v93
    v_mfma_f32_16x16x32_bf16 v[108:111], a[52:55], v[60:63], v[108:111]
    v_add_f32_e64 v92, v92, v94
    v_mfma_f32_16x16x32_bf16 v[112:115], a[116:119], v[60:63], v[112:115]
    v_add_f32_e64 v93, v93, v95
    v_mfma_f32_16x16x32_bf16 v[116:119], a[180:183], v[60:63], v[116:119]
    s_waitcnt lgkmcnt(2)
    v_mfma_f32_16x16x32_bf16 v[96:99], a[56:59], v[76:79], v[96:99]
    v_mul_f32 v92, s62, v92
    v_mfma_f32_16x16x32_bf16 v[100:103], a[120:123], v[76:79], v[100:103]
    ds_read_b128 v[136:139], v12 offset:0
    v_mul_f32_e64 v93, s62, v93
    v_mfma_f32_16x16x32_bf16 v[104:107], a[184:187], v[76:79], v[104:107]
    v_fma_f32 v93, -v92, v92, v93
    v_mfma_f32_16x16x32_bf16 v[108:111], a[56:59], v[80:83], v[108:111]
    ds_read_b128 v[140:143], v12 offset:16
    v_max_f32_e64 v93, 0, v93
    v_mfma_f32_16x16x32_bf16 v[112:115], a[120:123], v[80:83], v[112:115]
    v_mfma_f32_16x16x32_bf16 v[116:119], a[184:187], v[80:83], v[116:119]
    v_add_f32 v93, 0x3727c5ac, v93
    s_waitcnt lgkmcnt(2)
    v_mfma_f32_16x16x32_bf16 v[96:99], a[60:63], v[84:87], v[96:99]
    v_rsq_f32 v68, v93
    v_mfma_f32_16x16x32_bf16 v[100:103], a[124:127], v[84:87], v[100:103]
    v_mul_f32_e64 v92, -1.0, v92
    v_mfma_f32_16x16x32_bf16 v[104:107], a[188:191], v[84:87], v[104:107]
    v_mul_f32_e64 v69, v92, v68
    v_mfma_f32_16x16x32_bf16 v[108:111], a[60:63], v[88:91], v[108:111]
    v_mfma_f32_16x16x32_bf16 v[112:115], a[124:127], v[88:91], v[112:115]
    v_mfma_f32_16x16x32_bf16 v[116:119], a[188:191], v[88:91], v[116:119]
    s_add_u32 s37, s46, 49152
    buffer_load_dword v22, v20, s[4:7], s37 offen offset:0 sc1
    s_add_u32 s35, s40, 6291456
    s_cmp_eq_u32 s16, 3
    s_cselect_b32 s39, s90, s35
    s_waitcnt lgkmcnt(0)
    v_pk_fma_f32 v[120:121], v[68:69], v[140:141], v[136:137] op_sel:[1,0,0] op_sel_hi:[1,1,1]
    v_pk_fma_f32 v[122:123], v[68:69], v[142:143], v[138:139] op_sel:[1,0,0] op_sel_hi:[1,1,1]
    v_pk_fma_f32 v[124:125], v[70:71], v[140:141], v[136:137] op_sel:[1,0,0] op_sel_hi:[1,1,1]
    v_pk_fma_f32 v[126:127], v[70:71], v[142:143], v[138:139] op_sel:[1,0,0] op_sel_hi:[1,1,1]
    ds_read_b128 v[136:139], v12 offset:128
    ds_read_b128 v[140:143], v12 offset:144
    v_pk_fma_f32 v[120:121], v[68:69], v[96:97], v[120:121] op_sel_hi:[0,1,1]
    v_pk_fma_f32 v[122:123], v[68:69], v[98:99], v[122:123] op_sel_hi:[0,1,1]
    v_pk_fma_f32 v[124:125], v[70:71], v[108:109], v[124:125] op_sel_hi:[0,1,1]
    v_pk_fma_f32 v[126:127], v[70:71], v[110:111], v[126:127] op_sel_hi:[0,1,1]
    v_pk_mul_f32 v[128:129], v[120:121], v[120:121]
    v_pk_mul_f32 v[130:131], v[122:123], v[122:123]
    v_pk_mul_f32 v[132:133], v[124:125], v[124:125]
    v_pk_mul_f32 v[134:135], v[126:127], v[126:127]
    v_pk_fma_f32 v[128:129], v[128:129], s[58:59], v[0:1] op_sel_hi:[1,1,0]
    v_pk_fma_f32 v[130:131], v[130:131], s[58:59], v[0:1] op_sel_hi:[1,1,0]
    v_pk_fma_f32 v[132:133], v[132:133], s[58:59], v[0:1] op_sel_hi:[1,1,0]
    v_pk_fma_f32 v[134:135], v[134:135], s[58:59], v[0:1] op_sel_hi:[1,1,0]
    v_pk_mul_f32 v[128:129], v[120:121], v[128:129]
    v_pk_mul_f32 v[130:131], v[122:123], v[130:131]
    v_pk_mul_f32 v[132:133], v[124:125], v[132:133]
    v_pk_mul_f32 v[134:135], v[126:127], v[134:135]
    v_exp_f32 v128, v128
    v_exp_f32 v129, v129
    v_exp_f32 v130, v130
    v_exp_f32 v131, v131
    v_exp_f32 v132, v132
    v_exp_f32 v133, v133
    v_exp_f32 v134, v134
    v_exp_f32_e64 v135, v135
    v_pk_add_f32 v[128:129], v[128:129], 1.0 op_sel_hi:[1,0]
    v_pk_add_f32 v[130:131], v[130:131], 1.0 op_sel_hi:[1,0]
    v_pk_add_f32 v[132:133], v[132:133], 1.0 op_sel_hi:[1,0]
    v_pk_add_f32 v[134:135], v[134:135], 1.0 op_sel_hi:[1,0]
    v_rcp_f32 v128, v128
    v_rcp_f32 v129, v129
    v_rcp_f32 v130, v130
    v_rcp_f32 v131, v131
    v_rcp_f32 v132, v132
    v_rcp_f32 v133, v133
    v_rcp_f32 v134, v134
    v_rcp_f32 v135, v135
    v_pk_mul_f32 v[120:121], v[120:121], v[128:129]
    v_pk_mul_f32 v[122:123], v[122:123], v[130:131]
    v_pk_mul_f32 v[124:125], v[124:125], v[132:133]
    v_pk_mul_f32 v[126:127], v[126:127], v[134:135]
    v_cvt_pk_bf16_f32 v128, v120, v121
    v_cvt_pk_bf16_f32 v129, v122, v123
    v_cvt_pk_bf16_f32 v130, v124, v125
    s_waitcnt vmcnt(0)
    v_cmp_eq_u32 vcc, -1, v22
    s_nop 0
    s_and_b64 vcc, exec, vcc
    s_cbranch_vccz K1_PDONE61
    s_mov_b32 s63, 524288
K1_POLL60:
    buffer_load_dword v22, v20, s[4:7], s37 offen offset:0 sc1
    s_waitcnt vmcnt(0)
    v_cmp_eq_u32 vcc, -1, v22
    s_nop 0
    s_and_b64 vcc, exec, vcc
    s_cbranch_vccz K1_PDONE61
    s_sub_u32 s63, s63, 1
    s_cmp_lg_u32 s63, 0
    s_cbranch_scc1 K1_POLL60
K1_PDONE61:
    v_cvt_pk_bf16_f32 v131, v126, v127
    v_permlane32_swap_b32 v128, v130
    s_nop 0
    v_permlane32_swap_b32 v129, v131
    buffer_store_dwordx4 v[128:131], v2, s[4:7], s35 offen offset:0 sc1
    s_add_u32 s36, s47, 0x1e01000
    v_lshrrev_b32_e64 v15, 3, v1
    v_mul_u32_u24 v15, 196608, v15
    v_lshl_add_u32 v15, v20, 2, v15
    s_waitcnt lgkmcnt(0)
    v_pk_fma_f32 v[120:121], v[68:69], v[140:141], v[136:137] op_sel:[1,0,0] op_sel_hi:[1,1,1]
    v_pk_fma_f32 v[122:123], v[68:69], v[142:143], v[138:139] op_sel:[1,0,0] op_sel_hi:[1,1,1]
    v_pk_fma_f32 v[124:125], v[70:71], v[140:141], v[136:137] op_sel:[1,0,0] op_sel_hi:[1,1,1]
    v_pk_fma_f32 v[126:127], v[70:71], v[142:143], v[138:139] op_sel:[1,0,0] op_sel_hi:[1,1,1]
    ds_read_b128 v[136:139], v12 offset:256
    s_add_u32 m0, s48, 33792
    s_nop 0
    buffer_load_dwordx4 v15, s[4:7], s36 offen offset:0 sc1 lds
    ds_read_b128 v[140:143], v12 offset:272
    v_pk_fma_f32 v[120:121], v[68:69], v[100:101], v[120:121] op_sel_hi:[0,1,1]
    v_pk_fma_f32 v[122:123], v[68:69], v[102:103], v[122:123] op_sel_hi:[0,1,1]
    v_pk_fma_f32 v[124:125], v[70:71], v[112:113], v[124:125] op_sel_hi:[0,1,1]
    s_add_u32 m0, s48, 34720
    s_nop 0
    buffer_load_dwordx4 v15, s[4:7], s36 offen offset:128 sc1 lds
    v_pk_fma_f32 v[126:127], v[70:71], v[114:115], v[126:127] op_sel_hi:[0,1,1]
    v_pk_mul_f32 v[128:129], v[120:121], v[120:121]
    v_pk_mul_f32 v[130:131], v[122:123], v[122:123]
    v_pk_mul_f32 v[132:133], v[124:125], v[124:125]
    v_pk_mul_f32 v[134:135], v[126:127], v[126:127]
    s_add_u32 m0, s48, 35648
    s_nop 0
    buffer_load_dwordx4 v15, s[4:7], s36 offen offset:256 sc1 lds
    v_pk_fma_f32 v[128:129], v[128:129], s[58:59], v[0:1] op_sel_hi:[1,1,0]
    v_pk_fma_f32 v[130:131], v[130:131], s[58:59], v[0:1] op_sel_hi:[1,1,0]
    v_pk_fma_f32 v[132:133], v[132:133], s[58:59], v[0:1] op_sel_hi:[1,1,0]
    v_pk_fma_f32 v[134:135], v[134:135], s[58:59], v[0:1] op_sel_hi:[1,1,0]
    s_add_u32 m0, s48, 36576
    s_nop 0
    buffer_load_dwordx4 v15, s[4:7], s36 offen offset:384 sc1 lds
    v_pk_mul_f32 v[128:129], v[120:121], v[128:129]
    v_pk_mul_f32 v[130:131], v[122:123], v[130:131]
    v_pk_mul_f32 v[132:133], v[124:125], v[132:133]
    v_pk_mul_f32 v[134:135], v[126:127], v[134:135]
    v_exp_f32 v128, v128
    s_add_u32 m0, s48, 37504
    s_nop 0
    buffer_load_dwordx4 v15, s[4:7], s36 offen offset:512 sc1 lds
    v_exp_f32 v129, v129
    v_exp_f32 v130, v130
    v_exp_f32 v131, v131
    v_exp_f32_e64 v132, v132
    s_add_u32 m0, s48, 38432
    s_nop 0
    buffer_load_dwordx4 v15, s[4:7], s36 offen offset:640 sc1 lds
    v_exp_f32 v133, v133
    v_exp_f32 v134, v134
    v_exp_f32 v135, v135
    v_pk_add_f32 v[128:129], v[128:129], 1.0 op_sel_hi:[1,0]
    v_pk_add_f32 v[130:131], v[130:131], 1.0 op_sel_hi:[1,0]
    s_add_u32 m0, s48, 39360
    s_nop 0
    buffer_load_dwordx4 v15, s[4:7], s36 offen offset:768 sc1 lds
    v_pk_add_f32 v[132:133], v[132:133], 1.0 op_sel_hi:[1,0]
    v_pk_add_f32 v[134:135], v[134:135], 1.0 op_sel_hi:[1,0]
    v_rcp_f32 v128, v128
    v_rcp_f32_e64 v129, v129
    s_add_u32 m0, s48, 40288
    s_nop 0
    buffer_load_dwordx4 v15, s[4:7], s36 offen offset:896 sc1 lds
    v_rcp_f32 v130, v130
    v_rcp_f32 v131, v131
    v_rcp_f32 v132, v132
    v_rcp_f32 v133, v133
    v_rcp_f32 v134, v134
    v_rcp_f32_e64 v135, v135
    v_pk_mul_f32 v[120:121], v[120:121], v[128:129]
    v_pk_mul_f32 v[122:123], v[122:123], v[130:131]
    v_pk_mul_f32 v[124:125], v[124:125], v[132:133]
    v_pk_mul_f32 v[126:127], v[126:127], v[134:135]
    v_cvt_pk_bf16_f32 v128, v120, v121
    v_cvt_pk_bf16_f32 v129, v122, v123
    v_cvt_pk_bf16_f32 v130, v124, v125
    v_cvt_pk_bf16_f32 v131, v126, v127
    s_nop 0
    v_permlane32_swap_b32 v128, v130
    v_permlane32_swap_b32_e64 v129, v131
    buffer_store_dwordx4 v[128:131], v2, s[4:7], s35 offen offset:1024 sc1
    s_waitcnt lgkmcnt(0)
    v_pk_fma_f32 v[120:121], v[68:69], v[140:141], v[136:137] op_sel:[1,0,0] op_sel_hi:[1,1,1]
    v_pk_fma_f32 v[122:123], v[68:69], v[142:143], v[138:139] op_sel:[1,0,0] op_sel_hi:[1,1,1]
    v_pk_fma_f32 v[124:125], v[70:71], v[140:141], v[136:137] op_sel:[1,0,0] op_sel_hi:[1,1,1]
    v_pk_fma_f32 v[126:127], v[70:71], v[142:143], v[138:139] op_sel:[1,0,0] op_sel_hi:[1,1,1]
    v_pk_fma_f32 v[120:121], v[68:69], v[104:105], v[120:121] op_sel_hi:[0,1,1]
    v_pk_fma_f32 v[122:123], v[68:69], v[106:107], v[122:123] op_sel_hi:[0,1,1]
    v_pk_fma_f32 v[124:125], v[70:71], v[116:117], v[124:125] op_sel_hi:[0,1,1]
    v_pk_fma_f32 v[126:127], v[70:71], v[118:119], v[126:127] op_sel_hi:[0,1,1]
    v_pk_mul_f32 v[128:129], v[120:121], v[120:121]
    v_pk_mul_f32 v[130:131], v[122:123], v[122:123]
    v_pk_mul_f32 v[132:133], v[124:125], v[124:125]
    v_pk_mul_f32 v[134:135], v[126:127], v[126:127]
    v_pk_fma_f32 v[128:129], v[128:129], s[58:59], v[0:1] op_sel_hi:[1,1,0]
    v_pk_fma_f32 v[130:131], v[130:131], s[58:59], v[0:1] op_sel_hi:[1,1,0]
    v_pk_fma_f32 v[132:133], v[132:133], s[58:59], v[0:1] op_sel_hi:[1,1,0]
    v_pk_fma_f32 v[134:135], v[134:135], s[58:59], v[0:1] op_sel_hi:[1,1,0]
    v_pk_mul_f32 v[128:129], v[120:121], v[128:129]
    v_pk_mul_f32 v[130:131], v[122:123], v[130:131]
    v_pk_mul_f32 v[132:133], v[124:125], v[132:133]
    v_pk_mul_f32 v[134:135], v[126:127], v[134:135]
    v_exp_f32 v128, v128
    v_exp_f32 v129, v129
    v_exp_f32 v130, v130
    v_exp_f32 v131, v131
    v_exp_f32 v132, v132
    v_exp_f32 v133, v133
    v_exp_f32 v134, v134
    v_exp_f32_e64 v135, v135
    v_pk_add_f32 v[128:129], v[128:129], 1.0 op_sel_hi:[1,0]
    v_pk_add_f32 v[130:131], v[130:131], 1.0 op_sel_hi:[1,0]
    v_pk_add_f32 v[132:133], v[132:133], 1.0 op_sel_hi:[1,0]
    v_pk_add_f32 v[134:135], v[134:135], 1.0 op_sel_hi:[1,0]
    v_rcp_f32 v128, v128
    v_rcp_f32 v129, v129
    v_rcp_f32 v130, v130
    v_rcp_f32 v131, v131
    v_rcp_f32 v132, v132
    v_rcp_f32 v133, v133
    v_rcp_f32 v134, v134
    v_rcp_f32 v135, v135
    v_pk_mul_f32 v[120:121], v[120:121], v[128:129]
    v_pk_mul_f32 v[122:123], v[122:123], v[130:131]
    v_pk_mul_f32 v[124:125], v[124:125], v[132:133]
    v_pk_mul_f32 v[126:127], v[126:127], v[134:135]
    v_cvt_pk_bf16_f32 v128, v120, v121
    v_cvt_pk_bf16_f32 v129, v122, v123
    v_cvt_pk_bf16_f32 v130, v124, v125
    v_cvt_pk_bf16_f32 v131, v126, v127
    s_nop 0
    v_permlane32_swap_b32 v128, v130
    s_waitcnt vmcnt(1)
    s_barrier
    ds_read_b128 v[84:87], v64 offset:33792
    ds_read_b128 v[88:91], v64 offset:50688
    ds_read_b128 v[56:59], v64 offset:33856
    ds_read_b128 v[60:63], v64 offset:50752
    v_permlane32_swap_b32_e64 v129, v131
    buffer_store_dwordx4 v[128:131], v2, s[4:7], s39 offen offset:2048 sc1
    s_add_u32 s38, s51, 31465728
    s_add_u32 s39, s38, 196608
    s_waitcnt lgkmcnt(2)
    v_mfma_f32_16x16x32_bf16 v[32:35], a[0:3], v[84:87], 0
    ds_read_b128 v[76:79], v64 offset:33920
    v_mfma_f32_16x16x32_bf16 v[36:39], a[64:67], v[84:87], 0
    buffer_load_dwordx2 v[72:73], v9, s[4:7], s38 offen offset:128 sc1
    v_mfma_f32_16x16x32_bf16 v[40:43], a[128:131], v[84:87], 0
    ds_read_b128 v[80:83], v64 offset:50816
    v_mfma_f32_16x16x32_bf16 v[44:47], a[0:3], v[88:91], 0
    buffer_load_dwordx2 v[74:75], v9, s[4:7], s39 offen offset:128 sc1
    v_mfma_f32_16x16x32_bf16 v[48:51], a[64:67], v[88:91], 0
    v_mfma_f32_16x16x32_bf16 v[52:55], a[128:131], v[88:91], 0
    buffer_load_dwordx2 v[92:93], v9, s[4:7], s38 offen offset:0 sc1
    s_waitcnt lgkmcnt(2)
    v_mfma_f32_16x16x32_bf16 v[32:35], a[4:7], v[56:59], v[32:35]
    ds_read_b128 v[84:87], v64 offset:33984
    v_mfma_f32_16x16x32_bf16 v[36:39], a[68:71], v[56:59], v[36:39]
    buffer_load_dwordx2 v[94:95], v9, s[4:7], s39 offen offset:0 sc1
    v_mfma_f32_16x16x32_bf16 v[40:43], a[132:135], v[56:59], v[40:43]
    ds_read_b128 v[88:91], v64 offset:50880
    v_mfma_f32_16x16x32_bf16 v[44:47], a[4:7], v[60:63], v[44:47]
    v_mfma_f32_16x16x32_bf16 v[48:51], a[68:71], v[60:63], v[48:51]
    v_mfma_f32_16x16x32_bf16 v[52:55], a[132:135], v[60:63], v[52:55]
    s_waitcnt lgkmcnt(2)
    v_mfma_f32_16x16x32_bf16 v[32:35], a[8:11], v[76:79], v[32:35]
    ds_read_b128 v[56:59], v65 offset:33792
    v_mfma_f32_16x16x32_bf16 v[36:39], a[72:75], v[76:79], v[36:39]
    v_mfma_f32_16x16x32_bf16 v[40:43], a[136:139], v[76:79], v[40:43]
    ds_read_b128 v[60:63], v65 offset:50688
    v_mfma_f32_16x16x32_bf16 v[44:47], a[8:11], v[80:83], v[44:47]
    v_mfma_f32_16x16x32_bf16 v[48:51], a[72:75], v[80:83], v[48:51]
    v_mfma_f32_16x16x32_bf16 v[52:55], a[136:139], v[80:83], v[52:55]
    s_waitcnt lgkmcnt(2)
    v_mfma_f32_16x16x32_bf16 v[32:35], a[12:15], v[84:87], v[32:35]
    ds_read_b128 v[76:79], v65 offset:33856
    v_mfma_f32_16x16x32_bf16 v[36:39], a[76:79], v[84:87], v[36:39]
    v_mfma_f32_16x16x32_bf16 v[40:43], a[140:143], v[84:87], v[40:43]
    ds_read_b128 v[80:83], v65 offset:50752
    v_mfma_f32_16x16x32_bf16 v[44:47], a[12:15], v[88:91], v[44:47]
    v_mfma_f32_16x16x32_bf16 v[48:51], a[76:79], v[88:91], v[48:51]
    v_mfma_f32_16x16x32_bf16 v[52:55], a[140:143], v[88:91], v[52:55]
    s_waitcnt lgkmcnt(2)
    v_mfma_f32_16x16x32_bf16 v[32:35], a[16:19], v[56:59], v[32:35]
    ds_read_b128 v[84:87], v65 offset:33920
    v_mfma_f32_16x16x32_bf16 v[36:39], a[80:83], v[56:59], v[36:39]
    v_mfma_f32_16x16x32_bf16 v[40:43], a[144:147], v[56:59], v[40:43]
    ds_read_b128 v[88:91], v65 offset:50816
    v_mfma_f32_16x16x32_bf16 v[44:47], a[16:19], v[60:63], v[44:47]
    v_mfma_f32_16x16x32_bf16 v[48:51], a[80:83], v[60:63], v[48:51]
    v_mfma_f32_16x16x32_bf16 v[52:55], a[144:147], v[60:63], v[52:55]
    s_waitcnt lgkmcnt(2)
    v_mfma_f32_16x16x32_bf16 v[32:35], a[20:23], v[76:79], v[32:35]
    ds_read_b128 v[56:59], v65 offset:33984
    v_mfma_f32_16x16x32_bf16 v[36:39], a[84:87], v[76:79], v[36:39]
    v_mfma_f32_16x16x32_bf16 v[40:43], a[148:151], v[76:79], v[40:43]
    ds_read_b128 v[60:63], v65 offset:50880
    s_waitcnt vmcnt(4)
    s_add_u32 s36, s41, 32768
    s_mov_b64 exec, 1
    buffer_store_dword v8, v8, s[4:7], s36 offen offset:0 sc1
    s_mov_b64 exec, -1
    v_mfma_f32_16x16x32_bf16 v[44:47], a[20:23], v[80:83], v[44:47]
    v_mfma_f32_16x16x32_bf16 v[48:51], a[84:87], v[80:83], v[48:51]
    v_mfma_f32_16x16x32_bf16 v[52:55], a[148:151], v[80:83], v[52:55]
    s_waitcnt lgkmcnt(2)
    v_mfma_f32_16x16x32_bf16 v[32:35], a[24:27], v[84:87], v[32:35]
    ds_read_b128 v[76:79], v66 offset:33792
    v_mfma_f32_16x16x32_bf16 v[36:39], a[88:91], v[84:87], v[36:39]
    v_mfma_f32_16x16x32_bf16 v[40:43], a[152:155], v[84:87], v[40:43]
    ds_read_b128 v[80:83], v66 offset:50688
    v_mfma_f32_16x16x32_bf16 v[44:47], a[24:27], v[88:91], v[44:47]
    v_mfma_f32_16x16x32_bf16 v[48:51], a[88:91], v[88:91], v[48:51]
    s_waitcnt vmcnt(3)
    v_add_f32 v72, v72, v74
    v_mfma_f32_16x16x32_bf16 v[52:55], a[152:155], v[88:91], v[52:55]
    v_add_f32 v73, v73, v75
    s_waitcnt lgkmcnt(2)
    v_mfma_f32_16x16x32_bf16 v[32:35], a[28:31], v[56:59], v[32:35]
    ds_read_b128 v[84:87], v66 offset:33856
    v_mov_b32_e64 v74, v72
    v_mfma_f32_16x16x32_bf16 v[36:39], a[92:95], v[56:59], v[36:39]
    v_mov_b32_e64 v75, v73
    v_mfma_f32_16x16x32_bf16 v[40:43], a[156:159], v[56:59], v[40:43]
    ds_read_b128 v[88:91], v66 offset:50752
    v_permlane32_swap_b32_e64 v74, v72
    v_mfma_f32_16x16x32_bf16 v[44:47], a[28:31], v[60:63], v[44:47]
    v_mfma_f32_16x16x32_bf16 v[48:51], a[92:95], v[60:63], v[48:51]
    v_permlane32_swap_b32_e64 v75, v73
    v_mfma_f32_16x16x32_bf16 v[52:55], a[156:159], v[60:63], v[52:55]
    v_add_f32 v72, v72, v74
    s_waitcnt lgkmcnt(2)
    v_mfma_f32_16x16x32_bf16 v[32:35], a[32:35], v[76:79], v[32:35]
    ds_read_b128 v[56:59], v66 offset:33920
    v_add_f32_e64 v73, v73, v75
    v_mfma_f32_16x16x32_bf16 v[36:39], a[96:99], v[76:79], v[36:39]
    v_mov_b32_e64 v74, v72
    v_mfma_f32_16x16x32_bf16 v[40:43], a[160:163], v[76:79], v[40:43]
    ds_read_b128 v[60:63], v66 offset:50816
    v_mfma_f32_16x16x32_bf16 v[44:47], a[32:35], v[80:83], v[44:47]
    v_mov_b32_e64 v75, v73
    v_mfma_f32_16x16x32_bf16 v[48:51], a[96:99], v[80:83], v[48:51]
    s_add_u32 s37, s42, 32768
    buffer_load_dword v22, v20, s[4:7], s37 offen offset:0 sc1
    s_add_u32 s36, s49, 6291456
    v_add_u32_e64 v21, s36, v11
    v_mfma_f32_16x16x32_bf16 v[52:55], a[160:163], v[80:83], v[52:55]
    v_permlane16_swap_b32 v74, v72
    s_waitcnt lgkmcnt(2)
    v_mfma_f32_16x16x32_bf16 v[32:35], a[36:39], v[84:87], v[32:35]
    ds_read_b128 v[76:79], v66 offset:33984
    v_permlane16_swap_b32_e64 v75, v73
    v_mfma_f32_16x16x32_bf16 v[36:39], a[100:103], v[84:87], v[36:39]
    v_add_f32 v72, v72, v74
    v_add_f32 v73, v73, v75
    v_mfma_f32_16x16x32_bf16 v[40:43], a[164:167], v[84:87], v[40:43]
    ds_read_b128 v[80:83], v66 offset:50880
    v_mfma_f32_16x16x32_bf16 v[44:47], a[36:39], v[88:91], v[44:47]
    v_mul_f32_e64 v72, s62, v72
    v_mfma_f32_16x16x32_bf16 v[48:51], a[100:103], v[88:91], v[48:51]
    v_mul_f32_e64 v73, s62, v73
    v_mfma_f32_16x16x32_bf16 v[52:55], a[164:167], v[88:91], v[52:55]
    v_fma_f32 v73, -v72, v72, v73
    s_waitcnt lgkmcnt(2)
    v_mfma_f32_16x16x32_bf16 v[32:35], a[40:43], v[56:59], v[32:35]
    ds_read_b128 v[84:87], v67 offset:33792
    v_max_f32 v73, 0, v73
    v_mfma_f32_16x16x32_bf16 v[36:39], a[104:107], v[56:59], v[36:39]
    v_mfma_f32_16x16x32_bf16 v[40:43], a[168:171], v[56:59], v[40:43]
    ds_read_b128 v[88:91], v67 offset:50688
    v_add_f32 v73, 0x3727c5ac, v73
    v_mfma_f32_16x16x32_bf16 v[44:47], a[40:43], v[60:63], v[44:47]
    v_rsq_f32_e64 v74, v73
    v_mfma_f32_16x16x32_bf16 v[48:51], a[104:107], v[60:63], v[48:51]
    v_mul_f32_e64 v72, -1.0, v72
    v_mfma_f32_16x16x32_bf16 v[52:55], a[168:171], v[60:63], v[52:55]
    v_mul_f32 v75, v72, v74
    s_waitcnt lgkmcnt(2)
    v_mfma_f32_16x16x32_bf16 v[32:35], a[44:47], v[76:79], v[32:35]
    ds_read_b128 v[56:59], v67 offset:33856
    v_mfma_f32_16x16x32_bf16 v[36:39], a[108:111], v[76:79], v[36:39]
    s_waitcnt vmcnt(2)
    v_add_f32 v92, v92, v94
    v_mfma_f32_16x16x32_bf16 v[40:43], a[172:175], v[76:79], v[40:43]
    ds_read_b128 v[60:63], v67 offset:50752
    v_add_f32_e64 v93, v93, v95
    v_mfma_f32_16x16x32_bf16 v[44:47], a[44:47], v[80:83], v[44:47]
    v_mov_b32_e64 v94, v92
    v_mfma_f32_16x16x32_bf16 v[48:51], a[108:111], v[80:83], v[48:51]
    v_mov_b32_e64 v95, v93
    v_mfma_f32_16x16x32_bf16 v[52:55], a[172:175], v[80:83], v[52:55]
    v_permlane32_swap_b32 v94, v92
    s_waitcnt lgkmcnt(2)
    v_mfma_f32_16x16x32_bf16 v[32:35], a[48:51], v[84:87], v[32:35]
    ds_read_b128 v[76:79], v67 offset:33920
    v_mfma_f32_16x16x32_bf16 v[36:39], a[112:115], v[84:87], v[36:39]
    v_permlane32_swap_b32_e64 v95, v93
    v_mfma_f32_16x16x32_bf16 v[40:43], a[176:179], v[84:87], v[40:43]
    ds_read_b128 v[80:83], v67 offset:50816
    s_waitcnt vmcnt(0)
    v_cmp_eq_u32 vcc, -1, v22
    s_nop 0
    s_and_b64 vcc, exec, vcc
    s_cbranch_vccz K1_PDONE63
    s_mov_b32 s63, 524288
K1_POLL62:
    buffer_load_dword v22, v20, s[4:7], s37 offen offset:0 sc1
    s_waitcnt vmcnt(0)
    v_cmp_eq_u32 vcc, -1, v22
    s_nop 0
    s_and_b64 vcc, exec, vcc
    s_cbranch_vccz K1_PDONE63
    s_sub_u32 s63, s63, 1
    s_cmp_lg_u32 s63, 0
    s_cbranch_scc1 K1_POLL62
K1_PDONE63:
    v_mfma_f32_16x16x32_bf16 v[44:47], a[48:51], v[88:91], v[44:47]
    buffer_load_dwordx4 v[96:99], v21, s[4:7], s64 offen sc1
    v_add_f32 v92, v92, v94
    v_mfma_f32_16x16x32_bf16 v[48:51], a[112:115], v[88:91], v[48:51]
    v_add_f32 v93, v93, v95
    v_mov_b32 v94, v92
    v_mfma_f32_16x16x32_bf16 v[52:55], a[176:179], v[88:91], v[52:55]
    s_waitcnt lgkmcnt(2)
    v_mfma_f32_16x16x32_bf16 v[32:35], a[52:55], v[56:59], v[32:35]
    ds_read_b128 v[84:87], v67 offset:33984
    v_mov_b32 v95, v93
    v_mfma_f32_16x16x32_bf16 v[36:39], a[116:119], v[56:59], v[36:39]
    buffer_load_dwordx4 v[100:103], v21, s[4:7], s65 offen sc1
    v_permlane16_swap_b32_e64 v94, v92
    v_mfma_f32_16x16x32_bf16 v[40:43], a[180:183], v[56:59], v[40:43]
    ds_read_b128 v[88:91], v67 offset:50880
    v_permlane16_swap_b32_e64 v95, v93
    v_mfma_f32_16x16x32_bf16 v[44:47], a[52:55], v[60:63], v[44:47]
    v_add_f32_e64 v92, v92, v94
    v_mfma_f32_16x16x32_bf16 v[48:51], a[116:119], v[60:63], v[48:51]
    v_add_f32_e64 v93, v93, v95
    v_mfma_f32_16x16x32_bf16 v[52:55], a[180:183], v[60:63], v[52:55]
    buffer_load_dwordx4 v[104:107], v21, s[4:7], s66 offen sc1
    s_waitcnt lgkmcnt(2)
    v_mfma_f32_16x16x32_bf16 v[32:35], a[56:59], v[76:79], v[32:35]
    v_mul_f32 v92, s62, v92
    v_mfma_f32_16x16x32_bf16 v[36:39], a[120:123], v[76:79], v[36:39]
    ds_read_b128 v[56:59], v12 offset:0
    v_mul_f32_e64 v93, s62, v93
    v_mfma_f32_16x16x32_bf16 v[40:43], a[184:187], v[76:79], v[40:43]
    v_fma_f32 v93, -v92, v92, v93
    v_mfma_f32_16x16x32_bf16 v[44:47], a[56:59], v[80:83], v[44:47]
    ds_read_b128 v[60:63], v12 offset:16
    buffer_load_dwordx4 v[108:111], v21, s[4:7], s67 offen sc1
    v_mfma_f32_16x16x32_bf16 v[48:51], a[120:123], v[80:83], v[48:51]
    v_max_f32_e64 v93, 0, v93
    v_mfma_f32_16x16x32_bf16 v[52:55], a[184:187], v[80:83], v[52:55]
    v_add_f32 v93, 0x3727c5ac, v93
    s_waitcnt lgkmcnt(2)
    v_mfma_f32_16x16x32_bf16 v[32:35], a[60:63], v[84:87], v[32:35]
    v_rsq_f32 v72, v93
    v_mfma_f32_16x16x32_bf16 v[36:39], a[124:127], v[84:87], v[36:39]
    buffer_load_dwordx4 v[112:115], v21, s[4:7], s68 offen sc1
    v_mul_f32_e64 v92, -1.0, v92
    v_mfma_f32_16x16x32_bf16 v[40:43], a[188:191], v[84:87], v[40:43]
    v_mul_f32_e64 v73, v92, v72
    v_mfma_f32_16x16x32_bf16 v[44:47], a[60:63], v[88:91], v[44:47]
    v_mfma_f32_16x16x32_bf16 v[48:51], a[124:127], v[88:91], v[48:51]
    v_mfma_f32_16x16x32_bf16 v[52:55], a[188:191], v[88:91], v[52:55]
    s_add_u32 s35, s40, 6302720
    s_cmp_eq_u32 s16, 3
    s_cselect_b32 s39, s90, s35
    s_waitcnt lgkmcnt(0)
    v_pk_fma_f32 v[76:77], v[72:73], v[60:61], v[56:57] op_sel:[1,0,0] op_sel_hi:[1,1,1]
    buffer_load_dwordx4 v[116:119], v21, s[4:7], s69 offen sc1
    v_pk_fma_f32 v[78:79], v[72:73], v[62:63], v[58:59] op_sel:[1,0,0] op_sel_hi:[1,1,1]
    v_pk_fma_f32 v[80:81], v[74:75], v[60:61], v[56:57] op_sel:[1,0,0] op_sel_hi:[1,1,1]
    v_pk_fma_f32 v[82:83], v[74:75], v[62:63], v[58:59] op_sel:[1,0,0] op_sel_hi:[1,1,1]
    ds_read_b128 v[56:59], v12 offset:128
    ds_read_b128 v[60:63], v12 offset:144
    v_pk_fma_f32 v[76:77], v[72:73], v[32:33], v[76:77] op_sel_hi:[0,1,1]
    v_pk_fma_f32 v[78:79], v[72:73], v[34:35], v[78:79] op_sel_hi:[0,1,1]
    v_pk_fma_f32 v[80:81], v[74:75], v[44:45], v[80:81] op_sel_hi:[0,1,1]
    v_pk_fma_f32 v[82:83], v[74:75], v[46:47], v[82:83] op_sel_hi:[0,1,1]
    v_pk_mul_f32 v[84:85], v[76:77], v[76:77]
    v_pk_mul_f32 v[86:87], v[78:79], v[78:79]
    v_pk_mul_f32 v[88:89], v[80:81], v[80:81]
    v_pk_mul_f32 v[90:91], v[82:83], v[82:83]
    v_pk_fma_f32 v[84:85], v[84:85], s[58:59], v[0:1] op_sel_hi:[1,1,0]
    v_pk_fma_f32 v[86:87], v[86:87], s[58:59], v[0:1] op_sel_hi:[1,1,0]
    v_pk_fma_f32 v[88:89], v[88:89], s[58:59], v[0:1] op_sel_hi:[1,1,0]
    v_pk_fma_f32 v[90:91], v[90:91], s[58:59], v[0:1] op_sel_hi:[1,1,0]
    v_pk_mul_f32 v[84:85], v[76:77], v[84:85]
    v_pk_mul_f32 v[86:87], v[78:79], v[86:87]
    v_pk_mul_f32 v[88:89], v[80:81], v[88:89]
    v_pk_mul_f32 v[90:91], v[82:83], v[90:91]
    v_exp_f32 v84, v84
    buffer_load_dwordx4 v[120:123], v21, s[4:7], s70 offen sc1
    v_exp_f32 v85, v85
    v_exp_f32 v86, v86
    v_exp_f32 v87, v87
    v_exp_f32 v88, v88
    v_exp_f32 v89, v89
    v_exp_f32 v90, v90
    v_exp_f32_e64 v91, v91
    v_pk_add_f32 v[84:85], v[84:85], 1.0 op_sel_hi:[1,0]
    v_pk_add_f32 v[86:87], v[86:87], 1.0 op_sel_hi:[1,0]
    v_pk_add_f32 v[88:89], v[88:89], 1.0 op_sel_hi:[1,0]
    v_pk_add_f32 v[90:91], v[90:91], 1.0 op_sel_hi:[1,0]
    v_rcp_f32 v84, v84
    v_rcp_f32 v85, v85
    v_rcp_f32 v86, v86
    v_rcp_f32 v87, v87
    v_rcp_f32 v88, v88
    v_rcp_f32 v89, v89
    v_rcp_f32 v90, v90
    v_rcp_f32 v91, v91
    v_pk_mul_f32 v[76:77], v[76:77], v[84:85]
    v_pk_mul_f32 v[78:79], v[78:79], v[86:87]
    v_pk_mul_f32 v[80:81], v[80:81], v[88:89]
    buffer_load_dwordx4 v[124:127], v21, s[4:7], s71 offen sc1
    v_pk_mul_f32 v[82:83], v[82:83], v[90:91]
    v_cvt_pk_bf16_f32 v84, v76, v77
    v_cvt_pk_bf16_f32 v85, v78, v79
    v_cvt_pk_bf16_f32 v86, v80, v81
    v_cvt_pk_bf16_f32 v87, v82, v83
    s_nop 0
    v_permlane32_swap_b32 v84, v86
    v_permlane32_swap_b32_e64 v85, v87
    buffer_store_dwordx4 v[84:87], v2, s[4:7], s35 offen offset:0 sc1
    s_waitcnt lgkmcnt(0)
    v_pk_fma_f32 v[76:77], v[72:73], v[60:61], v[56:57] op_sel:[1,0,0] op_sel_hi:[1,1,1]
    v_pk_fma_f32 v[78:79], v[72:73], v[62:63], v[58:59] op_sel:[1,0,0] op_sel_hi:[1,1,1]
    v_pk_fma_f32 v[80:81], v[74:75], v[60:61], v[56:57] op_sel:[1,0,0] op_sel_hi:[1,1,1]
    v_pk_fma_f32 v[82:83], v[74:75], v[62:63], v[58:59] op_sel:[1,0,0] op_sel_hi:[1,1,1]
    ds_read_b128 v[56:59], v12 offset:256
    ds_read_b128 v[60:63], v12 offset:272
    v_pk_fma_f32 v[76:77], v[72:73], v[36:37], v[76:77] op_sel_hi:[0,1,1]
    v_pk_fma_f32 v[78:79], v[72:73], v[38:39], v[78:79] op_sel_hi:[0,1,1]
    v_pk_fma_f32 v[80:81], v[74:75], v[48:49], v[80:81] op_sel_hi:[0,1,1]
    v_pk_fma_f32 v[82:83], v[74:75], v[50:51], v[82:83] op_sel_hi:[0,1,1]
    v_pk_mul_f32 v[84:85], v[76:77], v[76:77]
    v_pk_mul_f32 v[86:87], v[78:79], v[78:79]
    v_pk_mul_f32 v[88:89], v[80:81], v[80:81]
    v_pk_mul_f32 v[90:91], v[82:83], v[82:83]
    buffer_load_dwordx4 v[128:131], v21, s[4:7], s72 offen sc1
    v_pk_fma_f32 v[84:85], v[84:85], s[58:59], v[0:1] op_sel_hi:[1,1,0]
    v_pk_fma_f32 v[86:87], v[86:87], s[58:59], v[0:1] op_sel_hi:[1,1,0]
    v_pk_fma_f32 v[88:89], v[88:89], s[58:59], v[0:1] op_sel_hi:[1,1,0]
    v_pk_fma_f32 v[90:91], v[90:91], s[58:59], v[0:1] op_sel_hi:[1,1,0]
    v_pk_mul_f32 v[84:85], v[76:77], v[84:85]
    v_pk_mul_f32 v[86:87], v[78:79], v[86:87]
    v_pk_mul_f32 v[88:89], v[80:81], v[88:89]
    v_pk_mul_f32 v[90:91], v[82:83], v[90:91]
    v_exp_f32 v84, v84
    v_exp_f32 v85, v85
    v_exp_f32 v86, v86
    v_exp_f32 v87, v87
    v_exp_f32 v88, v88
    v_exp_f32 v89, v89
    v_exp_f32 v90, v90
    v_exp_f32_e64 v91, v91
    v_pk_add_f32 v[84:85], v[84:85], 1.0 op_sel_hi:[1,0]
    v_pk_add_f32 v[86:87], v[86:87], 1.0 op_sel_hi:[1,0]
    v_pk_add_f32 v[88:89], v[88:89], 1.0 op_sel_hi:[1,0]
    v_pk_add_f32 v[90:91], v[90:91], 1.0 op_sel_hi:[1,0]
    v_rcp_f32 v84, v84
    v_rcp_f32 v85, v85
    buffer_load_dwordx4 v[132:135], v21, s[4:7], s73 offen sc1
    v_rcp_f32 v86, v86
    v_rcp_f32 v87, v87
    v_rcp_f32 v88, v88
    v_rcp_f32 v89, v89
    v_rcp_f32 v90, v90
    v_rcp_f32 v91, v91
    v_pk_mul_f32 v[76:77], v[76:77], v[84:85]
    v_pk_mul_f32 v[78:79], v[78:79], v[86:87]
    v_pk_mul_f32 v[80:81], v[80:81], v[88:89]
    v_pk_mul_f32 v[82:83], v[82:83], v[90:91]
    v_cvt_pk_bf16_f32 v84, v76, v77
    v_cvt_pk_bf16_f32 v85, v78, v79
    v_cvt_pk_bf16_f32 v86, v80, v81
    v_cvt_pk_bf16_f32 v87, v82, v83
    s_nop 0
    v_permlane32_swap_b32 v84, v86
    v_permlane32_swap_b32_e64 v85, v87
    buffer_store_dwordx4 v[84:87], v2, s[4:7], s35 offen offset:1024 sc1
    s_waitcnt lgkmcnt(0)
    v_pk_fma_f32 v[76:77], v[72:73], v[60:61], v[56:57] op_sel:[1,0,0] op_sel_hi:[1,1,1]
    v_pk_fma_f32 v[78:79], v[72:73], v[62:63], v[58:59] op_sel:[1,0,0] op_sel_hi:[1,1,1]
    v_pk_fma_f32 v[80:81], v[74:75], v[60:61], v[56:57] op_sel:[1,0,0] op_sel_hi:[1,1,1]
    v_pk_fma_f32 v[82:83], v[74:75], v[62:63], v[58:59] op_sel:[1,0,0] op_sel_hi:[1,1,1]
    v_pk_fma_f32 v[76:77], v[72:73], v[40:41], v[76:77] op_sel_hi:[0,1,1]
    buffer_load_dwordx4 v[136:139], v21, s[4:7], s74 offen sc1
    v_pk_fma_f32 v[78:79], v[72:73], v[42:43], v[78:79] op_sel_hi:[0,1,1]
    v_pk_fma_f32 v[80:81], v[74:75], v[52:53], v[80:81] op_sel_hi:[0,1,1]
    v_pk_fma_f32 v[82:83], v[74:75], v[54:55], v[82:83] op_sel_hi:[0,1,1]
    v_pk_mul_f32 v[84:85], v[76:77], v[76:77]
    v_pk_mul_f32 v[86:87], v[78:79], v[78:79]
    v_pk_mul_f32 v[88:89], v[80:81], v[80:81]
    v_pk_mul_f32 v[90:91], v[82:83], v[82:83]
    v_pk_fma_f32 v[84:85], v[84:85], s[58:59], v[0:1] op_sel_hi:[1,1,0]
    v_pk_fma_f32 v[86:87], v[86:87], s[58:59], v[0:1] op_sel_hi:[1,1,0]
    v_pk_fma_f32 v[88:89], v[88:89], s[58:59], v[0:1] op_sel_hi:[1,1,0]
    v_pk_fma_f32 v[90:91], v[90:91], s[58:59], v[0:1] op_sel_hi:[1,1,0]
    v_pk_mul_f32 v[84:85], v[76:77], v[84:85]
    v_pk_mul_f32 v[86:87], v[78:79], v[86:87]
    v_pk_mul_f32 v[88:89], v[80:81], v[88:89]
    v_pk_mul_f32 v[90:91], v[82:83], v[90:91]
    v_exp_f32 v84, v84
    v_exp_f32 v85, v85
    v_exp_f32 v86, v86
    v_exp_f32 v87, v87
    v_exp_f32 v88, v88
    v_exp_f32 v89, v89
    v_exp_f32 v90, v90
    buffer_load_dwordx4 v[140:143], v21, s[4:7], s75 offen sc1
    v_exp_f32_e64 v91, v91
    v_pk_add_f32 v[84:85], v[84:85], 1.0 op_sel_hi:[1,0]
    v_pk_add_f32 v[86:87], v[86:87], 1.0 op_sel_hi:[1,0]
    v_pk_add_f32 v[88:89], v[88:89], 1.0 op_sel_hi:[1,0]
    v_pk_add_f32 v[90:91], v[90:91], 1.0 op_sel_hi:[1,0]
    v_rcp_f32 v84, v84
    v_rcp_f32 v85, v85
    v_rcp_f32 v86, v86
    v_rcp_f32 v87, v87
    v_rcp_f32 v88, v88
    v_rcp_f32 v89, v89
    v_rcp_f32 v90, v90
    v_rcp_f32 v91, v91
    v_pk_mul_f32 v[76:77], v[76:77], v[84:85]
    v_pk_mul_f32 v[78:79], v[78:79], v[86:87]
    v_pk_mul_f32 v[80:81], v[80:81], v[88:89]
    v_pk_mul_f32 v[82:83], v[82:83], v[90:91]
    v_cvt_pk_bf16_f32 v84, v76, v77
    v_cvt_pk_bf16_f32 v85, v78, v79
    v_cvt_pk_bf16_f32 v86, v80, v81
    v_cvt_pk_bf16_f32 v87, v82, v83
    s_nop 0
    v_permlane32_swap_b32 v84, v86
    v_permlane32_swap_b32_e64 v85, v87
    buffer_store_dwordx4 v[84:87], v2, s[4:7], s39 offen offset:2048 sc1
    s_waitcnt vmcnt(14)
    v_mfma_f32_32x32x16_bf16 v[32:47], a[192:195], v[96:99], 0
    v_mfma_f32_32x32x16_bf16 v[48:63], a[196:199], v[96:99], 0
    buffer_load_dwordx4 v[96:99], v21, s[4:7], s76 offen sc1
    s_waitcnt vmcnt(14)
    v_mfma_f32_32x32x16_bf16 v[32:47], a[200:203], v[100:103], v[32:47]
    v_mfma_f32_32x32x16_bf16 v[48:63], a[204:207], v[100:103], v[48:63]
    buffer_load_dwordx4 v[100:103], v21, s[4:7], s77 offen sc1
    s_waitcnt vmcnt(14)
    v_mfma_f32_32x32x16_bf16 v[32:47], a[208:211], v[104:107], v[32:47]
    v_mfma_f32_32x32x16_bf16 v[48:63], a[212:215], v[104:107], v[48:63]
    buffer_load_dwordx4 v[104:107], v21, s[4:7], s78 offen sc1
    s_waitcnt vmcnt(14)
    v_mfma_f32_32x32x16_bf16 v[32:47], a[216:219], v[108:111], v[32:47]
    v_mfma_f32_32x32x16_bf16 v[48:63], a[220:223], v[108:111], v[48:63]
    buffer_load_dwordx4 v[108:111], v21, s[4:7], s79 offen sc1
    s_waitcnt vmcnt(14)
    v_mfma_f32_32x32x16_bf16 v[32:47], a[224:227], v[112:115], v[32:47]
    v_mfma_f32_32x32x16_bf16 v[48:63], a[228:231], v[112:115], v[48:63]
    buffer_load_dwordx4 v[112:115], v21, s[4:7], s80 offen sc1
    s_waitcnt vmcnt(14)
    v_mfma_f32_32x32x16_bf16 v[32:47], a[232:235], v[116:119], v[32:47]
    v_mfma_f32_32x32x16_bf16 v[48:63], a[236:239], v[116:119], v[48:63]
    buffer_load_dwordx4 v[116:119], v21, s[4:7], s81 offen sc1
    s_waitcnt vmcnt(14)
    v_mfma_f32_32x32x16_bf16 v[32:47], a[240:243], v[120:123], v[32:47]
    v_mfma_f32_32x32x16_bf16 v[48:63], a[244:247], v[120:123], v[48:63]
    buffer_load_dwordx4 v[120:123], v21, s[4:7], s82 offen sc1
    s_waitcnt vmcnt(14)
    v_mfma_f32_32x32x16_bf16 v[32:47], a[248:251], v[124:127], v[32:47]
    v_mfma_f32_32x32x16_bf16 v[48:63], a[252:255], v[124:127], v[48:63]
    buffer_load_dwordx4 v[124:127], v21, s[4:7], s83 offen sc1
    s_waitcnt vmcnt(13)
    v_mfma_f32_32x32x16_bf16 v[32:47], v[144:147], v[128:131], v[32:47]
    v_mfma_f32_32x32x16_bf16 v[48:63], v[148:151], v[128:131], v[48:63]
    buffer_load_dwordx4 v[128:131], v21, s[4:7], s84 offen sc1
    s_waitcnt vmcnt(13)
    v_mfma_f32_32x32x16_bf16 v[32:47], v[152:155], v[132:135], v[32:47]
    s_waitcnt vmcnt(9)
    s_add_u32 s36, s41, 49152
    s_mov_b64 exec, 1
    buffer_store_dword v8, v8, s[4:7], s36 offen offset:0 sc1
    s_mov_b64 exec, -1
    v_mfma_f32_32x32x16_bf16 v[48:63], v[156:159], v[132:135], v[48:63]
    buffer_load_dwordx4 v[132:135], v21, s[4:7], s85 offen sc1
    v_mfma_f32_32x32x16_bf16 v[32:47], v[160:163], v[136:139], v[32:47]
    v_mfma_f32_32x32x16_bf16 v[48:63], v[164:167], v[136:139], v[48:63]
    v_mfma_f32_32x32x16_bf16 v[32:47], v[168:171], v[140:143], v[32:47]
    v_mfma_f32_32x32x16_bf16 v[48:63], v[172:175], v[140:143], v[48:63]
    s_waitcnt vmcnt(10)
    v_mfma_f32_32x32x16_bf16 v[32:47], v[176:179], v[96:99], v[32:47]
    v_mfma_f32_32x32x16_bf16 v[48:63], v[180:183], v[96:99], v[48:63]
    s_waitcnt vmcnt(9)
    v_mfma_f32_32x32x16_bf16 v[32:47], v[184:187], v[100:103], v[32:47]
    v_mfma_f32_32x32x16_bf16 v[48:63], v[188:191], v[100:103], v[48:63]
    s_waitcnt vmcnt(8)
    v_mfma_f32_32x32x16_bf16 v[32:47], v[192:195], v[104:107], v[32:47]
    s_add_u32 s37, s42, 49152
    buffer_load_dword v22, v20, s[4:7], s37 offen offset:0 sc1
    s_add_u32 s36, s49, 6302720
    v_add_u32 v21, s36, v11
    s_waitcnt vmcnt(8)
    v_mfma_f32_32x32x16_bf16 v[32:47], v[200:203], v[108:111], v[32:47]
    v_mfma_f32_32x32x16_bf16 v[48:63], v[196:199], v[104:107], v[48:63]
    s_waitcnt vmcnt(7)
    v_mfma_f32_32x32x16_bf16 v[32:47], v[208:211], v[112:115], v[32:47]
    s_waitcnt vmcnt(6)
    v_mfma_f32_32x32x16_bf16 v[32:47], v[216:219], v[116:119], v[32:47]
    v_mfma_f32_32x32x16_bf16 v[48:63], v[204:207], v[108:111], v[48:63]
    s_waitcnt vmcnt(5)
    v_mfma_f32_32x32x16_bf16 v[32:47], v[224:227], v[120:123], v[32:47]
    s_waitcnt vmcnt(4)
    v_mfma_f32_32x32x16_bf16 v[32:47], v[232:235], v[124:127], v[32:47]
    v_mfma_f32_32x32x16_bf16 v[48:63], v[212:215], v[112:115], v[48:63]
    s_waitcnt vmcnt(3)
    v_mfma_f32_32x32x16_bf16 v[32:47], v[240:243], v[128:131], v[32:47]
    s_waitcnt vmcnt(1)
    v_mfma_f32_32x32x16_bf16 v[32:47], v[248:251], v[132:135], v[32:47]
    v_mfma_f32_32x32x16_bf16 v[48:63], v[220:223], v[116:119], v[48:63]
    s_waitcnt vmcnt(0)
    v_cmp_eq_u32 vcc, -1, v22
    s_nop 0
    s_and_b64 vcc, exec, vcc
    s_cbranch_vccz K1_PDONE65
    s_mov_b32 s63, 524288
K1_POLL64:
    buffer_load_dword v22, v20, s[4:7], s37 offen offset:0 sc1
    s_waitcnt vmcnt(0)
    v_cmp_eq_u32 vcc, -1, v22
    s_nop 0
    s_and_b64 vcc, exec, vcc
    s_cbranch_vccz K1_PDONE65
    s_sub_u32 s63, s63, 1
    s_cmp_lg_u32 s63, 0
    s_cbranch_scc1 K1_POLL64
K1_PDONE65:
    v_mfma_f32_32x32x16_bf16 v[48:63], v[228:231], v[120:123], v[48:63]
    buffer_load_dwordx4 v[136:139], v21, s[4:7], s64 offen sc1
    buffer_load_dwordx4 v[140:143], v21, s[4:7], s65 offen sc1
    v_mfma_f32_32x32x16_bf16 v[48:63], v[236:239], v[124:127], v[48:63]
    s_nop 1
    ds_write_b128 v3, v[32:35] offset:0
    buffer_load_dwordx4 v[96:99], v21, s[4:7], s66 offen sc1
    v_mfma_f32_32x32x16_bf16 v[48:63], v[244:247], v[128:131], v[48:63]
    ds_write_b128 v3, v[36:39] offset:16
    ds_write_b128 v3, v[40:43] offset:32
    buffer_load_dwordx4 v[100:103], v21, s[4:7], s67 offen sc1
    v_mfma_f32_32x32x16_bf16 v[48:63], v[252:255], v[132:135], v[48:63]
    ds_write_b128 v3, v[44:47] offset:48
    buffer_load_dwordx4 v[104:107], v21, s[4:7], s68 offen sc1
    s_nop 9
    ds_write_b128 v3, v[48:51] offset:128
    buffer_load_dwordx4 v[108:111], v21, s[4:7], s69 offen sc1
    buffer_load_dwordx4 v[112:115], v21, s[4:7], s70 offen sc1
    ds_write_b128 v3, v[52:55] offset:144
    buffer_load_dwordx4 v[116:119], v21, s[4:7], s71 offen sc1
    buffer_load_dwordx4 v[120:123], v21, s[4:7], s72 offen sc1
    ds_write_b128 v3, v[56:59] offset:160
    buffer_load_dwordx4 v[124:127], v21, s[4:7], s73 offen sc1
    buffer_load_dwordx4 v[128:131], v21, s[4:7], s74 offen sc1
    ds_write_b128 v3, v[60:63] offset:176
    buffer_load_dwordx4 v[132:135], v21, s[4:7], s75 offen sc1
    s_waitcnt lgkmcnt(0)
    s_barrier
    s_waitcnt vmcnt(11)
    v_mfma_f32_32x32x16_bf16 v[32:47], a[192:195], v[136:139], 0
    ds_read_b128 v[76:79], v4 offset:0
    ds_read_b128 v[80:83], v4 offset:16
    ds_read_b128 v[84:87], v4 offset:8704
    ds_read_b128 v[88:91], v4 offset:8720
    v_lshlrev_b32_e64 v64, 16, v24
    v_mfma_f32_32x32x16_bf16 v[48:63], a[196:199], v[136:139], 0
    buffer_load_dwordx4 v[136:139], v21, s[4:7], s76 offen sc1
    v_and_b32 v65, s56, v24
    v_lshlrev_b32 v66, 16, v25
    v_and_b32 v67, s56, v25
    v_lshlrev_b32_e64 v68, 16, v26
    s_waitcnt vmcnt(11)
    v_mfma_f32_32x32x16_bf16 v[32:47], a[200:203], v[140:143], v[32:47]
    v_and_b32 v69, s56, v26
    v_lshlrev_b32 v70, 16, v27
    v_and_b32 v71, s56, v27
    s_waitcnt lgkmcnt(3)
    v_add_f32 v64, v64, v76
    v_add_f32 v65, v65, v77
    v_mfma_f32_32x32x16_bf16 v[48:63], a[204:207], v[140:143], v[48:63]
    buffer_load_dwordx4 v[140:143], v21, s[4:7], s77 offen sc1
    v_add_f32 v66, v66, v78
    v_add_f32 v67, v67, v79
    s_waitcnt lgkmcnt(2)
    v_add_f32 v68, v68, v80
    v_add_f32 v69, v69, v81
    s_waitcnt vmcnt(11)
    v_mfma_f32_32x32x16_bf16 v[32:47], a[208:211], v[96:99], v[32:47]
    v_add_f32 v70, v70, v82
    v_add_f32 v71, v71, v83
    ds_read_b128 v[76:79], v13 offset:0
    ds_read_b128 v[80:83], v13 offset:16
    s_waitcnt lgkmcnt(3)
    v_add_f32 v64, v64, v84
    v_mfma_f32_32x32x16_bf16 v[48:63], a[212:215], v[96:99], v[48:63]
    buffer_load_dwordx4 v[96:99], v21, s[4:7], s78 offen sc1
    v_add_f32 v65, v65, v85
    v_add_f32 v66, v66, v86
    v_add_f32 v67, v67, v87
    s_waitcnt lgkmcnt(2)
    v_add_f32 v68, v68, v88
    s_waitcnt vmcnt(11)
    v_mfma_f32_32x32x16_bf16 v[32:47], a[216:219], v[100:103], v[32:47]
    v_add_f32 v69, v69, v89
    v_add_f32 v70, v70, v90
    v_add_f32_e64 v71, v71, v91
    ds_read_b128 v[84:87], v4 offset:17408
    ds_read_b128 v[88:91], v4 offset:17424
    v_mfma_f32_32x32x16_bf16 v[48:63], a[220:223], v[100:103], v[48:63]
    buffer_load_dwordx4 v[100:103], v21, s[4:7], s79 offen sc1
    s_waitcnt lgkmcnt(3)
    v_add_f32 v64, v64, v76
    v_add_f32 v65, v65, v77
    v_add_f32 v66, v66, v78
    v_add_f32 v67, v67, v79
    s_waitcnt vmcnt(11)
    v_mfma_f32_32x32x16_bf16 v[32:47], a[224:227], v[104:107], v[32:47]
    s_waitcnt lgkmcnt(2)
    v_add_f32 v68, v68, v80
    v_add_f32 v69, v69, v81
    v_add_f32 v70, v70, v82
    v_add_f32_e64 v71, v71, v83
    ds_read_b128 v[76:79], v4 offset:26112
    v_mfma_f32_32x32x16_bf16 v[48:63], a[228:231], v[104:107], v[48:63]
    buffer_load_dwordx4 v[104:107], v21, s[4:7], s80 offen sc1
    ds_read_b128 v[80:83], v4 offset:26128
    s_waitcnt lgkmcnt(3)
    v_add_f32 v64, v64, v84
    v_add_f32 v65, v65, v85
    v_add_f32_e64 v66, v66, v86
    s_waitcnt vmcnt(11)
    v_mfma_f32_32x32x16_bf16 v[32:47], a[232:235], v[108:111], v[32:47]
    v_add_f32 v67, v67, v87
    s_waitcnt lgkmcnt(2)
    v_add_f32 v68, v68, v88
    v_add_f32 v69, v69, v89
    v_add_f32 v70, v70, v90
    v_add_f32 v71, v71, v91
    v_mfma_f32_32x32x16_bf16 v[48:63], a[236:239], v[108:111], v[48:63]
    buffer_load_dwordx4 v[108:111], v21, s[4:7], s81 offen sc1
    s_waitcnt lgkmcnt(1)
    v_add_f32 v64, v64, v76
    v_add_f32 v65, v65, v77
    v_add_f32 v66, v66, v78
    v_add_f32 v67, v67, v79
    s_waitcnt vmcnt(11)
    v_mfma_f32_32x32x16_bf16 v[32:47], a[240:243], v[112:115], v[32:47]
    s_waitcnt lgkmcnt(0)
    v_add_f32 v68, v68, v80
    v_add_f32 v69, v69, v81
    v_add_f32 v70, v70, v82
    v_add_f32_e64 v71, v71, v83
    v_cvt_pk_bf16_f32 v24, v64, v65
    v_mfma_f32_32x32x16_bf16 v[48:63], a[244:247], v[112:115], v[48:63]
    buffer_load_dwordx4 v[112:115], v21, s[4:7], s82 offen sc1
    v_cvt_pk_bf16_f32 v25, v66, v67
    v_cvt_pk_bf16_f32 v26, v68, v69
    v_cvt_pk_bf16_f32 v27, v70, v71
    s_add_u32 s35, s43, 0
    s_waitcnt vmcnt(11)
    v_mfma_f32_32x32x16_bf16 v[32:47], a[248:251], v[116:119], v[32:47]
    buffer_store_dwordx4 v[24:27], v7, s[12:15], s35 offen
    v_mfma_f32_32x32x16_bf16 v[48:63], a[252:255], v[116:119], v[48:63]
    buffer_load_dwordx4 v[116:119], v21, s[4:7], s83 offen sc1
    s_waitcnt vmcnt(12)
    v_mfma_f32_32x32x16_bf16 v[32:47], v[144:147], v[120:123], v[32:47]
    v_mfma_f32_32x32x16_bf16 v[48:63], v[148:151], v[120:123], v[48:63]
    buffer_load_dwordx4 v[120:123], v21, s[4:7], s84 offen sc1
    s_waitcnt vmcnt(12)
    v_mfma_f32_32x32x16_bf16 v[32:47], v[152:155], v[124:127], v[32:47]
    v_mfma_f32_32x32x16_bf16 v[48:63], v[156:159], v[124:127], v[48:63]
    buffer_load_dwordx4 v[124:127], v21, s[4:7], s85 offen sc1
    s_waitcnt vmcnt(12)
    v_mfma_f32_32x32x16_bf16 v[32:47], v[160:163], v[128:131], v[32:47]
    v_mfma_f32_32x32x16_bf16 v[48:63], v[164:167], v[128:131], v[48:63]
    s_waitcnt vmcnt(11)
    v_mfma_f32_32x32x16_bf16 v[32:47], v[168:171], v[132:135], v[32:47]
    v_mfma_f32_32x32x16_bf16 v[48:63], v[172:175], v[132:135], v[48:63]
    s_waitcnt vmcnt(10)
    v_mfma_f32_32x32x16_bf16 v[32:47], v[176:179], v[136:139], v[32:47]
    v_mfma_f32_32x32x16_bf16 v[48:63], v[180:183], v[136:139], v[48:63]
    s_waitcnt vmcnt(9)
    v_mfma_f32_32x32x16_bf16 v[32:47], v[184:187], v[140:143], v[32:47]
    v_mfma_f32_32x32x16_bf16 v[48:63], v[188:191], v[140:143], v[48:63]
    s_waitcnt vmcnt(8)
    v_mfma_f32_32x32x16_bf16 v[32:47], v[192:195], v[96:99], v[32:47]
    s_waitcnt vmcnt(7)
    v_mfma_f32_32x32x16_bf16 v[32:47], v[200:203], v[100:103], v[32:47]
    v_mfma_f32_32x32x16_bf16 v[48:63], v[196:199], v[96:99], v[48:63]
    s_waitcnt vmcnt(6)
    v_mfma_f32_32x32x16_bf16 v[32:47], v[208:211], v[104:107], v[32:47]
    s_waitcnt vmcnt(5)
    v_mfma_f32_32x32x16_bf16 v[32:47], v[216:219], v[108:111], v[32:47]
    v_mfma_f32_32x32x16_bf16 v[48:63], v[204:207], v[100:103], v[48:63]
    s_waitcnt vmcnt(4)
    v_mfma_f32_32x32x16_bf16 v[32:47], v[224:227], v[112:115], v[32:47]
    s_waitcnt vmcnt(2)
    v_mfma_f32_32x32x16_bf16 v[32:47], v[232:235], v[116:119], v[32:47]
    v_mfma_f32_32x32x16_bf16 v[48:63], v[212:215], v[104:107], v[48:63]
    s_waitcnt vmcnt(1)
    v_mfma_f32_32x32x16_bf16 v[32:47], v[240:243], v[120:123], v[32:47]
    s_waitcnt vmcnt(0)
    v_mfma_f32_32x32x16_bf16 v[32:47], v[248:251], v[124:127], v[32:47]
    v_mfma_f32_32x32x16_bf16 v[48:63], v[220:223], v[108:111], v[48:63]
    v_mfma_f32_32x32x16_bf16 v[48:63], v[228:231], v[112:115], v[48:63]
    v_mfma_f32_32x32x16_bf16 v[48:63], v[236:239], v[116:119], v[48:63]
    s_nop 8
    ds_write_b128 v3, v[32:35] offset:34816
    v_mfma_f32_32x32x16_bf16 v[48:63], v[244:247], v[120:123], v[48:63]
    ds_write_b128 v3, v[36:39] offset:34832
    ds_write_b128 v3, v[40:43] offset:34848
    v_mfma_f32_32x32x16_bf16 v[48:63], v[252:255], v[124:127], v[48:63]
    ds_write_b128 v3, v[44:47] offset:34864
    s_nop 10
    ds_write_b128 v3, v[48:51] offset:34944
    ds_write_b128 v3, v[52:55] offset:34960
    ds_write_b128 v3, v[56:59] offset:34976
    ds_write_b128 v3, v[60:63] offset:34992
    s_waitcnt lgkmcnt(0)
    s_barrier
    ds_read_b128 v[32:35], v4 offset:34816
    ds_read_b128 v[36:39], v4 offset:34832
    ds_read_b128 v[40:43], v4 offset:43520
    ds_read_b128 v[44:47], v4 offset:43536
    ds_read_b128 v[48:51], v4 offset:52224
    ds_read_b128 v[52:55], v4 offset:52240
    ds_read_b128 v[56:59], v4 offset:60928
    ds_read_b128 v[60:63], v4 offset:60944
    ds_read_b128 v[76:79], v13 offset:0
    ds_read_b128 v[80:83], v13 offset:16
    v_lshlrev_b32 v64, 16, v28
    v_and_b32 v65, s56, v28
    v_lshlrev_b32 v66, 16, v29
    v_and_b32 v67, s56, v29
    v_lshlrev_b32 v68, 16, v30
    v_and_b32 v69, s56, v30
    v_lshlrev_b32 v70, 16, v31
    v_and_b32_e64 v71, s56, v31
    s_waitcnt lgkmcnt(7)
    v_pk_add_f32 v[32:33], v[32:33], v[40:41]
    v_pk_add_f32 v[34:35], v[34:35], v[42:43]
    s_waitcnt lgkmcnt(6)
    v_pk_add_f32 v[36:37], v[36:37], v[44:45]
    v_pk_add_f32 v[38:39], v[38:39], v[46:47]
    s_waitcnt lgkmcnt(3)
    v_pk_add_f32 v[48:49], v[48:49], v[56:57]
    v_pk_add_f32 v[50:51], v[50:51], v[58:59]
    s_waitcnt lgkmcnt(2)
    v_pk_add_f32 v[52:53], v[52:53], v[60:61]
    v_pk_add_f32 v[54:55], v[54:55], v[62:63]
    v_pk_add_f32 v[64:65], v[64:65], v[32:33]
    v_pk_add_f32 v[66:67], v[66:67], v[34:35]
    v_pk_add_f32 v[68:69], v[68:69], v[36:37]
    v_pk_add_f32 v[70:71], v[70:71], v[38:39]
    v_pk_add_f32 v[64:65], v[64:65], v[48:49]
    v_pk_add_f32 v[66:67], v[66:67], v[50:51]
    v_pk_add_f32 v[68:69], v[68:69], v[52:53]
    v_pk_add_f32 v[70:71], v[70:71], v[54:55]
    s_waitcnt lgkmcnt(1)
    v_pk_add_f32 v[64:65], v[64:65], v[76:77]
    v_pk_add_f32 v[66:67], v[66:67], v[78:79]
    s_waitcnt lgkmcnt(0)
    v_pk_add_f32 v[68:69], v[68:69], v[80:81]
    v_pk_add_f32 v[70:71], v[70:71], v[82:83]
    v_cvt_pk_bf16_f32 v28, v64, v65
    v_cvt_pk_bf16_f32 v29, v66, v67
    v_cvt_pk_bf16_f32 v30, v68, v69
    v_cvt_pk_bf16_f32 v31, v70, v71
    s_add_u32 s35, s43, 32768
    buffer_store_dwordx4 v[28:31], v7, s[12:15], s35 offen
K1_FIN:
    s_cmp_lg_u32 s2, 0
    s_cbranch_scc1 K1_NOEP
    v_mov_b32 v14, s92
    s_mov_b32 s35, 0x1308000
    s_mov_b64 exec, 1
    buffer_store_dword v14, v8, s[4:7], s35 offen
    s_mov_b64 exec, -1
K1_NOEP:
K1_END:
    s_endpgm
.section .rodata,"a"
.p2align 6
.amdhsa_kernel interleave_layers__ssm_conv_h3__dense_activation_gelu__prompt_kernel
  .amdhsa_next_free_vgpr 512
  .amdhsa_next_free_sgpr 102
  .amdhsa_accum_offset 256
  .amdhsa_group_segment_fixed_size 0
  .amdhsa_kernarg_size 112
  .amdhsa_user_sgpr_count 2
  .amdhsa_user_sgpr_kernarg_segment_ptr 1
  .amdhsa_system_sgpr_workgroup_id_x 1
  .amdhsa_float_denorm_mode_32 3
.end_amdhsa_kernel
```
